```python
import torch

def _softmax(x, axis=-1):
    return torch.softmax(x, dim=axis)

def _gelu(x):
    return torch.nn.functional.gelu(x, approximate='tanh')

def _silu(x):
    return torch.nn.functional.silu(x)

def _sigmoid(x):
    return torch.sigmoid(x)

def _layernorm(x, axis=-1, eps=1e-05):
    m = x.mean(dim=axis, keepdim=True)
    v = x.var(dim=axis, keepdim=True, unbiased=False)
    return (x - m) / torch.sqrt(v + eps)

def _scatter_add(tgt, idx, src, axis=0):
    return tgt.clone().index_add_(axis, idx, src)

def _segment_sum(src, seg, n):
    out = torch.zeros((n,) + src.shape[1:], dtype=src.dtype)
    return out.index_add_(0, seg, src)

def _pad(x, pw):
    flat = tuple((v for pair in reversed(pw) for v in pair))
    return torch.nn.functional.pad(x, flat)
kernel_name = 'sequential_preLN__mha_block__mixer_gmlp__prompt'

def setup_inputs():

    _w = lambda a: (lambda t: t.to(torch.bfloat16) if t.is_floating_point() else t)(torch.as_tensor(a))

    def _A_setup():
        B, S, D, H = (1, 2048, 512, 32)
        return {'x': _w((lambda *s: torch.randn(*s, dtype=torch.bfloat16) * 0.05)(B, S, D)), 'wqkv': _w((lambda *s: torch.randn(*s, dtype=torch.bfloat16) * 0.05)(D, 3 * D)), 'wo': _w((lambda *s: torch.randn(*s, dtype=torch.bfloat16) * 0.05)(D, D))}
    _A_in = _A_setup()

    def _B_setup():
        B, S, D, F = (1, 2048, 512, 1792)
        Fh = F // 2
        return {'x': _w((lambda *s: torch.randn(*s, dtype=torch.bfloat16) * 0.05)(B, S, D)), 'w_in': _w((lambda *s: torch.randn(*s, dtype=torch.bfloat16) * 0.4)(D, 2 * Fh)), 'w_sp': _w(0.01 * (lambda *s: torch.randn(*s, dtype=torch.bfloat16) * 0.4)(S, S)), 'b_sp': _w(1.0 + 0.01 * (lambda *s: torch.randn(*s, dtype=torch.bfloat16) * 0.05)(S)), 'w_out': _w((lambda *s: torch.randn(*s, dtype=torch.bfloat16) * 0.05)(Fh, D))}
    _B_in = _B_setup()
    return {'A_x': _A_in['x'], 'A_wqkv': _A_in['wqkv'], 'A_wo': _A_in['wo'], 'B_x': _B_in['x'], 'B_w_in': _B_in['w_in'], 'B_w_sp': _B_in['w_sp'], 'B_b_sp': _B_in['b_sp'], 'B_w_out': _B_in['w_out']}

def reference(A_x, A_wqkv, A_wo, B_x, B_w_in, B_w_sp, B_b_sp, B_w_out):

    def _A_ref(x, wqkv, wo):
        B, S, D = x.shape
        H = 32
        Dh = D // H
        qkv = (lambda x, *d: x.permute(*d))((x @ wqkv).reshape(B, S, 3, H, Dh), 2, 0, 3, 1, 4)
        q, k, v = (qkv[0], qkv[1], qkv[2])
        scores = torch.einsum('bhqd,bhkd->bhqk', q, k) * Dh ** (-0.5)
        p = _softmax(scores, axis=-1)
        o = torch.einsum('bhqk,bhkd->bhqd', p, v)
        return (lambda x, *d: x.permute(*d))(o, 0, 2, 1, 3).reshape(B, S, D) @ wo

    def _B_ref(x, w_in, w_sp, b_sp, w_out):
        B, S, D = x.shape
        F = w_in.shape[-1]
        Fh = F // 2
        z = _gelu(torch.einsum('bsd,df->bsf', x, w_in))
        z1 = z[..., :Fh].clone()
        z2 = _layernorm(z[..., Fh:], axis=-1)
        g = torch.einsum('ts,bsf->btf', w_sp, z2) + b_sp[None, :, None]
        return torch.einsum('bsf,fd->bsd', z1 * g, w_out)
    x = A_x
    h = x + _A_ref(_layernorm(x, axis=-1), A_wqkv, A_wo)
    h2 = h + _B_ref(_layernorm(h, axis=-1), B_w_in, B_w_sp, B_b_sp, B_w_out)
    return h2
```

```asm
; @launch kernel=k1_qkv_kernel grid=(256,1,1) block=(256,1,1) lds=163840
; @launch kernel=k2_main_kernel grid=(256,1,1) block=(256,1,1) lds=163840
.amdgcn_target "amdgcn-amd-amdhsa--gfx950"
.text
.globl k1_qkv_kernel
.p2align 8
.type k1_qkv_kernel,@function
k1_qkv_kernel:
    s_cmp_ge_u32 s2, 256
    s_cbranch_scc1 k1_qkv_kernel_end
    s_load_dwordx4 s[4:7], s[0:1], 0
    s_load_dwordx2 s[8:9], s[0:1], 80
    s_load_dwordx2 s[48:49], s[0:1], 32
    s_getpc_b64 s[56:57]
k1_qkv_kernel_ct:
    s_mov_b32 s58, k1_qkv_kernel_end-k1_qkv_kernel_ct
    s_mov_b32 s59, 0x00020000
    s_lshr_b32 s3, s2, 3
    s_mul_i32 s3, s3, 512
    v_lshlrev_b32 v254, 7, v0
    v_cmp_gt_u32 vcc, 4, v0
    s_nop 0
    s_and_saveexec_b64 s[92:93], vcc
    s_cbranch_execz k1_qkv_kernel_ct2
    buffer_load_dword v255, v254, s[56:59], s3 offen
k1_qkv_kernel_ct2:
    s_mov_b64 exec, s[92:93]
    s_and_b32 s10, s2, 7
    s_lshr_b32 s11, s2, 3
    s_lshr_b32 s12, s10, 1
    s_lshl_b32 s12, s12, 3
    s_and_b32 s28, s11, 7
    s_add_u32 s12, s12, s28
    s_and_b32 s13, s10, 1
    s_lshl_b32 s13, s13, 2
    s_lshr_b32 s14, s11, 3
    s_add_u32 s13, s13, s14
    v_and_b32 v1, 63, v0
    v_lshrrev_b32 v2, 6, v0
    s_nop 0
    v_readfirstlane_b32 s14, v2
    s_nop 0
    s_and_b32 s15, s14, 1
    s_lshr_b32 s16, s14, 1
    s_lshl_b32 s18, s12, 6
    s_lshl_b32 s19, s14, 4
    s_add_u32 s18, s18, s19
    v_lshrrev_b32 v2, 3, v1
    v_add_u32 v3, s18, v2
    v_lshlrev_b32 v3, 10, v3
    v_and_b32 v4, 7, v1
    v_lshl_add_u32 v5, v4, 4, v3
    v_add_u32 v6, 0x2000, v5
    s_waitcnt lgkmcnt(0)
    s_mov_b32 s20, s4
    s_mov_b32 s21, s5
    s_mov_b32 s22, 0x200000
    s_mov_b32 s23, 0x00020000
    buffer_load_dwordx4 v[76:79], v5, s[20:23], 0 offen offset:0
    buffer_load_dwordx4 v[80:83], v6, s[20:23], 0 offen offset:0
    buffer_load_dwordx4 v[84:87], v5, s[20:23], 0 offen offset:128
    buffer_load_dwordx4 v[88:91], v6, s[20:23], 0 offen offset:128
    buffer_load_dwordx4 v[92:95], v5, s[20:23], 0 offen offset:256
    buffer_load_dwordx4 v[96:99], v6, s[20:23], 0 offen offset:256
    buffer_load_dwordx4 v[100:103], v5, s[20:23], 0 offen offset:384
    buffer_load_dwordx4 v[104:107], v6, s[20:23], 0 offen offset:384
    s_lshl_b32 s19, s14, 6
    v_add_u32 v3, s19, v2
    v_mul_u32_u24 v3, 3072, v3
    v_bfe_u32 v2, v1, 4, 1
    v_lshlrev_b32 v2, 2, v2
    v_xor_b32 v7, v2, v4
    v_lshl_add_u32 v7, v7, 4, v3
    s_lshl_b32 s19, s13, 7
    v_add_u32 v7, s19, v7
    s_lshl_b32 s17, s14, 13
    s_lshl_b32 s54, s11, 2
    s_add_u32 s54, s54, s14
    s_mul_i32 s19, s54, 12288
    s_and_b32 s18, s10, 1
    s_lshl_b32 s18, s18, 9
    s_add_u32 s19, s19, s18
    v_lshrrev_b32 v2, 2, v1
    v_and_b32 v3, 3, v1
    v_lshlrev_b32 v3, 7, v3
    v_lshl_add_u32 v2, v2, 10, v3
    v_add_u32 v8, s19, v2
    v_lshrrev_b32 v140, 5, v1
    v_and_b32 v141, 31, v1
    v_and_b32 v142, 15, v1
    s_lshl_b32 s19, s15, 12
    v_lshl_add_u32 v2, v141, 7, s19
    v_lshrrev_b32 v3, 1, v142
    v_xor_b32 v3, v3, v140
    v_lshl_add_u32 v143, v3, 4, v2
    v_xor_b32 v144, 32, v143
    v_xor_b32 v145, 64, v143
    v_xor_b32 v146, 96, v143
    buffer_load_dwordx4 v[108:111], v5, s[20:23], 0 offen offset:512
    buffer_load_dwordx4 v[112:115], v6, s[20:23], 0 offen offset:512
    v_lshrrev_b32 v2, 2, v142
    v_lshl_add_u32 v2, v140, 3, v2
    v_lshlrev_b32 v2, 7, v2
    v_lshrrev_b32 v3, 4, v141
    v_lshl_add_u32 v2, v3, 5, v2
    v_and_b32 v3, 3, v1
    v_lshl_add_u32 v2, v3, 3, v2
    v_lshrrev_b32 v3, 3, v142
    v_xor_b32 v3, s16, v3
    v_lshl_add_u32 v147, v3, 6, v2
    v_add_u32 v148, 0x10000, v147
    v_add_u32 v149, 0x20000, v147
    s_lshl_b32 s55, s2, 11
    s_add_u32 s55, s55, 0x1780000
    s_lshl_b32 s18, s12, 1
    s_add_u32 s18, s18, s15
    s_lshl_b32 s19, s13, 2
    s_lshl_b32 s28, s16, 1
    s_add_u32 s19, s19, s28
    s_lshl_b32 s33, s18, 5
    s_add_u32 s33, s33, s19
    s_lshl_b32 s33, s33, 10
    s_lshl_b32 s28, s19, 6
    s_add_u32 s28, s28, s18
    s_lshl_b32 s28, s28, 10
    v_lshl_add_u32 v150, v1, 4, s28
    v_lshrrev_b32 v152, 4, v141
    v_lshlrev_b32 v152, 16, v152
    v_lshl_add_u32 v152, v140, 8, v152
    v_lshl_add_u32 v152, v142, 4, v152
    v_add_u32 v152, s28, v152
    s_lshl_b32 s28, s19, 9
    buffer_load_dwordx4 v[116:119], v5, s[20:23], 0 offen offset:640
    buffer_load_dwordx4 v[120:123], v6, s[20:23], 0 offen offset:640
    s_lshl_b32 s29, s18, 3
    s_add_u32 s28, s28, s29
    s_add_u32 s28, s28, 0x600000
    v_lshrrev_b32 v151, 4, v141
    v_lshlrev_b32 v151, 2, v151
    v_lshl_add_u32 v151, v140, 9, v151
    s_lshl_b32 s19, s14, 6
    s_add_u32 s19, s19, 0
    v_add_u32 v2, s19, v1
    v_mul_u32_u24 v3, 4682, v2
    v_lshrrev_b32 v3, 16, v3
    v_mul_u32_u24 v172, 14, v3
    v_sub_u32 v2, v2, v172
    v_mul_u32_u24 v3, 3584, v3
    v_lshl_add_u32 v153, v2, 4, v3
    s_lshl_b32 s19, s14, 6
    s_add_u32 s19, s19, 256
    v_add_u32 v2, s19, v1
    v_mul_u32_u24 v3, 4682, v2
    v_lshrrev_b32 v3, 16, v3
    v_mul_u32_u24 v172, 14, v3
    v_sub_u32 v2, v2, v172
    v_mul_u32_u24 v3, 3584, v3
    v_lshl_add_u32 v154, v2, 4, v3
    s_and_b32 s50, s2, 15
    s_lshr_b32 s51, s2, 4
    s_mul_i32 s52, s50, 224
    s_mul_i32 s53, s51, 114688
    s_add_u32 s52, s52, s53
    s_lshl_b32 s50, s50, 4
    s_add_u32 s50, s50, s51
    s_mul_i32 s50, s50, 7168
    buffer_load_dwordx4 v[124:127], v5, s[20:23], 0 offen offset:768
    buffer_load_dwordx4 v[128:131], v6, s[20:23], 0 offen offset:768
    s_lshl_b32 s51, s14, 10
    s_add_u32 s50, s50, s51
    s_add_u32 s50, s50, 0x1300000
    v_lshrrev_b32 v173, 2, v142
    v_lshl_add_u32 v173, v140, 4, v173
    v_bfe_u32 v2, v1, 4, 1
    v_lshl_add_u32 v173, v2, 2, v173
    v_mul_u32_u24 v173, 224, v173
    v_and_b32 v2, 3, v1
    v_lshl_add_u32 v173, v2, 3, v173
    s_lshl_b32 s19, s14, 5
    v_add_u32 v173, s19, v173
    v_lshlrev_b32 v174, 4, v1
    buffer_load_dwordx4 v[132:135], v5, s[20:23], 0 offen offset:896
    buffer_load_dwordx4 v[136:139], v6, s[20:23], 0 offen offset:896
    s_mov_b32 s24, s6
    s_mov_b32 s25, s7
    s_mov_b32 s26, 0x180000
    s_mov_b32 s27, 0x00020000
    s_add_u32 m0, s17, 65536
    s_mov_b32 s30, 1024
    buffer_load_dwordx4 v7, s[24:27], s30 offen lds
    s_add_u32 m0, s17, 66560
    s_mov_b32 s30, 25600
    buffer_load_dwordx4 v7, s[24:27], s30 offen lds
    s_add_u32 m0, s17, 67584
    s_mov_b32 s30, 50176
    buffer_load_dwordx4 v7, s[24:27], s30 offen lds
    s_add_u32 m0, s17, 68608
    s_mov_b32 s30, 74752
    buffer_load_dwordx4 v7, s[24:27], s30 offen lds
    s_add_u32 m0, s17, 69632
    s_mov_b32 s30, 99328
    buffer_load_dwordx4 v7, s[24:27], s30 offen lds
    s_add_u32 m0, s17, 70656
    s_mov_b32 s30, 123904
    buffer_load_dwordx4 v7, s[24:27], s30 offen lds
    s_add_u32 m0, s17, 71680
    s_mov_b32 s30, 148480
    buffer_load_dwordx4 v7, s[24:27], s30 offen lds
    s_add_u32 m0, s17, 72704
    s_mov_b32 s30, 173056
    buffer_load_dwordx4 v7, s[24:27], s30 offen lds
    s_mov_b32 exec_hi, 0xffff
    buffer_load_dword v9, v8, s[24:27], 0 offen
    s_mov_b64 exec, -1
    s_mov_b32 s44, s48
    s_mov_b32 s45, s49
    s_mov_b32 s46, 0x1c0000
    s_mov_b32 s47, 0x00020000
    buffer_load_dwordx4 v[176:179], v153, s[44:47], s52 offen
    buffer_load_dwordx4 v[180:183], v154, s[44:47], s52 offen
    s_mov_b32 s40, s8
    s_mov_b32 s41, s9
    s_mov_b32 s42, 0x2000000
    s_mov_b32 s43, 0x00020000
    v_mov_b32 v184, 0
    v_mov_b32 v185, 0
    v_mov_b32 v186, 0
    v_mov_b32 v187, 0
    s_mov_b32 s34, 0x3f803f80
    s_mov_b32 s35, 0xffff0000
    s_mov_b32 s36, 0x3eb8aa3b
    s_waitcnt vmcnt(25)
    v_dot2_f32_bf16 v184, v76, s34, v184
    v_dot2_f32_bf16 v185, v76, v76, v185
    v_dot2_f32_bf16 v186, v80, s34, v186
    v_dot2_f32_bf16 v187, v80, v80, v187
    v_dot2_f32_bf16 v184, v77, s34, v184
    v_dot2_f32_bf16 v185, v77, v77, v185
    v_dot2_f32_bf16 v186, v81, s34, v186
    v_dot2_f32_bf16 v187, v81, v81, v187
    v_dot2_f32_bf16 v184, v78, s34, v184
    v_dot2_f32_bf16 v185, v78, v78, v185
    v_dot2_f32_bf16 v186, v82, s34, v186
    v_dot2_f32_bf16 v187, v82, v82, v187
    v_dot2_f32_bf16 v184, v79, s34, v184
    v_dot2_f32_bf16 v185, v79, v79, v185
    v_dot2_f32_bf16 v186, v83, s34, v186
    v_dot2_f32_bf16 v187, v83, v83, v187
    s_waitcnt vmcnt(23)
    v_dot2_f32_bf16 v184, v84, s34, v184
    v_dot2_f32_bf16 v185, v84, v84, v185
    v_dot2_f32_bf16 v186, v88, s34, v186
    v_dot2_f32_bf16 v187, v88, v88, v187
    v_dot2_f32_bf16 v184, v85, s34, v184
    v_dot2_f32_bf16 v185, v85, v85, v185
    v_dot2_f32_bf16 v186, v89, s34, v186
    v_dot2_f32_bf16 v187, v89, v89, v187
    v_dot2_f32_bf16 v184, v86, s34, v184
    v_dot2_f32_bf16 v185, v86, v86, v185
    v_dot2_f32_bf16 v186, v90, s34, v186
    v_dot2_f32_bf16 v187, v90, v90, v187
    v_dot2_f32_bf16 v184, v87, s34, v184
    v_dot2_f32_bf16 v185, v87, v87, v185
    v_dot2_f32_bf16 v186, v91, s34, v186
    v_dot2_f32_bf16 v187, v91, v91, v187
    s_waitcnt vmcnt(21)
    v_dot2_f32_bf16 v184, v92, s34, v184
    v_dot2_f32_bf16 v185, v92, v92, v185
    v_dot2_f32_bf16 v186, v96, s34, v186
    v_dot2_f32_bf16 v187, v96, v96, v187
    v_dot2_f32_bf16 v184, v93, s34, v184
    v_dot2_f32_bf16 v185, v93, v93, v185
    v_dot2_f32_bf16 v186, v97, s34, v186
    v_dot2_f32_bf16 v187, v97, v97, v187
    v_dot2_f32_bf16 v184, v94, s34, v184
    v_dot2_f32_bf16 v185, v94, v94, v185
    v_dot2_f32_bf16 v186, v98, s34, v186
    v_dot2_f32_bf16 v187, v98, v98, v187
    v_dot2_f32_bf16 v184, v95, s34, v184
    v_dot2_f32_bf16 v185, v95, v95, v185
    v_dot2_f32_bf16 v186, v99, s34, v186
    v_dot2_f32_bf16 v187, v99, v99, v187
    s_waitcnt vmcnt(19)
    v_dot2_f32_bf16 v184, v100, s34, v184
    v_dot2_f32_bf16 v185, v100, v100, v185
    v_dot2_f32_bf16 v186, v104, s34, v186
    v_dot2_f32_bf16 v187, v104, v104, v187
    v_dot2_f32_bf16 v184, v101, s34, v184
    v_dot2_f32_bf16 v185, v101, v101, v185
    v_dot2_f32_bf16 v186, v105, s34, v186
    v_dot2_f32_bf16 v187, v105, v105, v187
    v_dot2_f32_bf16 v184, v102, s34, v184
    v_dot2_f32_bf16 v185, v102, v102, v185
    v_dot2_f32_bf16 v186, v106, s34, v186
    v_dot2_f32_bf16 v187, v106, v106, v187
    v_dot2_f32_bf16 v184, v103, s34, v184
    v_dot2_f32_bf16 v185, v103, v103, v185
    v_dot2_f32_bf16 v186, v107, s34, v186
    v_dot2_f32_bf16 v187, v107, v107, v187
    s_waitcnt vmcnt(17)
    v_dot2_f32_bf16 v184, v108, s34, v184
    v_dot2_f32_bf16 v185, v108, v108, v185
    v_dot2_f32_bf16 v186, v112, s34, v186
    v_dot2_f32_bf16 v187, v112, v112, v187
    v_dot2_f32_bf16 v184, v109, s34, v184
    v_dot2_f32_bf16 v185, v109, v109, v185
    v_dot2_f32_bf16 v186, v113, s34, v186
    v_dot2_f32_bf16 v187, v113, v113, v187
    v_dot2_f32_bf16 v184, v110, s34, v184
    v_dot2_f32_bf16 v185, v110, v110, v185
    v_dot2_f32_bf16 v186, v114, s34, v186
    v_dot2_f32_bf16 v187, v114, v114, v187
    v_dot2_f32_bf16 v184, v111, s34, v184
    v_dot2_f32_bf16 v185, v111, v111, v185
    v_dot2_f32_bf16 v186, v115, s34, v186
    v_dot2_f32_bf16 v187, v115, v115, v187
    s_waitcnt vmcnt(15)
    v_dot2_f32_bf16 v184, v116, s34, v184
    v_dot2_f32_bf16 v185, v116, v116, v185
    v_dot2_f32_bf16 v186, v120, s34, v186
    v_dot2_f32_bf16 v187, v120, v120, v187
    v_dot2_f32_bf16 v184, v117, s34, v184
    v_dot2_f32_bf16 v185, v117, v117, v185
    v_dot2_f32_bf16 v186, v121, s34, v186
    v_dot2_f32_bf16 v187, v121, v121, v187
    v_dot2_f32_bf16 v184, v118, s34, v184
    v_dot2_f32_bf16 v185, v118, v118, v185
    v_dot2_f32_bf16 v186, v122, s34, v186
    v_dot2_f32_bf16 v187, v122, v122, v187
    v_dot2_f32_bf16 v184, v119, s34, v184
    v_dot2_f32_bf16 v185, v119, v119, v185
    v_dot2_f32_bf16 v186, v123, s34, v186
    v_dot2_f32_bf16 v187, v123, v123, v187
    s_waitcnt vmcnt(13)
    v_dot2_f32_bf16 v184, v124, s34, v184
    v_dot2_f32_bf16 v185, v124, v124, v185
    v_dot2_f32_bf16 v186, v128, s34, v186
    v_dot2_f32_bf16 v187, v128, v128, v187
    v_dot2_f32_bf16 v184, v125, s34, v184
    v_dot2_f32_bf16 v185, v125, v125, v185
    v_dot2_f32_bf16 v186, v129, s34, v186
    v_dot2_f32_bf16 v187, v129, v129, v187
    v_dot2_f32_bf16 v184, v126, s34, v184
    v_dot2_f32_bf16 v185, v126, v126, v185
    v_dot2_f32_bf16 v186, v130, s34, v186
    v_dot2_f32_bf16 v187, v130, v130, v187
    v_dot2_f32_bf16 v184, v127, s34, v184
    v_dot2_f32_bf16 v185, v127, v127, v185
    v_dot2_f32_bf16 v186, v131, s34, v186
    v_dot2_f32_bf16 v187, v131, v131, v187
    s_waitcnt vmcnt(11)
    v_dot2_f32_bf16 v184, v132, s34, v184
    v_dot2_f32_bf16 v185, v132, v132, v185
    v_dot2_f32_bf16 v186, v136, s34, v186
    v_dot2_f32_bf16 v187, v136, v136, v187
    v_dot2_f32_bf16 v184, v133, s34, v184
    v_dot2_f32_bf16 v185, v133, v133, v185
    v_dot2_f32_bf16 v186, v137, s34, v186
    v_dot2_f32_bf16 v187, v137, v137, v187
    v_dot2_f32_bf16 v184, v134, s34, v184
    v_dot2_f32_bf16 v185, v134, v134, v185
    v_dot2_f32_bf16 v186, v138, s34, v186
    v_dot2_f32_bf16 v187, v138, v138, v187
    v_dot2_f32_bf16 v184, v135, s34, v184
    v_dot2_f32_bf16 v185, v135, v135, v185
    v_dot2_f32_bf16 v186, v139, s34, v186
    v_dot2_f32_bf16 v187, v139, v139, v187
    v_lshrrev_b32 v2, 4, v1
    v_xor_b32 v2, v2, v4
    v_lshrrev_b32 v3, 3, v1
    v_add_f32_dpp v184, v184, v184 quad_perm:[1,0,3,2] row_mask:0xf bank_mask:0xf
    v_add_f32_dpp v185, v185, v185 quad_perm:[1,0,3,2] row_mask:0xf bank_mask:0xf
    v_add_f32_dpp v186, v186, v186 quad_perm:[1,0,3,2] row_mask:0xf bank_mask:0xf
    v_add_f32_dpp v187, v187, v187 quad_perm:[1,0,3,2] row_mask:0xf bank_mask:0xf
    v_add_f32_dpp v184, v184, v184 quad_perm:[2,3,0,1] row_mask:0xf bank_mask:0xf
    v_add_f32_dpp v185, v185, v185 quad_perm:[2,3,0,1] row_mask:0xf bank_mask:0xf
    v_add_f32_dpp v186, v186, v186 quad_perm:[2,3,0,1] row_mask:0xf bank_mask:0xf
    v_add_f32_dpp v187, v187, v187 quad_perm:[2,3,0,1] row_mask:0xf bank_mask:0xf
    v_add_f32_dpp v184, v184, v184 row_half_mirror row_mask:0xf bank_mask:0xf
    v_add_f32_dpp v185, v185, v185 row_half_mirror row_mask:0xf bank_mask:0xf
    v_add_f32_dpp v186, v186, v186 row_half_mirror row_mask:0xf bank_mask:0xf
    v_add_f32_dpp v187, v187, v187 row_half_mirror row_mask:0xf bank_mask:0xf
    v_mul_f32 v194, 0xbb000000, v184
    v_mul_f32 v196, 0xbb000000, v186
    v_mul_f32 v185, 0x3b000000, v185
    v_mul_f32 v187, 0x3b000000, v187
    v_fma_f32 v185, -v194, v194, v185
    v_fma_f32 v187, -v196, v196, v187
    v_max_f32 v185, 0, v185
    v_max_f32 v187, 0, v187
    v_add_f32 v185, 0x3727c5ac, v185
    v_add_f32 v187, 0x3727c5ac, v187
    v_rsq_f32 v190, v185
    v_rsq_f32 v192, v187
    v_lshlrev_b32 v3, 7, v3
    v_lshl_add_u32 v2, v2, 4, v3
    s_lshl_b32 s19, s14, 11
    v_add_u32 v188, s19, v2
    v_xor_b32 v189, 0x440, v188
    v_mul_f32 v194, v194, v190
    v_mul_f32 v196, v196, v192
    v_lshlrev_b32 v156, 16, v76
    v_and_b32 v157, s35, v76
    v_lshlrev_b32 v158, 16, v77
    v_and_b32 v159, s35, v77
    v_lshlrev_b32 v160, 16, v78
    v_and_b32 v161, s35, v78
    v_lshlrev_b32 v162, 16, v79
    v_and_b32 v163, s35, v79
    v_pk_fma_f32 v[156:157], v[156:157], v[190:191], v[194:195] op_sel_hi:[1,0,0]
    v_pk_fma_f32 v[158:159], v[158:159], v[190:191], v[194:195] op_sel_hi:[1,0,0]
    v_pk_fma_f32 v[160:161], v[160:161], v[190:191], v[194:195] op_sel_hi:[1,0,0]
    v_pk_fma_f32 v[162:163], v[162:163], v[190:191], v[194:195] op_sel_hi:[1,0,0]
    v_cvt_pk_bf16_f32 v76, v156, v157
    v_cvt_pk_bf16_f32 v77, v158, v159
    v_cvt_pk_bf16_f32 v78, v160, v161
    v_cvt_pk_bf16_f32 v79, v162, v163
    ds_write_b128 v188, v[76:79] offset:0
    v_lshlrev_b32 v164, 16, v80
    v_and_b32 v165, s35, v80
    v_lshlrev_b32 v166, 16, v81
    v_and_b32 v167, s35, v81
    v_lshlrev_b32 v168, 16, v82
    v_and_b32 v169, s35, v82
    v_lshlrev_b32 v170, 16, v83
    v_and_b32 v171, s35, v83
    v_pk_fma_f32 v[164:165], v[164:165], v[192:193], v[196:197] op_sel_hi:[1,0,0]
    v_pk_fma_f32 v[166:167], v[166:167], v[192:193], v[196:197] op_sel_hi:[1,0,0]
    v_pk_fma_f32 v[168:169], v[168:169], v[192:193], v[196:197] op_sel_hi:[1,0,0]
    v_pk_fma_f32 v[170:171], v[170:171], v[192:193], v[196:197] op_sel_hi:[1,0,0]
    v_cvt_pk_bf16_f32 v80, v164, v165
    v_cvt_pk_bf16_f32 v81, v166, v167
    v_cvt_pk_bf16_f32 v82, v168, v169
    v_cvt_pk_bf16_f32 v83, v170, v171
    ds_write_b128 v189, v[80:83] offset:0
    v_lshlrev_b32 v156, 16, v84
    v_and_b32 v157, s35, v84
    v_lshlrev_b32 v158, 16, v85
    v_and_b32 v159, s35, v85
    v_lshlrev_b32 v160, 16, v86
    v_and_b32 v161, s35, v86
    v_lshlrev_b32 v162, 16, v87
    v_and_b32 v163, s35, v87
    v_pk_fma_f32 v[156:157], v[156:157], v[190:191], v[194:195] op_sel_hi:[1,0,0]
    v_pk_fma_f32 v[158:159], v[158:159], v[190:191], v[194:195] op_sel_hi:[1,0,0]
    v_pk_fma_f32 v[160:161], v[160:161], v[190:191], v[194:195] op_sel_hi:[1,0,0]
    v_pk_fma_f32 v[162:163], v[162:163], v[190:191], v[194:195] op_sel_hi:[1,0,0]
    v_cvt_pk_bf16_f32 v84, v156, v157
    v_cvt_pk_bf16_f32 v85, v158, v159
    v_cvt_pk_bf16_f32 v86, v160, v161
    v_cvt_pk_bf16_f32 v87, v162, v163
    ds_write_b128 v188, v[84:87] offset:8192
    v_lshlrev_b32 v164, 16, v88
    v_and_b32 v165, s35, v88
    v_lshlrev_b32 v166, 16, v89
    v_and_b32 v167, s35, v89
    v_lshlrev_b32 v168, 16, v90
    v_and_b32 v169, s35, v90
    v_lshlrev_b32 v170, 16, v91
    v_and_b32 v171, s35, v91
    v_pk_fma_f32 v[164:165], v[164:165], v[192:193], v[196:197] op_sel_hi:[1,0,0]
    v_pk_fma_f32 v[166:167], v[166:167], v[192:193], v[196:197] op_sel_hi:[1,0,0]
    v_pk_fma_f32 v[168:169], v[168:169], v[192:193], v[196:197] op_sel_hi:[1,0,0]
    v_pk_fma_f32 v[170:171], v[170:171], v[192:193], v[196:197] op_sel_hi:[1,0,0]
    v_cvt_pk_bf16_f32 v88, v164, v165
    v_cvt_pk_bf16_f32 v89, v166, v167
    v_cvt_pk_bf16_f32 v90, v168, v169
    v_cvt_pk_bf16_f32 v91, v170, v171
    ds_write_b128 v189, v[88:91] offset:8192
    v_lshlrev_b32 v156, 16, v92
    v_and_b32 v157, s35, v92
    v_lshlrev_b32 v158, 16, v93
    v_and_b32 v159, s35, v93
    v_lshlrev_b32 v160, 16, v94
    v_and_b32 v161, s35, v94
    v_lshlrev_b32 v162, 16, v95
    v_and_b32 v163, s35, v95
    v_pk_fma_f32 v[156:157], v[156:157], v[190:191], v[194:195] op_sel_hi:[1,0,0]
    v_pk_fma_f32 v[158:159], v[158:159], v[190:191], v[194:195] op_sel_hi:[1,0,0]
    v_pk_fma_f32 v[160:161], v[160:161], v[190:191], v[194:195] op_sel_hi:[1,0,0]
    v_pk_fma_f32 v[162:163], v[162:163], v[190:191], v[194:195] op_sel_hi:[1,0,0]
    v_cvt_pk_bf16_f32 v92, v156, v157
    v_cvt_pk_bf16_f32 v93, v158, v159
    v_cvt_pk_bf16_f32 v94, v160, v161
    v_cvt_pk_bf16_f32 v95, v162, v163
    ds_write_b128 v188, v[92:95] offset:16384
    v_lshlrev_b32 v164, 16, v96
    v_and_b32 v165, s35, v96
    v_lshlrev_b32 v166, 16, v97
    v_and_b32 v167, s35, v97
    v_lshlrev_b32 v168, 16, v98
    v_and_b32 v169, s35, v98
    v_lshlrev_b32 v170, 16, v99
    v_and_b32 v171, s35, v99
    v_pk_fma_f32 v[164:165], v[164:165], v[192:193], v[196:197] op_sel_hi:[1,0,0]
    v_pk_fma_f32 v[166:167], v[166:167], v[192:193], v[196:197] op_sel_hi:[1,0,0]
    v_pk_fma_f32 v[168:169], v[168:169], v[192:193], v[196:197] op_sel_hi:[1,0,0]
    v_pk_fma_f32 v[170:171], v[170:171], v[192:193], v[196:197] op_sel_hi:[1,0,0]
    v_cvt_pk_bf16_f32 v96, v164, v165
    v_cvt_pk_bf16_f32 v97, v166, v167
    v_cvt_pk_bf16_f32 v98, v168, v169
    v_cvt_pk_bf16_f32 v99, v170, v171
    ds_write_b128 v189, v[96:99] offset:16384
    v_lshlrev_b32 v156, 16, v100
    v_and_b32 v157, s35, v100
    v_lshlrev_b32 v158, 16, v101
    v_and_b32 v159, s35, v101
    v_lshlrev_b32 v160, 16, v102
    v_and_b32 v161, s35, v102
    v_lshlrev_b32 v162, 16, v103
    v_and_b32 v163, s35, v103
    v_pk_fma_f32 v[156:157], v[156:157], v[190:191], v[194:195] op_sel_hi:[1,0,0]
    v_pk_fma_f32 v[158:159], v[158:159], v[190:191], v[194:195] op_sel_hi:[1,0,0]
    v_pk_fma_f32 v[160:161], v[160:161], v[190:191], v[194:195] op_sel_hi:[1,0,0]
    v_pk_fma_f32 v[162:163], v[162:163], v[190:191], v[194:195] op_sel_hi:[1,0,0]
    v_cvt_pk_bf16_f32 v100, v156, v157
    v_cvt_pk_bf16_f32 v101, v158, v159
    v_cvt_pk_bf16_f32 v102, v160, v161
    v_cvt_pk_bf16_f32 v103, v162, v163
    ds_write_b128 v188, v[100:103] offset:24576
    v_lshlrev_b32 v164, 16, v104
    v_and_b32 v165, s35, v104
    v_lshlrev_b32 v166, 16, v105
    v_and_b32 v167, s35, v105
    v_lshlrev_b32 v168, 16, v106
    v_and_b32 v169, s35, v106
    v_lshlrev_b32 v170, 16, v107
    v_and_b32 v171, s35, v107
    v_pk_fma_f32 v[164:165], v[164:165], v[192:193], v[196:197] op_sel_hi:[1,0,0]
    v_pk_fma_f32 v[166:167], v[166:167], v[192:193], v[196:197] op_sel_hi:[1,0,0]
    v_pk_fma_f32 v[168:169], v[168:169], v[192:193], v[196:197] op_sel_hi:[1,0,0]
    v_pk_fma_f32 v[170:171], v[170:171], v[192:193], v[196:197] op_sel_hi:[1,0,0]
    v_cvt_pk_bf16_f32 v104, v164, v165
    v_cvt_pk_bf16_f32 v105, v166, v167
    v_cvt_pk_bf16_f32 v106, v168, v169
    v_cvt_pk_bf16_f32 v107, v170, v171
    ds_write_b128 v189, v[104:107] offset:24576
    v_lshlrev_b32 v156, 16, v108
    v_and_b32 v157, s35, v108
    v_lshlrev_b32 v158, 16, v109
    v_and_b32 v159, s35, v109
    v_lshlrev_b32 v160, 16, v110
    v_and_b32 v161, s35, v110
    v_lshlrev_b32 v162, 16, v111
    v_and_b32 v163, s35, v111
    v_pk_fma_f32 v[156:157], v[156:157], v[190:191], v[194:195] op_sel_hi:[1,0,0]
    v_pk_fma_f32 v[158:159], v[158:159], v[190:191], v[194:195] op_sel_hi:[1,0,0]
    v_pk_fma_f32 v[160:161], v[160:161], v[190:191], v[194:195] op_sel_hi:[1,0,0]
    v_pk_fma_f32 v[162:163], v[162:163], v[190:191], v[194:195] op_sel_hi:[1,0,0]
    v_cvt_pk_bf16_f32 v108, v156, v157
    v_cvt_pk_bf16_f32 v109, v158, v159
    v_cvt_pk_bf16_f32 v110, v160, v161
    v_cvt_pk_bf16_f32 v111, v162, v163
    ds_write_b128 v188, v[108:111] offset:32768
    v_lshlrev_b32 v164, 16, v112
    v_and_b32 v165, s35, v112
    v_lshlrev_b32 v166, 16, v113
    v_and_b32 v167, s35, v113
    v_lshlrev_b32 v168, 16, v114
    v_and_b32 v169, s35, v114
    v_lshlrev_b32 v170, 16, v115
    v_and_b32 v171, s35, v115
    v_pk_fma_f32 v[164:165], v[164:165], v[192:193], v[196:197] op_sel_hi:[1,0,0]
    v_pk_fma_f32 v[166:167], v[166:167], v[192:193], v[196:197] op_sel_hi:[1,0,0]
    v_pk_fma_f32 v[168:169], v[168:169], v[192:193], v[196:197] op_sel_hi:[1,0,0]
    v_pk_fma_f32 v[170:171], v[170:171], v[192:193], v[196:197] op_sel_hi:[1,0,0]
    v_cvt_pk_bf16_f32 v112, v164, v165
    v_cvt_pk_bf16_f32 v113, v166, v167
    v_cvt_pk_bf16_f32 v114, v168, v169
    v_cvt_pk_bf16_f32 v115, v170, v171
    ds_write_b128 v189, v[112:115] offset:32768
    s_add_u32 m0, s17, 98304
    s_mov_b32 s30, 787456
    buffer_load_dwordx4 v7, s[24:27], s30 offen lds
    v_lshlrev_b32 v156, 16, v116
    v_and_b32 v157, s35, v116
    v_lshlrev_b32 v158, 16, v117
    v_and_b32 v159, s35, v117
    v_lshlrev_b32 v160, 16, v118
    v_and_b32 v161, s35, v118
    v_lshlrev_b32 v162, 16, v119
    v_and_b32 v163, s35, v119
    v_pk_fma_f32 v[156:157], v[156:157], v[190:191], v[194:195] op_sel_hi:[1,0,0]
    v_pk_fma_f32 v[158:159], v[158:159], v[190:191], v[194:195] op_sel_hi:[1,0,0]
    v_pk_fma_f32 v[160:161], v[160:161], v[190:191], v[194:195] op_sel_hi:[1,0,0]
    v_pk_fma_f32 v[162:163], v[162:163], v[190:191], v[194:195] op_sel_hi:[1,0,0]
    v_cvt_pk_bf16_f32 v116, v156, v157
    v_cvt_pk_bf16_f32 v117, v158, v159
    v_cvt_pk_bf16_f32 v118, v160, v161
    v_cvt_pk_bf16_f32 v119, v162, v163
    ds_write_b128 v188, v[116:119] offset:40960
    s_add_u32 m0, s17, 99328
    s_mov_b32 s30, 812032
    buffer_load_dwordx4 v7, s[24:27], s30 offen lds
    v_lshlrev_b32 v164, 16, v120
    v_and_b32 v165, s35, v120
    v_lshlrev_b32 v166, 16, v121
    v_and_b32 v167, s35, v121
    v_lshlrev_b32 v168, 16, v122
    v_and_b32 v169, s35, v122
    v_lshlrev_b32 v170, 16, v123
    v_and_b32 v171, s35, v123
    v_pk_fma_f32 v[164:165], v[164:165], v[192:193], v[196:197] op_sel_hi:[1,0,0]
    v_pk_fma_f32 v[166:167], v[166:167], v[192:193], v[196:197] op_sel_hi:[1,0,0]
    v_pk_fma_f32 v[168:169], v[168:169], v[192:193], v[196:197] op_sel_hi:[1,0,0]
    v_pk_fma_f32 v[170:171], v[170:171], v[192:193], v[196:197] op_sel_hi:[1,0,0]
    v_cvt_pk_bf16_f32 v120, v164, v165
    v_cvt_pk_bf16_f32 v121, v166, v167
    v_cvt_pk_bf16_f32 v122, v168, v169
    v_cvt_pk_bf16_f32 v123, v170, v171
    ds_write_b128 v189, v[120:123] offset:40960
    s_add_u32 m0, s17, 100352
    s_mov_b32 s30, 836608
    buffer_load_dwordx4 v7, s[24:27], s30 offen lds
    v_lshlrev_b32 v156, 16, v124
    v_and_b32 v157, s35, v124
    v_lshlrev_b32 v158, 16, v125
    v_and_b32 v159, s35, v125
    v_lshlrev_b32 v160, 16, v126
    v_and_b32 v161, s35, v126
    v_lshlrev_b32 v162, 16, v127
    v_and_b32 v163, s35, v127
    v_pk_fma_f32 v[156:157], v[156:157], v[190:191], v[194:195] op_sel_hi:[1,0,0]
    v_pk_fma_f32 v[158:159], v[158:159], v[190:191], v[194:195] op_sel_hi:[1,0,0]
    v_pk_fma_f32 v[160:161], v[160:161], v[190:191], v[194:195] op_sel_hi:[1,0,0]
    v_pk_fma_f32 v[162:163], v[162:163], v[190:191], v[194:195] op_sel_hi:[1,0,0]
    v_cvt_pk_bf16_f32 v124, v156, v157
    v_cvt_pk_bf16_f32 v125, v158, v159
    v_cvt_pk_bf16_f32 v126, v160, v161
    v_cvt_pk_bf16_f32 v127, v162, v163
    ds_write_b128 v188, v[124:127] offset:49152
    s_add_u32 m0, s17, 101376
    s_mov_b32 s30, 861184
    buffer_load_dwordx4 v7, s[24:27], s30 offen lds
    v_lshlrev_b32 v164, 16, v128
    v_and_b32 v165, s35, v128
    v_lshlrev_b32 v166, 16, v129
    v_and_b32 v167, s35, v129
    v_lshlrev_b32 v168, 16, v130
    v_and_b32 v169, s35, v130
    v_lshlrev_b32 v170, 16, v131
    v_and_b32 v171, s35, v131
    v_pk_fma_f32 v[164:165], v[164:165], v[192:193], v[196:197] op_sel_hi:[1,0,0]
    v_pk_fma_f32 v[166:167], v[166:167], v[192:193], v[196:197] op_sel_hi:[1,0,0]
    v_pk_fma_f32 v[168:169], v[168:169], v[192:193], v[196:197] op_sel_hi:[1,0,0]
    v_pk_fma_f32 v[170:171], v[170:171], v[192:193], v[196:197] op_sel_hi:[1,0,0]
    v_cvt_pk_bf16_f32 v128, v164, v165
    v_cvt_pk_bf16_f32 v129, v166, v167
    v_cvt_pk_bf16_f32 v130, v168, v169
    v_cvt_pk_bf16_f32 v131, v170, v171
    ds_write_b128 v189, v[128:131] offset:49152
    s_add_u32 m0, s17, 102400
    s_mov_b32 s30, 885760
    buffer_load_dwordx4 v7, s[24:27], s30 offen lds
    v_lshlrev_b32 v156, 16, v132
    v_and_b32 v157, s35, v132
    v_lshlrev_b32 v158, 16, v133
    v_and_b32 v159, s35, v133
    v_lshlrev_b32 v160, 16, v134
    v_and_b32 v161, s35, v134
    v_lshlrev_b32 v162, 16, v135
    v_and_b32 v163, s35, v135
    v_pk_fma_f32 v[156:157], v[156:157], v[190:191], v[194:195] op_sel_hi:[1,0,0]
    v_pk_fma_f32 v[158:159], v[158:159], v[190:191], v[194:195] op_sel_hi:[1,0,0]
    v_pk_fma_f32 v[160:161], v[160:161], v[190:191], v[194:195] op_sel_hi:[1,0,0]
    v_pk_fma_f32 v[162:163], v[162:163], v[190:191], v[194:195] op_sel_hi:[1,0,0]
    v_cvt_pk_bf16_f32 v132, v156, v157
    v_cvt_pk_bf16_f32 v133, v158, v159
    v_cvt_pk_bf16_f32 v134, v160, v161
    v_cvt_pk_bf16_f32 v135, v162, v163
    ds_write_b128 v188, v[132:135] offset:57344
    s_add_u32 m0, s17, 103424
    s_mov_b32 s30, 910336
    buffer_load_dwordx4 v7, s[24:27], s30 offen lds
    v_lshlrev_b32 v164, 16, v136
    v_and_b32 v165, s35, v136
    v_lshlrev_b32 v166, 16, v137
    v_and_b32 v167, s35, v137
    v_lshlrev_b32 v168, 16, v138
    v_and_b32 v169, s35, v138
    v_lshlrev_b32 v170, 16, v139
    v_and_b32 v171, s35, v139
    v_pk_fma_f32 v[164:165], v[164:165], v[192:193], v[196:197] op_sel_hi:[1,0,0]
    v_pk_fma_f32 v[166:167], v[166:167], v[192:193], v[196:197] op_sel_hi:[1,0,0]
    v_pk_fma_f32 v[168:169], v[168:169], v[192:193], v[196:197] op_sel_hi:[1,0,0]
    v_pk_fma_f32 v[170:171], v[170:171], v[192:193], v[196:197] op_sel_hi:[1,0,0]
    v_cvt_pk_bf16_f32 v136, v164, v165
    v_cvt_pk_bf16_f32 v137, v166, v167
    v_cvt_pk_bf16_f32 v138, v168, v169
    v_cvt_pk_bf16_f32 v139, v170, v171
    ds_write_b128 v189, v[136:139] offset:57344
    s_add_u32 m0, s17, 104448
    s_mov_b32 s30, 934912
    buffer_load_dwordx4 v7, s[24:27], s30 offen lds
    s_waitcnt vmcnt(10) lgkmcnt(0)
    s_barrier
    ds_read_b128 v[12:15], v143 offset:0
    ds_read_b64_tr_b16 v[164:165], v148 offset:0
    ds_read_b64_tr_b16 v[166:167], v148 offset:512
    ds_read_b128 v[16:19], v144 offset:0
    ds_read_b64_tr_b16 v[168:169], v148 offset:2048
    ds_read_b64_tr_b16 v[170:171], v148 offset:2560
    ds_read_b128 v[20:23], v145 offset:0
    ds_read_b64_tr_b16 v[232:233], v148 offset:4096
    ds_read_b64_tr_b16 v[234:235], v148 offset:4608
    ds_read_b128 v[24:27], v146 offset:0
    ds_read_b64_tr_b16 v[236:237], v148 offset:6144
    ds_read_b64_tr_b16 v[238:239], v148 offset:6656
    ds_read_b128 v[28:31], v143 offset:8192
    ds_read_b64_tr_b16 v[240:241], v148 offset:8192
    ds_read_b64_tr_b16 v[242:243], v148 offset:8704
    s_waitcnt lgkmcnt(9)
    v_mfma_f32_32x32x16_bf16 v[200:215], v[164:167], v[12:15], 0
    ds_read_b128 v[32:35], v144 offset:8192
    ds_read_b64_tr_b16 v[244:245], v148 offset:10240
    ds_read_b64_tr_b16 v[246:247], v148 offset:10752
    s_add_u32 m0, s17, 105472
    s_mov_b32 s30, 959488
    buffer_load_dwordx4 v7, s[24:27], s30 offen lds
    v_mfma_f32_32x32x16_bf16 v[200:215], v[168:171], v[16:19], v[200:215]
    ds_read_b128 v[36:39], v145 offset:8192
    ds_read_b64_tr_b16 v[164:165], v148 offset:12288
    ds_read_b64_tr_b16 v[166:167], v148 offset:12800
    s_add_u32 m0, s17, 131072
    s_mov_b32 s30, 0
    buffer_load_dwordx4 v7, s[24:27], s30 offen lds
    s_waitcnt lgkmcnt(9)
    v_mfma_f32_32x32x16_bf16 v[200:215], v[232:235], v[20:23], v[200:215]
    ds_read_b128 v[40:43], v146 offset:8192
    ds_read_b64_tr_b16 v[168:169], v148 offset:14336
    ds_read_b64_tr_b16 v[170:171], v148 offset:14848
    s_add_u32 m0, s17, 132096
    s_mov_b32 s30, 24576
    buffer_load_dwordx4 v7, s[24:27], s30 offen lds
    v_mfma_f32_32x32x16_bf16 v[200:215], v[236:239], v[24:27], v[200:215]
    ds_read_b128 v[44:47], v143 offset:16384
    ds_read_b64_tr_b16 v[232:233], v148 offset:16384
    ds_read_b64_tr_b16 v[234:235], v148 offset:16896
    s_add_u32 m0, s17, 133120
    s_mov_b32 s30, 49152
    buffer_load_dwordx4 v7, s[24:27], s30 offen lds
    s_waitcnt lgkmcnt(9)
    v_mfma_f32_32x32x16_bf16 v[200:215], v[240:243], v[28:31], v[200:215]
    ds_read_b128 v[48:51], v144 offset:16384
    ds_read_b64_tr_b16 v[236:237], v148 offset:18432
    ds_read_b64_tr_b16 v[238:239], v148 offset:18944
    s_add_u32 m0, s17, 134144
    s_mov_b32 s30, 73728
    buffer_load_dwordx4 v7, s[24:27], s30 offen lds
    v_mfma_f32_32x32x16_bf16 v[200:215], v[244:247], v[32:35], v[200:215]
    ds_read_b128 v[52:55], v145 offset:16384
    ds_read_b64_tr_b16 v[240:241], v148 offset:20480
    ds_read_b64_tr_b16 v[242:243], v148 offset:20992
    s_add_u32 m0, s17, 135168
    s_mov_b32 s30, 98304
    buffer_load_dwordx4 v7, s[24:27], s30 offen lds
    s_waitcnt lgkmcnt(9)
    v_mfma_f32_32x32x16_bf16 v[200:215], v[164:167], v[36:39], v[200:215]
    ds_read_b128 v[56:59], v146 offset:16384
    ds_read_b64_tr_b16 v[244:245], v148 offset:22528
    ds_read_b64_tr_b16 v[246:247], v148 offset:23040
    s_add_u32 m0, s17, 136192
    s_mov_b32 s30, 122880
    buffer_load_dwordx4 v7, s[24:27], s30 offen lds
    v_mfma_f32_32x32x16_bf16 v[200:215], v[168:171], v[40:43], v[200:215]
    ds_read_b128 v[60:63], v143 offset:24576
    ds_read_b64_tr_b16 v[164:165], v148 offset:24576
    ds_read_b64_tr_b16 v[166:167], v148 offset:25088
    s_add_u32 m0, s17, 137216
    s_mov_b32 s30, 147456
    buffer_load_dwordx4 v7, s[24:27], s30 offen lds
    s_waitcnt lgkmcnt(9)
    v_mfma_f32_32x32x16_bf16 v[200:215], v[232:235], v[44:47], v[200:215]
    ds_read_b128 v[64:67], v144 offset:24576
    ds_read_b64_tr_b16 v[168:169], v148 offset:26624
    ds_read_b64_tr_b16 v[170:171], v148 offset:27136
    s_add_u32 m0, s17, 138240
    s_mov_b32 s30, 172032
    buffer_load_dwordx4 v7, s[24:27], s30 offen lds
    v_mfma_f32_32x32x16_bf16 v[200:215], v[236:239], v[48:51], v[200:215]
    ds_read_b128 v[68:71], v145 offset:24576
    ds_read_b64_tr_b16 v[232:233], v148 offset:28672
    ds_read_b64_tr_b16 v[234:235], v148 offset:29184
    s_waitcnt lgkmcnt(9)
    v_mfma_f32_32x32x16_bf16 v[200:215], v[240:243], v[52:55], v[200:215]
    ds_read_b128 v[72:75], v146 offset:24576
    ds_read_b64_tr_b16 v[236:237], v148 offset:30720
    ds_read_b64_tr_b16 v[238:239], v148 offset:31232
    s_waitcnt vmcnt(8) lgkmcnt(0)
    s_barrier
    v_mfma_f32_32x32x16_bf16 v[200:215], v[244:247], v[56:59], v[200:215]
    ds_read_b128 v[76:79], v143 offset:32768
    ds_read_b64_tr_b16 v[240:241], v148 offset:32768
    ds_read_b64_tr_b16 v[242:243], v148 offset:33280
    s_add_u32 m0, s17, 65536
    s_mov_b32 s30, 786432
    buffer_load_dwordx4 v7, s[24:27], s30 offen lds
    s_waitcnt lgkmcnt(9)
    v_mfma_f32_32x32x16_bf16 v[200:215], v[164:167], v[60:63], v[200:215]
    ds_read_b128 v[80:83], v144 offset:32768
    ds_read_b64_tr_b16 v[244:245], v148 offset:34816
    ds_read_b64_tr_b16 v[246:247], v148 offset:35328
    s_add_u32 m0, s17, 66560
    s_mov_b32 s30, 811008
    buffer_load_dwordx4 v7, s[24:27], s30 offen lds
    v_mfma_f32_32x32x16_bf16 v[200:215], v[168:171], v[64:67], v[200:215]
    ds_read_b128 v[84:87], v145 offset:32768
    ds_read_b64_tr_b16 v[164:165], v148 offset:36864
    ds_read_b64_tr_b16 v[166:167], v148 offset:37376
    s_add_u32 m0, s17, 67584
    s_mov_b32 s30, 835584
    buffer_load_dwordx4 v7, s[24:27], s30 offen lds
    s_waitcnt lgkmcnt(9)
    v_mfma_f32_32x32x16_bf16 v[200:215], v[232:235], v[68:71], v[200:215]
    ds_read_b128 v[88:91], v146 offset:32768
    ds_read_b64_tr_b16 v[168:169], v148 offset:38912
    ds_read_b64_tr_b16 v[170:171], v148 offset:39424
    s_add_u32 m0, s17, 68608
    s_mov_b32 s30, 860160
    buffer_load_dwordx4 v7, s[24:27], s30 offen lds
    v_mfma_f32_32x32x16_bf16 v[200:215], v[236:239], v[72:75], v[200:215]
    ds_read_b128 v[92:95], v143 offset:40960
    ds_read_b64_tr_b16 v[232:233], v148 offset:40960
    ds_read_b64_tr_b16 v[234:235], v148 offset:41472
    s_add_u32 m0, s17, 69632
    s_mov_b32 s30, 884736
    buffer_load_dwordx4 v7, s[24:27], s30 offen lds
    s_waitcnt lgkmcnt(9)
    v_mfma_f32_32x32x16_bf16 v[200:215], v[240:243], v[76:79], v[200:215]
    ds_read_b128 v[96:99], v144 offset:40960
    ds_read_b64_tr_b16 v[236:237], v148 offset:43008
    ds_read_b64_tr_b16 v[238:239], v148 offset:43520
    s_add_u32 m0, s17, 70656
    s_mov_b32 s30, 909312
    buffer_load_dwordx4 v7, s[24:27], s30 offen lds
    v_mfma_f32_32x32x16_bf16 v[200:215], v[244:247], v[80:83], v[200:215]
    ds_read_b128 v[100:103], v145 offset:40960
    ds_read_b64_tr_b16 v[240:241], v148 offset:45056
    ds_read_b64_tr_b16 v[242:243], v148 offset:45568
    s_add_u32 m0, s17, 71680
    s_mov_b32 s30, 933888
    buffer_load_dwordx4 v7, s[24:27], s30 offen lds
    s_waitcnt lgkmcnt(9)
    v_mfma_f32_32x32x16_bf16 v[200:215], v[164:167], v[84:87], v[200:215]
    ds_read_b128 v[104:107], v146 offset:40960
    ds_read_b64_tr_b16 v[244:245], v148 offset:47104
    ds_read_b64_tr_b16 v[246:247], v148 offset:47616
    s_add_u32 m0, s17, 72704
    s_mov_b32 s30, 958464
    buffer_load_dwordx4 v7, s[24:27], s30 offen lds
    v_mfma_f32_32x32x16_bf16 v[200:215], v[168:171], v[88:91], v[200:215]
    ds_read_b128 v[108:111], v143 offset:49152
    ds_read_b64_tr_b16 v[164:165], v148 offset:49152
    ds_read_b64_tr_b16 v[166:167], v148 offset:49664
    s_waitcnt lgkmcnt(9)
    v_mfma_f32_32x32x16_bf16 v[200:215], v[232:235], v[92:95], v[200:215]
    ds_read_b128 v[112:115], v144 offset:49152
    ds_read_b64_tr_b16 v[168:169], v148 offset:51200
    ds_read_b64_tr_b16 v[170:171], v148 offset:51712
    v_mfma_f32_32x32x16_bf16 v[200:215], v[236:239], v[96:99], v[200:215]
    ds_read_b128 v[116:119], v145 offset:49152
    ds_read_b64_tr_b16 v[232:233], v148 offset:53248
    ds_read_b64_tr_b16 v[234:235], v148 offset:53760
    s_waitcnt lgkmcnt(9)
    v_mfma_f32_32x32x16_bf16 v[200:215], v[240:243], v[100:103], v[200:215]
    ds_read_b128 v[120:123], v146 offset:49152
    ds_read_b64_tr_b16 v[236:237], v148 offset:55296
    ds_read_b64_tr_b16 v[238:239], v148 offset:55808
    v_mfma_f32_32x32x16_bf16 v[200:215], v[244:247], v[104:107], v[200:215]
    ds_read_b128 v[124:127], v143 offset:57344
    ds_read_b64_tr_b16 v[240:241], v148 offset:57344
    ds_read_b64_tr_b16 v[242:243], v148 offset:57856
    s_waitcnt lgkmcnt(9)
    v_mfma_f32_32x32x16_bf16 v[200:215], v[164:167], v[108:111], v[200:215]
    ds_read_b128 v[128:131], v144 offset:57344
    ds_read_b64_tr_b16 v[244:245], v148 offset:59392
    ds_read_b64_tr_b16 v[246:247], v148 offset:59904
    v_mfma_f32_32x32x16_bf16 v[200:215], v[168:171], v[112:115], v[200:215]
    ds_read_b128 v[132:135], v145 offset:57344
    ds_read_b64_tr_b16 v[164:165], v148 offset:61440
    ds_read_b64_tr_b16 v[166:167], v148 offset:61952
    s_waitcnt lgkmcnt(9)
    v_mfma_f32_32x32x16_bf16 v[200:215], v[232:235], v[116:119], v[200:215]
    ds_read_b128 v[136:139], v146 offset:57344
    ds_read_b64_tr_b16 v[168:169], v148 offset:63488
    ds_read_b64_tr_b16 v[170:171], v148 offset:64000
    s_waitcnt vmcnt(8) lgkmcnt(0)
    s_barrier
    v_lshlrev_b32 v172, 4, v0
    ds_write_b128 v172, v[176:179]
    ds_write_b128 v172, v[180:183] offset:4096
    v_mfma_f32_32x32x16_bf16 v[200:215], v[236:239], v[120:123], v[200:215]
    ds_read_b64_tr_b16 v[232:233], v149 offset:0
    ds_read_b64_tr_b16 v[234:235], v149 offset:512
    s_add_u32 m0, s17, 98304
    s_mov_b32 s30, 2048
    buffer_load_dwordx4 v7, s[24:27], s30 offen lds
    s_waitcnt lgkmcnt(10)
    v_mfma_f32_32x32x16_bf16 v[200:215], v[240:243], v[124:127], v[200:215]
    ds_read_b64_tr_b16 v[236:237], v149 offset:2048
    ds_read_b64_tr_b16 v[238:239], v149 offset:2560
    s_add_u32 m0, s17, 99328
    s_mov_b32 s30, 26624
    buffer_load_dwordx4 v7, s[24:27], s30 offen lds
    v_mfma_f32_32x32x16_bf16 v[200:215], v[244:247], v[128:131], v[200:215]
    ds_read_b64_tr_b16 v[240:241], v149 offset:4096
    ds_read_b64_tr_b16 v[242:243], v149 offset:4608
    s_add_u32 m0, s17, 100352
    s_mov_b32 s30, 51200
    buffer_load_dwordx4 v7, s[24:27], s30 offen lds
    s_waitcnt lgkmcnt(6)
    v_mfma_f32_32x32x16_bf16 v[200:215], v[164:167], v[132:135], v[200:215]
    ds_read_b64_tr_b16 v[244:245], v149 offset:6144
    ds_read_b64_tr_b16 v[246:247], v149 offset:6656
    s_add_u32 m0, s17, 101376
    s_mov_b32 s30, 75776
    buffer_load_dwordx4 v7, s[24:27], s30 offen lds
    v_mfma_f32_32x32x16_bf16 v[200:215], v[168:171], v[136:139], v[200:215]
    ds_read_b64_tr_b16 v[164:165], v149 offset:8192
    ds_read_b64_tr_b16 v[166:167], v149 offset:8704
    s_add_u32 m0, s17, 102400
    s_mov_b32 s30, 100352
    buffer_load_dwordx4 v7, s[24:27], s30 offen lds
    s_waitcnt lgkmcnt(6)
    v_mfma_f32_32x32x16_bf16 v[216:231], v[232:235], v[12:15], 0
    ds_read_b64_tr_b16 v[168:169], v149 offset:10240
    ds_read_b64_tr_b16 v[170:171], v149 offset:10752
    s_add_u32 m0, s17, 103424
    s_mov_b32 s30, 124928
    buffer_load_dwordx4 v7, s[24:27], s30 offen lds
    v_mfma_f32_32x32x16_bf16 v[216:231], v[236:239], v[16:19], v[216:231]
    ds_read_b64_tr_b16 v[232:233], v149 offset:12288
    ds_read_b64_tr_b16 v[234:235], v149 offset:12800
    s_add_u32 m0, s17, 104448
    s_mov_b32 s30, 149504
    buffer_load_dwordx4 v7, s[24:27], s30 offen lds
    s_waitcnt lgkmcnt(6)
    v_mfma_f32_32x32x16_bf16 v[216:231], v[240:243], v[20:23], v[216:231]
    ds_read_b64_tr_b16 v[236:237], v149 offset:14336
    ds_read_b64_tr_b16 v[238:239], v149 offset:14848
    s_add_u32 m0, s17, 105472
    s_mov_b32 s30, 174080
    buffer_load_dwordx4 v7, s[24:27], s30 offen lds
    v_mfma_f32_32x32x16_bf16 v[216:231], v[244:247], v[24:27], v[216:231]
    ds_read_b64_tr_b16 v[240:241], v149 offset:16384
    ds_read_b64_tr_b16 v[242:243], v149 offset:16896
    s_add_u32 m0, s17, 32768
    s_mov_b32 s30, 788480
    buffer_load_dwordx4 v7, s[24:27], s30 offen lds
    s_waitcnt lgkmcnt(6)
    v_mfma_f32_32x32x16_bf16 v[216:231], v[164:167], v[28:31], v[216:231]
    ds_read_b64_tr_b16 v[244:245], v149 offset:18432
    ds_read_b64_tr_b16 v[246:247], v149 offset:18944
    s_add_u32 m0, s17, 33792
    s_mov_b32 s30, 813056
    buffer_load_dwordx4 v7, s[24:27], s30 offen lds
    v_mfma_f32_32x32x16_bf16 v[216:231], v[168:171], v[32:35], v[216:231]
    ds_read_b64_tr_b16 v[164:165], v149 offset:20480
    ds_read_b64_tr_b16 v[166:167], v149 offset:20992
    s_add_u32 m0, s17, 34816
    s_mov_b32 s30, 837632
    buffer_load_dwordx4 v7, s[24:27], s30 offen lds
    s_waitcnt lgkmcnt(6)
    v_mfma_f32_32x32x16_bf16 v[216:231], v[232:235], v[36:39], v[216:231]
    ds_read_b64_tr_b16 v[168:169], v149 offset:22528
    ds_read_b64_tr_b16 v[170:171], v149 offset:23040
    s_add_u32 m0, s17, 35840
    s_mov_b32 s30, 862208
    buffer_load_dwordx4 v7, s[24:27], s30 offen lds
    v_mfma_f32_32x32x16_bf16 v[216:231], v[236:239], v[40:43], v[216:231]
    ds_read_b64_tr_b16 v[232:233], v149 offset:24576
    ds_read_b64_tr_b16 v[234:235], v149 offset:25088
    s_add_u32 m0, s17, 36864
    s_mov_b32 s30, 886784
    buffer_load_dwordx4 v7, s[24:27], s30 offen lds
    s_waitcnt lgkmcnt(6)
    v_mfma_f32_32x32x16_bf16 v[216:231], v[240:243], v[44:47], v[216:231]
    ds_read_b64_tr_b16 v[236:237], v149 offset:26624
    ds_read_b64_tr_b16 v[238:239], v149 offset:27136
    s_add_u32 m0, s17, 37888
    s_mov_b32 s30, 911360
    buffer_load_dwordx4 v7, s[24:27], s30 offen lds
    v_mfma_f32_32x32x16_bf16 v[216:231], v[244:247], v[48:51], v[216:231]
    ds_read_b64_tr_b16 v[240:241], v149 offset:28672
    ds_read_b64_tr_b16 v[242:243], v149 offset:29184
    s_add_u32 m0, s17, 38912
    s_mov_b32 s30, 935936
    buffer_load_dwordx4 v7, s[24:27], s30 offen lds
    s_waitcnt lgkmcnt(6)
    v_mfma_f32_32x32x16_bf16 v[216:231], v[164:167], v[52:55], v[216:231]
    ds_read_b64_tr_b16 v[244:245], v149 offset:30720
    ds_read_b64_tr_b16 v[246:247], v149 offset:31232
    s_add_u32 m0, s17, 39936
    s_mov_b32 s30, 960512
    buffer_load_dwordx4 v7, s[24:27], s30 offen lds
    s_waitcnt vmcnt(16) lgkmcnt(0)
    s_barrier
    ds_read_b64_tr_b16 v[176:177], v173 offset:0
    ds_read_b64_tr_b16 v[178:179], v173 offset:1792
    ds_read_b64_tr_b16 v[180:181], v173 offset:128
    ds_read_b64_tr_b16 v[182:183], v173 offset:1920
    v_mfma_f32_32x32x16_bf16 v[216:231], v[168:171], v[56:59], v[216:231]
    ds_read_b64_tr_b16 v[164:165], v148 offset:0
    ds_read_b64_tr_b16 v[166:167], v148 offset:512
    v_cvt_pk_bf16_f32 v156, v200, v201
    v_cvt_pk_bf16_f32 v157, v202, v203
    v_cvt_pk_bf16_f32 v158, v204, v205
    s_waitcnt lgkmcnt(10)
    v_mfma_f32_32x32x16_bf16 v[216:231], v[232:235], v[60:63], v[216:231]
    ds_read_b64_tr_b16 v[168:169], v148 offset:2048
    ds_read_b64_tr_b16 v[170:171], v148 offset:2560
    v_cvt_pk_bf16_f32 v159, v206, v207
    v_cvt_pk_bf16_f32 v160, v208, v209
    v_cvt_pk_bf16_f32 v161, v210, v211
    v_mfma_f32_32x32x16_bf16 v[216:231], v[236:239], v[64:67], v[216:231]
    ds_read_b64_tr_b16 v[232:233], v148 offset:4096
    ds_read_b64_tr_b16 v[234:235], v148 offset:4608
    v_cvt_pk_bf16_f32 v162, v212, v213
    v_cvt_pk_bf16_f32 v163, v214, v215
    s_mov_b32 s31, 0x200000
    s_waitcnt lgkmcnt(6)
    v_mfma_f32_32x32x16_bf16 v[216:231], v[240:243], v[68:71], v[216:231]
    ds_read_b64_tr_b16 v[236:237], v148 offset:6144
    ds_read_b64_tr_b16 v[238:239], v148 offset:6656
    buffer_store_dwordx4 v[156:159], v150, s[40:43], s31 offen sc1
    s_add_u32 s31, s31, 0x10000
    buffer_store_dwordx4 v[160:163], v150, s[40:43], s31 offen sc1
    v_mfma_f32_32x32x16_bf16 v[216:231], v[244:247], v[72:75], v[216:231]
    ds_read_b64_tr_b16 v[240:241], v148 offset:8192
    ds_read_b64_tr_b16 v[242:243], v148 offset:8704
    v_mul_f32 v2, v200, v200
    v_mul_f32 v3, v208, v208
    v_fmac_f32 v2, v201, v201
    s_waitcnt lgkmcnt(6)
    v_mfma_f32_32x32x16_bf16 v[216:231], v[164:167], v[76:79], v[216:231]
    ds_read_b64_tr_b16 v[244:245], v148 offset:10240
    ds_read_b64_tr_b16 v[246:247], v148 offset:10752
    v_fmac_f32 v3, v209, v209
    v_fmac_f32 v2, v202, v202
    v_fmac_f32 v3, v210, v210
    v_mfma_f32_32x32x16_bf16 v[216:231], v[168:171], v[80:83], v[216:231]
    ds_read_b64_tr_b16 v[164:165], v148 offset:12288
    ds_read_b64_tr_b16 v[166:167], v148 offset:12800
    v_fmac_f32 v2, v203, v203
    v_fmac_f32 v3, v211, v211
    v_fmac_f32 v2, v204, v204
    s_waitcnt lgkmcnt(6)
    v_mfma_f32_32x32x16_bf16 v[216:231], v[232:235], v[84:87], v[216:231]
    ds_read_b64_tr_b16 v[168:169], v148 offset:14336
    ds_read_b64_tr_b16 v[170:171], v148 offset:14848
    v_fmac_f32 v3, v212, v212
    v_fmac_f32 v2, v205, v205
    v_fmac_f32 v3, v213, v213
    v_mfma_f32_32x32x16_bf16 v[216:231], v[236:239], v[88:91], v[216:231]
    ds_read_b64_tr_b16 v[232:233], v148 offset:16384
    ds_read_b64_tr_b16 v[234:235], v148 offset:16896
    v_fmac_f32 v2, v206, v206
    v_fmac_f32 v3, v214, v214
    v_fmac_f32 v2, v207, v207
    s_waitcnt lgkmcnt(6)
    v_mfma_f32_32x32x16_bf16 v[216:231], v[240:243], v[92:95], v[216:231]
    ds_read_b64_tr_b16 v[236:237], v148 offset:18432
    ds_read_b64_tr_b16 v[238:239], v148 offset:18944
    v_fmac_f32 v3, v215, v215
    s_nop 1
    v_permlane32_swap_b32 v2, v3
    v_add_f32 v2, v2, v3
    v_mfma_f32_32x32x16_bf16 v[216:231], v[244:247], v[96:99], v[216:231]
    ds_read_b64_tr_b16 v[240:241], v148 offset:20480
    ds_read_b64_tr_b16 v[242:243], v148 offset:20992
    v_max_f32_dpp v2, v2, v2 row_ror:8 row_mask:0xf bank_mask:0xf
    s_nop 1
    v_max_f32_dpp v2, v2, v2 row_ror:4 row_mask:0xf bank_mask:0xf
    s_nop 1
    v_max_f32_dpp v2, v2, v2 row_ror:2 row_mask:0xf bank_mask:0xf
    s_waitcnt lgkmcnt(6)
    v_mfma_f32_32x32x16_bf16 v[216:231], v[164:167], v[100:103], v[216:231]
    ds_read_b64_tr_b16 v[244:245], v148 offset:22528
    ds_read_b64_tr_b16 v[246:247], v148 offset:23040
    v_max_f32_dpp v2, v2, v2 row_ror:1 row_mask:0xf bank_mask:0xf
    s_mov_b32 exec_lo, 0x00010001
    s_mov_b32 exec_hi, 0x00010001
    buffer_store_dword v2, v151, s[40:43], s28 offen sc1
    s_mov_b64 exec, -1
    buffer_store_dwordx4 v[176:179], v174, s[40:43], s50 offen sc1
    v_mfma_f32_32x32x16_bf16 v[216:231], v[168:171], v[104:107], v[216:231]
    ds_read_b64_tr_b16 v[164:165], v148 offset:24576
    ds_read_b64_tr_b16 v[166:167], v148 offset:25088
    s_cmp_eq_u32 s14, 3
    s_cselect_b32 s50, 0x2000000, s50
    s_add_u32 s50, s50, 4096
    buffer_store_dwordx4 v[180:183], v174, s[40:43], s50 offen sc1
    s_waitcnt lgkmcnt(6)
    v_mfma_f32_32x32x16_bf16 v[216:231], v[232:235], v[108:111], v[216:231]
    ds_read_b64_tr_b16 v[168:169], v148 offset:26624
    ds_read_b64_tr_b16 v[170:171], v148 offset:27136
    v_mfma_f32_32x32x16_bf16 v[216:231], v[236:239], v[112:115], v[216:231]
    ds_read_b64_tr_b16 v[232:233], v148 offset:28672
    ds_read_b64_tr_b16 v[234:235], v148 offset:29184
    s_waitcnt lgkmcnt(6)
    v_mfma_f32_32x32x16_bf16 v[216:231], v[240:243], v[116:119], v[216:231]
    ds_read_b64_tr_b16 v[236:237], v148 offset:30720
    ds_read_b64_tr_b16 v[238:239], v148 offset:31232
    s_waitcnt vmcnt(13)
    s_barrier
    v_mfma_f32_32x32x16_bf16 v[216:231], v[244:247], v[120:123], v[216:231]
    ds_read_b64_tr_b16 v[240:241], v148 offset:32768
    ds_read_b64_tr_b16 v[242:243], v148 offset:33280
    v_mov_b32 v190, -1
    v_mov_b32 v191, -1
    v_lshlrev_b32 v172, 3, v0
    s_waitcnt lgkmcnt(6)
    v_mfma_f32_32x32x16_bf16 v[216:231], v[164:167], v[124:127], v[216:231]
    ds_read_b64_tr_b16 v[244:245], v148 offset:34816
    ds_read_b64_tr_b16 v[246:247], v148 offset:35328
    buffer_store_dwordx2 v[190:191], v172, s[40:43], s55 offen sc1
    v_mov_b32 v194, 0x3f803f80
    v_lshlrev_b32 v196, 2, v1
    v_mfma_f32_32x32x16_bf16 v[216:231], v[168:171], v[128:131], v[216:231]
    ds_read_b64_tr_b16 v[164:165], v148 offset:36864
    ds_read_b64_tr_b16 v[166:167], v148 offset:37376
    s_lshl_b32 s32, s2, 8
    s_add_u32 s32, s32, 0x680000
    s_cmp_eq_u32 s14, 0
    s_waitcnt lgkmcnt(6)
    v_mfma_f32_32x32x16_bf16 v[216:231], v[232:235], v[132:135], v[216:231]
    ds_read_b64_tr_b16 v[168:169], v148 offset:38912
    ds_read_b64_tr_b16 v[170:171], v148 offset:39424
    s_cselect_b32 s32, s32, 0x2000000
    buffer_store_dword v194, v196, s[40:43], s32 offen sc1
    s_sub_u32 s55, s55, 524288
    buffer_store_dwordx2 v[190:191], v172, s[40:43], s55 offen sc1
    v_mfma_f32_32x32x16_bf16 v[216:231], v[236:239], v[136:139], v[216:231]
    ds_read_b64_tr_b16 v[232:233], v148 offset:40960
    ds_read_b64_tr_b16 v[234:235], v148 offset:41472
    s_waitcnt lgkmcnt(6)
    v_mfma_f32_32x32x16_bf16 v[200:215], v[12:15], v[240:243], 0
    ds_read_b64_tr_b16 v[236:237], v148 offset:43008
    ds_read_b64_tr_b16 v[238:239], v148 offset:43520
    v_mfma_f32_32x32x16_bf16 v[200:215], v[16:19], v[244:247], v[200:215]
    ds_read_b64_tr_b16 v[240:241], v148 offset:45056
    ds_read_b64_tr_b16 v[242:243], v148 offset:45568
    s_waitcnt lgkmcnt(6)
    v_mfma_f32_32x32x16_bf16 v[200:215], v[20:23], v[164:167], v[200:215]
    ds_read_b64_tr_b16 v[244:245], v148 offset:47104
    ds_read_b64_tr_b16 v[246:247], v148 offset:47616
    v_mul_f32 v216, s36, v216
    v_mul_f32 v217, s36, v217
    v_mul_f32 v218, s36, v218
    v_mfma_f32_32x32x16_bf16 v[200:215], v[24:27], v[168:171], v[200:215]
    ds_read_b64_tr_b16 v[164:165], v148 offset:49152
    ds_read_b64_tr_b16 v[166:167], v148 offset:49664
    v_mul_f32 v219, s36, v219
    v_mul_f32 v220, s36, v220
    v_mul_f32 v221, s36, v221
    s_waitcnt lgkmcnt(6)
    v_mfma_f32_32x32x16_bf16 v[200:215], v[28:31], v[232:235], v[200:215]
    ds_read_b64_tr_b16 v[168:169], v148 offset:51200
    ds_read_b64_tr_b16 v[170:171], v148 offset:51712
    v_mul_f32 v222, s36, v222
    v_mul_f32 v223, s36, v223
    v_mul_f32 v224, s36, v224
    v_mfma_f32_32x32x16_bf16 v[200:215], v[32:35], v[236:239], v[200:215]
    ds_read_b64_tr_b16 v[232:233], v148 offset:53248
    ds_read_b64_tr_b16 v[234:235], v148 offset:53760
    v_mul_f32 v225, s36, v225
    v_mul_f32 v226, s36, v226
    v_mul_f32 v227, s36, v227
    s_waitcnt lgkmcnt(6)
    v_mfma_f32_32x32x16_bf16 v[200:215], v[36:39], v[240:243], v[200:215]
    ds_read_b64_tr_b16 v[236:237], v148 offset:55296
    ds_read_b64_tr_b16 v[238:239], v148 offset:55808
    v_mul_f32 v228, s36, v228
    v_mul_f32 v229, s36, v229
    v_mul_f32 v230, s36, v230
    v_mfma_f32_32x32x16_bf16 v[200:215], v[40:43], v[244:247], v[200:215]
    ds_read_b64_tr_b16 v[240:241], v148 offset:57344
    ds_read_b64_tr_b16 v[242:243], v148 offset:57856
    v_mul_f32 v231, s36, v231
    v_cvt_pk_bf16_f32 v156, v216, v217
    v_cvt_pk_bf16_f32 v157, v218, v219
    s_waitcnt lgkmcnt(6)
    v_mfma_f32_32x32x16_bf16 v[200:215], v[44:47], v[164:167], v[200:215]
    ds_read_b64_tr_b16 v[244:245], v148 offset:59392
    ds_read_b64_tr_b16 v[246:247], v148 offset:59904
    v_cvt_pk_bf16_f32 v158, v220, v221
    v_cvt_pk_bf16_f32 v159, v222, v223
    v_cvt_pk_bf16_f32 v160, v224, v225
    v_mfma_f32_32x32x16_bf16 v[200:215], v[48:51], v[168:171], v[200:215]
    ds_read_b64_tr_b16 v[164:165], v148 offset:61440
    ds_read_b64_tr_b16 v[166:167], v148 offset:61952
    v_cvt_pk_bf16_f32 v161, v226, v227
    v_cvt_pk_bf16_f32 v162, v228, v229
    v_cvt_pk_bf16_f32 v163, v230, v231
    s_waitcnt lgkmcnt(6)
    v_mfma_f32_32x32x16_bf16 v[200:215], v[52:55], v[232:235], v[200:215]
    ds_read_b64_tr_b16 v[168:169], v148 offset:63488
    ds_read_b64_tr_b16 v[170:171], v148 offset:64000
    s_mov_b32 s31, 0x0
    s_add_u32 s31, s31, s33
    buffer_store_dwordx4 v[156:159], v174, s[40:43], s31 offen sc1
    s_waitcnt vmcnt(9)
    s_barrier
    v_mfma_f32_32x32x16_bf16 v[200:215], v[56:59], v[236:239], v[200:215]
    ds_read_b64_tr_b16 v[232:233], v147 offset:32768
    ds_read_b64_tr_b16 v[234:235], v147 offset:33280
    buffer_store_dwordx4 v[160:163], v174, s[40:43], s31 offen offset:1024 sc1
    s_waitcnt lgkmcnt(6)
    v_mfma_f32_32x32x16_bf16 v[200:215], v[60:63], v[240:243], v[200:215]
    ds_read_b64_tr_b16 v[236:237], v147 offset:34816
    ds_read_b64_tr_b16 v[238:239], v147 offset:35328
    v_mfma_f32_32x32x16_bf16 v[200:215], v[64:67], v[244:247], v[200:215]
    ds_read_b64_tr_b16 v[240:241], v147 offset:36864
    ds_read_b64_tr_b16 v[242:243], v147 offset:37376
    s_waitcnt lgkmcnt(6)
    v_mfma_f32_32x32x16_bf16 v[200:215], v[68:71], v[164:167], v[200:215]
    ds_read_b64_tr_b16 v[244:245], v147 offset:38912
    ds_read_b64_tr_b16 v[246:247], v147 offset:39424
    v_mfma_f32_32x32x16_bf16 v[200:215], v[72:75], v[168:171], v[200:215]
    ds_read_b64_tr_b16 v[164:165], v147 offset:40960
    ds_read_b64_tr_b16 v[166:167], v147 offset:41472
    s_waitcnt lgkmcnt(6)
    v_mfma_f32_32x32x16_bf16 v[200:215], v[76:79], v[232:235], v[200:215]
    ds_read_b64_tr_b16 v[168:169], v147 offset:43008
    ds_read_b64_tr_b16 v[170:171], v147 offset:43520
    v_mfma_f32_32x32x16_bf16 v[200:215], v[80:83], v[236:239], v[200:215]
    ds_read_b64_tr_b16 v[232:233], v147 offset:45056
    ds_read_b64_tr_b16 v[234:235], v147 offset:45568
    s_waitcnt lgkmcnt(6)
    v_mfma_f32_32x32x16_bf16 v[200:215], v[84:87], v[240:243], v[200:215]
    ds_read_b64_tr_b16 v[236:237], v147 offset:47104
    ds_read_b64_tr_b16 v[238:239], v147 offset:47616
    v_mfma_f32_32x32x16_bf16 v[200:215], v[88:91], v[244:247], v[200:215]
    ds_read_b64_tr_b16 v[240:241], v147 offset:49152
    ds_read_b64_tr_b16 v[242:243], v147 offset:49664
    s_waitcnt lgkmcnt(6)
    v_mfma_f32_32x32x16_bf16 v[200:215], v[92:95], v[164:167], v[200:215]
    ds_read_b64_tr_b16 v[244:245], v147 offset:51200
    ds_read_b64_tr_b16 v[246:247], v147 offset:51712
    v_mfma_f32_32x32x16_bf16 v[200:215], v[96:99], v[168:171], v[200:215]
    ds_read_b64_tr_b16 v[164:165], v147 offset:53248
    ds_read_b64_tr_b16 v[166:167], v147 offset:53760
    s_waitcnt lgkmcnt(6)
    v_mfma_f32_32x32x16_bf16 v[200:215], v[100:103], v[232:235], v[200:215]
    ds_read_b64_tr_b16 v[168:169], v147 offset:55296
    ds_read_b64_tr_b16 v[170:171], v147 offset:55808
    v_mfma_f32_32x32x16_bf16 v[200:215], v[104:107], v[236:239], v[200:215]
    ds_read_b64_tr_b16 v[232:233], v147 offset:57344
    ds_read_b64_tr_b16 v[234:235], v147 offset:57856
    s_waitcnt lgkmcnt(6)
    v_mfma_f32_32x32x16_bf16 v[200:215], v[108:111], v[240:243], v[200:215]
    ds_read_b64_tr_b16 v[236:237], v147 offset:59392
    ds_read_b64_tr_b16 v[238:239], v147 offset:59904
    v_mfma_f32_32x32x16_bf16 v[200:215], v[112:115], v[244:247], v[200:215]
    ds_read_b64_tr_b16 v[240:241], v147 offset:61440
    ds_read_b64_tr_b16 v[242:243], v147 offset:61952
    s_waitcnt lgkmcnt(6)
    v_mfma_f32_32x32x16_bf16 v[200:215], v[116:119], v[164:167], v[200:215]
    ds_read_b64_tr_b16 v[244:245], v147 offset:63488
    ds_read_b64_tr_b16 v[246:247], v147 offset:64000
    v_mfma_f32_32x32x16_bf16 v[200:215], v[120:123], v[168:171], v[200:215]
    s_waitcnt lgkmcnt(4)
    v_mfma_f32_32x32x16_bf16 v[200:215], v[124:127], v[232:235], v[200:215]
    v_mfma_f32_32x32x16_bf16 v[200:215], v[128:131], v[236:239], v[200:215]
    s_waitcnt lgkmcnt(0)
    v_mfma_f32_32x32x16_bf16 v[200:215], v[132:135], v[240:243], v[200:215]
    v_mfma_f32_32x32x16_bf16 v[200:215], v[136:139], v[244:247], v[200:215]
    s_nop 11
    v_cvt_pk_bf16_f32 v156, v200, v201
    v_cvt_pk_bf16_f32 v157, v202, v203
    v_cvt_pk_bf16_f32 v158, v204, v205
    v_cvt_pk_bf16_f32 v159, v206, v207
    v_cvt_pk_bf16_f32 v160, v208, v209
    v_cvt_pk_bf16_f32 v161, v210, v211
    v_cvt_pk_bf16_f32 v162, v212, v213
    v_cvt_pk_bf16_f32 v163, v214, v215
    s_mov_b32 s31, 0x400000
    buffer_store_dwordx4 v[156:159], v152, s[40:43], s31 offen sc1
    buffer_store_dwordx4 v[160:163], v152, s[40:43], s31 offen offset:512 sc1
k1_qkv_kernel_end:
    s_endpgm
.section .rodata,"a"
.p2align 6
.amdhsa_kernel k1_qkv_kernel
  .amdhsa_next_free_vgpr 256
  .amdhsa_next_free_sgpr 102
  .amdhsa_accum_offset 256
  .amdhsa_group_segment_fixed_size 0
  .amdhsa_kernarg_size 88
  .amdhsa_user_sgpr_count 2
  .amdhsa_user_sgpr_kernarg_segment_ptr 1
  .amdhsa_system_sgpr_workgroup_id_x 1
.end_amdhsa_kernel
.text
.globl k2_main_kernel
.p2align 8
.type k2_main_kernel,@function
k2_main_kernel:
    s_cmp_ge_u32 s2, 256
    s_cbranch_scc1 k2_main_kernel_end
    s_mov_b32 s87, 1
    s_load_dwordx2 s[8:9], s[0:1], 80
    s_load_dwordx2 s[4:5], s[0:1], 0
    s_load_dwordx2 s[6:7], s[0:1], 16
    s_load_dwordx8 s[44:51], s[0:1], 32
    s_load_dwordx2 s[52:53], s[0:1], 64
    s_getpc_b64 s[88:89]
k2_main_kernel_ct:
    s_mov_b32 s90, k2_main_kernel_end-k2_main_kernel_ct
    s_mov_b32 s91, 0x00020000
    s_lshr_b32 s3, s2, 3
    s_mul_i32 s3, s3, 1536
    v_lshlrev_b32 v254, 7, v0
    v_cmp_gt_u32 vcc, 12, v0
    s_nop 0
    s_and_saveexec_b64 s[92:93], vcc
    s_cbranch_execz k2_main_kernel_ct2
    buffer_load_dword v255, v254, s[88:91], s3 offen
k2_main_kernel_ct2:
    s_mov_b64 exec, s[92:93]
    s_and_b32 s12, s2, 7
    s_lshr_b32 s13, s2, 3
    s_lshr_b32 s10, s12, 1
    s_lshl_b32 s10, s10, 3
    s_and_b32 s17, s13, 7
    s_add_u32 s10, s10, s17
    s_and_b32 s11, s12, 1
    s_lshl_b32 s11, s11, 2
    s_lshr_b32 s17, s13, 3
    s_add_u32 s11, s11, s17
    s_lshl_b32 s31, s17, 8
    s_lshl_b32 s3, s12, 2
    s_and_b32 s17, s13, 3
    s_add_u32 s3, s3, s17
    s_lshr_b32 s55, s13, 2
    s_lshl_b32 s12, s12, 2
    s_and_b32 s17, s13, 3
    s_add_u32 s12, s12, s17
    s_lshr_b32 s13, s2, 5
    v_and_b32 v1, 63, v0
    v_lshrrev_b32 v2, 6, v0
    s_nop 0
    v_readfirstlane_b32 s14, v2
    s_nop 0
    s_lshr_b32 s15, s14, 1
    s_and_b32 s16, s14, 1
    v_lshlrev_b32 v8, 4, v1
    v_lshrrev_b32 v9, 5, v1
    v_and_b32 v10, 31, v1
    v_and_b32 v11, 15, v1
    v_lshrrev_b32 v12, 4, v1
    v_lshlrev_b32 v3, 4, v11
    v_lshl_add_u32 v13, v9, 8, v3
    v_add_u32 v13, 0x200000, v13
    s_lshl_b32 s17, s13, 3
    s_lshl_b32 s28, s15, 2
    s_add_u32 s17, s17, s28
    s_lshl_b32 s18, s12, 16
    s_lshl_b32 s34, s17, 5
    s_add_u32 s34, s34, s12
    s_lshl_b32 s34, s34, 10
    s_add_u32 s34, s34, 0x0
    s_add_u32 s35, s34, 0x8000
    s_lshl_b32 s28, s16, 16
    v_xor_b32 v4, s28, v8
    v_xor_b32 v3, 0x10000, v4
    s_lshl_b32 s29, s16, 15
    s_add_u32 s29, s29, s18
    s_add_u32 s29, s29, 0x200000
    s_lshl_b32 s30, s12, 9
    s_add_u32 s30, s30, 0x600000
    v_lshlrev_b32 v2, 3, v1
    s_sub_u32 s32, 0x480000, s18
    v_mov_b32 v5, 0x40000000
    v_cmp_gt_u32 vcc, 16, v10
    s_nop 1
    v_cndmask_b32 v13, v5, v13, vcc
    v_and_b32 v5, 27, v1
    v_mov_b32 v6, s32
    v_cmp_eq_u32 vcc, 16, v5
    s_nop 1
    v_cndmask_b32 v13, v13, v6, vcc
    s_waitcnt lgkmcnt(0)
    s_mov_b32 s20, s8
    s_mov_b32 s21, s9
    s_mov_b32 s22, 0x2000000
    s_mov_b32 s23, 0x00020000
    buffer_load_dwordx4 v[24:27], v4, s[20:23], s34 offen sc1
    buffer_load_dwordx4 v[28:31], v4, s[20:23], s35 offen sc1
    buffer_load_dwordx4 v[32:35], v3, s[20:23], s34 offen sc1
    buffer_load_dwordx4 v[36:39], v3, s[20:23], s35 offen sc1
    buffer_load_dwordx2 v[20:21], v2, s[20:23], s30 offen sc1
    s_add_u32 s36, s29, 4096
    buffer_load_dwordx4 a[192:195], v8, s[20:23], s29 offen offset:0
    buffer_load_dwordx4 a[196:199], v8, s[20:23], s29 offen offset:1024
    buffer_load_dwordx4 a[208:211], v13, s[20:23], s29 offen offset:0
    buffer_load_dwordx4 a[224:227], v13, s[20:23], s29 offen offset:512
    buffer_load_dwordx4 a[212:215], v13, s[20:23], s29 offen offset:1024
    buffer_load_dwordx4 a[228:231], v13, s[20:23], s29 offen offset:1536
    s_mov_b32 s33, s29
    s_add_u32 s29, s29, 7168
    s_mov_b32 s24, s46
    s_mov_b32 s25, s47
    s_mov_b32 s26, 0x800000
    s_mov_b32 s27, 0x00020000
    v_add_u32 v2, 0, v12
    v_xor_b32 v2, v2, v11
    v_lshlrev_b32 v2, 4, v2
    v_lshl_add_u32 v2, v12, 12, v2
    v_add_u32 v15, 0, v2
    v_add_u32 v2, 4, v12
    v_xor_b32 v2, v2, v11
    v_lshlrev_b32 v2, 4, v2
    v_lshl_add_u32 v2, v12, 12, v2
    v_add_u32 v16, 15360, v2
    v_add_u32 v2, 8, v12
    v_xor_b32 v2, v2, v11
    v_lshlrev_b32 v2, 4, v2
    v_lshl_add_u32 v2, v12, 12, v2
    v_add_u32 v17, 30720, v2
    v_add_u32 v2, 12, v12
    v_xor_b32 v2, v2, v11
    v_lshlrev_b32 v2, 4, v2
    v_lshl_add_u32 v2, v12, 12, v2
    v_add_u32 v18, 46080, v2
    s_lshl_b32 s38, s10, 18
    s_lshl_b32 s28, s14, 10
    s_add_u32 s38, s38, s28
    s_lshl_b32 s28, s14, 16
    s_add_u32 s38, s38, s28
    s_and_b32 s86, s10, 4
    s_lshl_b32 s86, s86, 6
    s_xor_b32 s86, s86, s31
    s_add_u32 s38, s38, s86
    s_lshl_b32 s39, s14, 14
    v_lshrrev_b32 v2, 3, v1
    v_lshlrev_b32 v2, 10, v2
    v_and_b32 v3, 1, v12
    v_lshlrev_b32 v3, 2, v3
    v_xor_b32 v3, v3, v1
    v_and_b32 v3, 7, v3
    v_lshl_add_u32 v2, v3, 4, v2
    s_lshl_b32 s28, s55, 7
    v_add_u32 v19, s28, v2
    s_mov_b32 s56, s6
    s_mov_b32 s57, s7
    s_mov_b32 s58, 0x80000
    s_mov_b32 s59, 0x00020000
    s_lshl_b32 s42, s14, 14
    s_add_u32 s42, s42, 69632
    s_lshl_b32 s41, s14, 17
    s_lshl_b32 s28, s31, 8
    s_xor_b32 s41, s41, s28
    v_mov_b32 v22, 0
    v_mov_b32 v23, 0
    v_mov_b32 v112, 0
    v_mov_b32 v113, 0
    s_waitcnt vmcnt(6)
    v_max_f32 v20, v20, v21
    s_nop 1
    v_max_f32_dpp v20, v20, v20 row_ror:8 row_mask:0xf bank_mask:0xf
    s_nop 1
    v_max_f32_dpp v20, v20, v20 row_ror:4 row_mask:0xf bank_mask:0xf
    s_nop 1
    v_max_f32_dpp v20, v20, v20 row_ror:2 row_mask:0xf bank_mask:0xf
    s_nop 1
    v_max_f32_dpp v20, v20, v20 row_ror:1 row_mask:0xf bank_mask:0xf
    v_dot2_f32_bf16 v22, v24, v24, v22
    v_dot2_f32_bf16 v23, v28, v28, v23
    v_dot2_f32_bf16 v112, v32, v32, v112
    v_dot2_f32_bf16 v113, v36, v36, v113
    v_dot2_f32_bf16 v22, v25, v25, v22
    v_dot2_f32_bf16 v23, v29, v29, v23
    v_dot2_f32_bf16 v112, v33, v33, v112
    v_dot2_f32_bf16 v113, v37, v37, v113
    v_dot2_f32_bf16 v22, v26, v26, v22
    v_dot2_f32_bf16 v23, v30, v30, v23
    v_dot2_f32_bf16 v112, v34, v34, v112
    v_dot2_f32_bf16 v113, v38, v38, v113
    v_dot2_f32_bf16 v22, v27, v27, v22
    v_dot2_f32_bf16 v23, v31, v31, v23
    v_dot2_f32_bf16 v112, v35, v35, v112
    v_dot2_f32_bf16 v113, v39, v39, v113
    v_readlane_b32 s34, v20, 0
    v_readlane_b32 s35, v20, 16
    v_readlane_b32 s40, v20, 32
    v_readlane_b32 s37, v20, 48
    s_max_u32 s34, s34, s35
    s_max_u32 s40, s40, s37
    s_max_u32 s34, s34, s40
    v_mov_b32 v2, v22
    s_nop 1
    v_permlane32_swap_b32 v22, v2
    v_add_f32 v22, v22, v2
    v_mul_f32 v22, s34, v22
    v_sqrt_f32 v22, v22
    v_mov_b32 v2, v23
    s_nop 1
    v_permlane32_swap_b32 v23, v2
    v_add_f32 v23, v23, v2
    v_mul_f32 v23, s34, v23
    v_sqrt_f32 v23, v23
    v_mov_b32 v2, v112
    s_nop 1
    v_permlane32_swap_b32 v112, v2
    v_add_f32 v112, v112, v2
    v_mul_f32 v112, s34, v112
    v_sqrt_f32 v112, v112
    v_mov_b32 v2, v113
    s_nop 1
    v_permlane32_swap_b32 v113, v2
    v_add_f32 v113, v113, v2
    v_mul_f32 v113, s34, v113
    v_sqrt_f32 v113, v113
    v_max3_f32 v2, v22, v23, v112
    v_max_f32 v2, v2, v113
    v_add_f32 v3, v22, v23
    v_add_f32 v4, v112, v113
    v_add_f32 v3, v3, v4
    v_mov_b32 v4, 0x42200000
    v_cmp_nle_f32 vcc, v2, v4
    v_cmp_u_f32 s[34:35], v3, v3
    s_nop 0
    s_or_b64 vcc, vcc, s[34:35]
    s_cbranch_vccnz k2_main_kernel_slow
k2_main_kernel_fast:
    v_sub_f32 v192, 0, v22
    v_sub_f32 v193, 0, v22
    v_sub_f32 v208, 0, v23
    v_sub_f32 v209, 0, v23
    v_sub_f32 v224, 0, v112
    v_sub_f32 v225, 0, v112
    v_sub_f32 v240, 0, v113
    v_sub_f32 v241, 0, v113
    v_mov_b64 v[194:195], v[192:193]
    v_mov_b64 v[196:197], v[192:193]
    v_mov_b64 v[198:199], v[192:193]
    v_mov_b64 v[200:201], v[192:193]
    v_mov_b64 v[202:203], v[192:193]
    v_mov_b64 v[204:205], v[192:193]
    v_mov_b64 v[206:207], v[192:193]
    v_mov_b64 v[210:211], v[208:209]
    v_mov_b64 v[212:213], v[208:209]
    v_mov_b64 v[214:215], v[208:209]
    v_mov_b64 v[216:217], v[208:209]
    v_mov_b64 v[218:219], v[208:209]
    v_mov_b64 v[220:221], v[208:209]
    v_mov_b64 v[222:223], v[208:209]
    v_mov_b64 v[226:227], v[224:225]
    v_mov_b64 v[228:229], v[224:225]
    v_mov_b64 v[230:231], v[224:225]
    v_mov_b64 v[232:233], v[224:225]
    v_mov_b64 v[234:235], v[224:225]
    v_mov_b64 v[236:237], v[224:225]
    v_mov_b64 v[238:239], v[224:225]
    v_mov_b64 v[242:243], v[240:241]
    v_mov_b64 v[244:245], v[240:241]
    v_mov_b64 v[246:247], v[240:241]
    v_mov_b64 v[248:249], v[240:241]
    v_mov_b64 v[250:251], v[240:241]
    v_mov_b64 v[252:253], v[240:241]
    v_mov_b64 v[254:255], v[240:241]
    s_waitcnt vmcnt(5)
    v_mfma_f32_32x32x16_bf16 v[96:111], a[192:195], v[24:27], v[192:207]
    s_lshr_b32 s35, s2, 3
    s_lshl_b32 s35, s35, 2
    s_add_u32 s35, s35, s14
    s_nop 7
    v_mfma_f32_32x32x16_bf16 v[112:127], a[192:195], v[28:31], v[208:223]
    buffer_load_dwordx4 a[200:203], v8, s[20:23], s33 offen offset:2048
    buffer_load_dwordx4 a[216:219], v13, s[20:23], s33 offen offset:2048
    buffer_load_dwordx4 a[232:235], v13, s[20:23], s33 offen offset:2560
    v_exp_f32 v96, v96
    v_exp_f32 v97, v97
    v_exp_f32 v98, v98
    v_cvt_pk_bf16_f32 v88, v96, v97
    v_exp_f32 v99, v99
    v_exp_f32 v100, v100
    v_cvt_pk_bf16_f32 v89, v98, v99
    v_exp_f32 v101, v101
    v_exp_f32 v102, v102
    v_cvt_pk_bf16_f32 v90, v100, v101
    v_exp_f32 v103, v103
    v_exp_f32 v104, v104
    v_cvt_pk_bf16_f32 v91, v102, v103
    v_exp_f32 v105, v105
    v_exp_f32 v106, v106
    s_waitcnt vmcnt(5)
    v_mfma_f32_32x32x16_bf16 v[128:143], a[208:211], v[88:91], 0
    v_xor_b32 v20, v12, v11
    v_lshlrev_b32 v20, 4, v20
    v_cvt_pk_bf16_f32 v92, v104, v105
    v_exp_f32 v107, v107
    v_exp_f32 v108, v108
    v_cvt_pk_bf16_f32 v93, v106, v107
    v_exp_f32 v109, v109
    v_exp_f32 v110, v110
    v_exp_f32 v111, v111
    v_cvt_pk_bf16_f32 v94, v108, v109
    v_cvt_pk_bf16_f32 v95, v110, v111
    v_mfma_f32_32x32x16_bf16 v[96:111], a[192:195], v[32:35], v[224:239]
    buffer_load_dwordx4 a[204:207], v8, s[20:23], s33 offen offset:3072
    buffer_load_dwordx4 a[220:223], v13, s[20:23], s33 offen offset:3072
    buffer_load_dwordx4 a[236:239], v13, s[20:23], s33 offen offset:3584
    v_exp_f32 v112, v112
    v_exp_f32 v113, v113
    v_exp_f32 v114, v114
    v_mfma_f32_32x32x16_bf16 v[128:143], a[224:227], v[92:95], v[128:143]
    buffer_load_dwordx4 v[52:55], v8, s[20:23], s29 offen offset:0
    buffer_load_dwordx4 v[68:71], v13, s[20:23], s29 offen offset:0
    buffer_load_dwordx4 v[84:87], v13, s[20:23], s29 offen offset:512
    v_cvt_pk_bf16_f32 v88, v112, v113
    v_exp_f32 v115, v115
    v_exp_f32 v116, v116
    v_cvt_pk_bf16_f32 v89, v114, v115
    v_exp_f32 v117, v117
    v_exp_f32 v118, v118
    v_cvt_pk_bf16_f32 v90, v116, v117
    v_exp_f32 v119, v119
    v_exp_f32 v120, v120
    v_cvt_pk_bf16_f32 v91, v118, v119
    v_exp_f32 v121, v121
    v_exp_f32 v122, v122
    v_mfma_f32_32x32x16_bf16 v[144:159], a[208:211], v[88:91], 0
    v_lshl_add_u32 v20, v11, 8, v20
    v_add_u32 v20, s39, v20
    v_cvt_pk_bf16_f32 v92, v120, v121
    v_exp_f32 v123, v123
    v_exp_f32 v124, v124
    v_cvt_pk_bf16_f32 v93, v122, v123
    v_exp_f32 v125, v125
    v_exp_f32 v126, v126
    v_exp_f32 v127, v127
    v_cvt_pk_bf16_f32 v94, v124, v125
    v_cvt_pk_bf16_f32 v95, v126, v127
    v_mfma_f32_32x32x16_bf16 v[112:127], a[192:195], v[36:39], v[240:255]
    buffer_load_dwordx4 v[40:43], v8, s[20:23], s36 offen offset:0
    buffer_load_dwordx4 v[56:59], v13, s[20:23], s36 offen offset:0
    buffer_load_dwordx4 v[72:75], v13, s[20:23], s36 offen offset:512
    v_exp_f32 v96, v96
    v_exp_f32 v97, v97
    v_exp_f32 v98, v98
    v_mfma_f32_32x32x16_bf16 v[144:159], a[224:227], v[92:95], v[144:159]
    s_and_b32 s54, s10, 3
    v_cvt_pk_bf16_f32 v88, v96, v97
    v_exp_f32 v99, v99
    v_exp_f32 v100, v100
    v_cvt_pk_bf16_f32 v89, v98, v99
    v_exp_f32 v101, v101
    v_exp_f32 v102, v102
    v_cvt_pk_bf16_f32 v90, v100, v101
    v_exp_f32 v103, v103
    v_exp_f32 v104, v104
    v_cvt_pk_bf16_f32 v91, v102, v103
    v_exp_f32 v105, v105
    v_exp_f32 v106, v106
    v_mfma_f32_32x32x16_bf16 v[160:175], a[208:211], v[88:91], 0
    s_waitcnt vmcnt(12)
    v_cvt_pk_bf16_f32 v92, v104, v105
    v_exp_f32 v107, v107
    v_exp_f32 v108, v108
    v_cvt_pk_bf16_f32 v93, v106, v107
    v_exp_f32 v109, v109
    v_exp_f32 v110, v110
    v_exp_f32 v111, v111
    v_cvt_pk_bf16_f32 v94, v108, v109
    v_cvt_pk_bf16_f32 v95, v110, v111
    v_mfma_f32_32x32x16_bf16 v[96:111], a[196:199], v[24:27], v[192:207]
    buffer_load_dwordx4 v[44:47], v8, s[20:23], s36 offen offset:1024
    buffer_load_dwordx4 v[60:63], v13, s[20:23], s36 offen offset:1024
    buffer_load_dwordx4 v[76:79], v13, s[20:23], s36 offen offset:1536
    v_exp_f32 v112, v112
    v_exp_f32 v113, v113
    v_exp_f32 v114, v114
    v_mfma_f32_32x32x16_bf16 v[160:175], a[224:227], v[92:95], v[160:175]
    s_lshl_b32 s54, s54, 6
    v_cvt_pk_bf16_f32 v88, v112, v113
    v_exp_f32 v115, v115
    v_exp_f32 v116, v116
    v_cvt_pk_bf16_f32 v89, v114, v115
    v_exp_f32 v117, v117
    v_exp_f32 v118, v118
    v_cvt_pk_bf16_f32 v90, v116, v117
    v_exp_f32 v119, v119
    v_exp_f32 v120, v120
    v_cvt_pk_bf16_f32 v91, v118, v119
    v_exp_f32 v121, v121
    v_exp_f32 v122, v122
    v_mfma_f32_32x32x16_bf16 v[176:191], a[208:211], v[88:91], 0
    v_xor_b32 v20, s54, v20
    v_cvt_pk_bf16_f32 v92, v120, v121
    v_exp_f32 v123, v123
    v_exp_f32 v124, v124
    v_cvt_pk_bf16_f32 v93, v122, v123
    v_exp_f32 v125, v125
    v_exp_f32 v126, v126
    v_exp_f32 v127, v127
    v_cvt_pk_bf16_f32 v94, v124, v125
    v_cvt_pk_bf16_f32 v95, v126, v127
    v_mfma_f32_32x32x16_bf16 v[112:127], a[196:199], v[28:31], v[208:223]
    buffer_load_dwordx4 v[48:51], v8, s[20:23], s36 offen offset:2048
    buffer_load_dwordx4 v[64:67], v13, s[20:23], s36 offen offset:2048
    buffer_load_dwordx4 v[80:83], v13, s[20:23], s36 offen offset:2560
    v_exp_f32 v96, v96
    v_exp_f32 v97, v97
    v_exp_f32 v98, v98
    v_mfma_f32_32x32x16_bf16 v[176:191], a[224:227], v[92:95], v[176:191]
    v_xor_b32 v21, 64, v20
    v_cvt_pk_bf16_f32 v88, v96, v97
    v_exp_f32 v99, v99
    v_exp_f32 v100, v100
    v_cvt_pk_bf16_f32 v89, v98, v99
    v_exp_f32 v101, v101
    v_exp_f32 v102, v102
    v_cvt_pk_bf16_f32 v90, v100, v101
    v_exp_f32 v103, v103
    v_exp_f32 v104, v104
    v_cvt_pk_bf16_f32 v91, v102, v103
    v_exp_f32 v105, v105
    v_exp_f32 v106, v106
    v_mfma_f32_32x32x16_bf16 v[128:143], a[212:215], v[88:91], v[128:143]
    v_xor_b32 v22, 128, v20
    v_cvt_pk_bf16_f32 v92, v104, v105
    v_exp_f32 v107, v107
    v_exp_f32 v108, v108
    v_cvt_pk_bf16_f32 v93, v106, v107
    v_exp_f32 v109, v109
    v_exp_f32 v110, v110
    v_exp_f32 v111, v111
    v_cvt_pk_bf16_f32 v94, v108, v109
    v_cvt_pk_bf16_f32 v95, v110, v111
    v_mfma_f32_32x32x16_bf16 v[96:111], a[196:199], v[32:35], v[224:239]
    v_xor_b32 v23, 192, v20
    v_exp_f32 v112, v112
    v_exp_f32 v113, v113
    v_exp_f32 v114, v114
    v_mfma_f32_32x32x16_bf16 v[128:143], a[228:231], v[92:95], v[128:143]
    buffer_load_dwordx4 a[192:195], v8, s[20:23], s29 offen offset:1024
    buffer_load_dwordx4 a[208:211], v13, s[20:23], s29 offen offset:1024
    buffer_load_dwordx4 a[224:227], v13, s[20:23], s29 offen offset:1536
    v_cvt_pk_bf16_f32 v88, v112, v113
    v_exp_f32 v115, v115
    v_exp_f32 v116, v116
    v_cvt_pk_bf16_f32 v89, v114, v115
    v_exp_f32 v117, v117
    v_exp_f32 v118, v118
    v_cvt_pk_bf16_f32 v90, v116, v117
    v_exp_f32 v119, v119
    v_exp_f32 v120, v120
    v_cvt_pk_bf16_f32 v91, v118, v119
    v_exp_f32 v121, v121
    v_exp_f32 v122, v122
    v_mfma_f32_32x32x16_bf16 v[144:159], a[212:215], v[88:91], v[144:159]
    v_cvt_pk_bf16_f32 v92, v120, v121
    v_exp_f32 v123, v123
    v_exp_f32 v124, v124
    v_cvt_pk_bf16_f32 v93, v122, v123
    v_exp_f32 v125, v125
    v_exp_f32 v126, v126
    v_exp_f32 v127, v127
    v_cvt_pk_bf16_f32 v94, v124, v125
    v_cvt_pk_bf16_f32 v95, v126, v127
    v_mfma_f32_32x32x16_bf16 v[112:127], a[196:199], v[36:39], v[240:255]
    s_xor_b32 s37, s38, 0
    v_exp_f32 v96, v96
    v_exp_f32 v97, v97
    v_exp_f32 v98, v98
    v_mfma_f32_32x32x16_bf16 v[144:159], a[228:231], v[92:95], v[144:159]
    s_add_u32 m0, s39, 0
    v_cvt_pk_bf16_f32 v88, v96, v97
    v_exp_f32 v99, v99
    v_exp_f32 v100, v100
    v_cvt_pk_bf16_f32 v89, v98, v99
    v_exp_f32 v101, v101
    v_exp_f32 v102, v102
    v_cvt_pk_bf16_f32 v90, v100, v101
    v_exp_f32 v103, v103
    v_exp_f32 v104, v104
    v_cvt_pk_bf16_f32 v91, v102, v103
    v_exp_f32 v105, v105
    v_exp_f32 v106, v106
    v_mfma_f32_32x32x16_bf16 v[160:175], a[212:215], v[88:91], v[160:175]
    s_waitcnt vmcnt(18)
    v_cvt_pk_bf16_f32 v92, v104, v105
    v_exp_f32 v107, v107
    v_exp_f32 v108, v108
    v_cvt_pk_bf16_f32 v93, v106, v107
    v_exp_f32 v109, v109
    v_exp_f32 v110, v110
    v_exp_f32 v111, v111
    v_cvt_pk_bf16_f32 v94, v108, v109
    v_cvt_pk_bf16_f32 v95, v110, v111
    v_mfma_f32_32x32x16_bf16 v[96:111], a[200:203], v[24:27], v[192:207]
    buffer_load_dwordx4 v15, s[24:27], s37 offen offset:0 lds
    buffer_load_dwordx4 v16, s[24:27], s37 offen offset:1024 lds
    buffer_load_dwordx4 v17, s[24:27], s37 offen offset:2048 lds
    buffer_load_dwordx4 v18, s[24:27], s37 offen offset:3072 lds
    v_exp_f32 v112, v112
    v_exp_f32 v113, v113
    v_exp_f32 v114, v114
    v_mfma_f32_32x32x16_bf16 v[160:175], a[228:231], v[92:95], v[160:175]
    v_cvt_pk_bf16_f32 v88, v112, v113
    v_exp_f32 v115, v115
    v_exp_f32 v116, v116
    v_cvt_pk_bf16_f32 v89, v114, v115
    v_exp_f32 v117, v117
    v_exp_f32 v118, v118
    v_cvt_pk_bf16_f32 v90, v116, v117
    v_exp_f32 v119, v119
    v_exp_f32 v120, v120
    v_cvt_pk_bf16_f32 v91, v118, v119
    v_exp_f32 v121, v121
    v_exp_f32 v122, v122
    v_mfma_f32_32x32x16_bf16 v[176:191], a[212:215], v[88:91], v[176:191]
    v_cvt_pk_bf16_f32 v92, v120, v121
    v_exp_f32 v123, v123
    v_exp_f32 v124, v124
    v_cvt_pk_bf16_f32 v93, v122, v123
    v_exp_f32 v125, v125
    v_exp_f32 v126, v126
    v_exp_f32 v127, v127
    v_cvt_pk_bf16_f32 v94, v124, v125
    v_cvt_pk_bf16_f32 v95, v126, v127
    v_mfma_f32_32x32x16_bf16 v[112:127], a[200:203], v[28:31], v[208:223]
    v_exp_f32 v96, v96
    v_exp_f32 v97, v97
    v_exp_f32 v98, v98
    v_mfma_f32_32x32x16_bf16 v[176:191], a[228:231], v[92:95], v[176:191]
    v_cvt_pk_bf16_f32 v88, v96, v97
    v_exp_f32 v99, v99
    v_exp_f32 v100, v100
    v_cvt_pk_bf16_f32 v89, v98, v99
    v_exp_f32 v101, v101
    v_exp_f32 v102, v102
    v_cvt_pk_bf16_f32 v90, v100, v101
    v_exp_f32 v103, v103
    v_exp_f32 v104, v104
    v_cvt_pk_bf16_f32 v91, v102, v103
    v_exp_f32 v105, v105
    v_exp_f32 v106, v106
    v_mfma_f32_32x32x16_bf16 v[128:143], a[216:219], v[88:91], v[128:143]
    v_cvt_pk_bf16_f32 v92, v104, v105
    v_exp_f32 v107, v107
    v_exp_f32 v108, v108
    v_cvt_pk_bf16_f32 v93, v106, v107
    v_exp_f32 v109, v109
    v_exp_f32 v110, v110
    v_exp_f32 v111, v111
    v_cvt_pk_bf16_f32 v94, v108, v109
    v_cvt_pk_bf16_f32 v95, v110, v111
    v_mfma_f32_32x32x16_bf16 v[96:111], a[200:203], v[32:35], v[224:239]
    v_exp_f32 v112, v112
    v_exp_f32 v113, v113
    v_exp_f32 v114, v114
    v_mfma_f32_32x32x16_bf16 v[128:143], a[232:235], v[92:95], v[128:143]
    buffer_load_dwordx4 a[196:199], v8, s[20:23], s29 offen offset:2048
    buffer_load_dwordx4 a[212:215], v13, s[20:23], s29 offen offset:2048
    buffer_load_dwordx4 a[228:231], v13, s[20:23], s29 offen offset:2560
    v_cvt_pk_bf16_f32 v88, v112, v113
    v_exp_f32 v115, v115
    v_exp_f32 v116, v116
    v_cvt_pk_bf16_f32 v89, v114, v115
    v_exp_f32 v117, v117
    v_exp_f32 v118, v118
    v_cvt_pk_bf16_f32 v90, v116, v117
    v_exp_f32 v119, v119
    v_exp_f32 v120, v120
    v_cvt_pk_bf16_f32 v91, v118, v119
    v_exp_f32 v121, v121
    v_exp_f32 v122, v122
    v_mfma_f32_32x32x16_bf16 v[144:159], a[216:219], v[88:91], v[144:159]
    s_add_u32 m0, s42, 0
    v_cvt_pk_bf16_f32 v92, v120, v121
    v_exp_f32 v123, v123
    v_exp_f32 v124, v124
    v_cvt_pk_bf16_f32 v93, v122, v123
    v_exp_f32 v125, v125
    v_exp_f32 v126, v126
    v_exp_f32 v127, v127
    v_cvt_pk_bf16_f32 v94, v124, v125
    v_cvt_pk_bf16_f32 v95, v126, v127
    v_mfma_f32_32x32x16_bf16 v[112:127], a[200:203], v[36:39], v[240:255]
    s_xor_b32 s28, s41, 0
    v_exp_f32 v96, v96
    v_exp_f32 v97, v97
    v_exp_f32 v98, v98
    v_mfma_f32_32x32x16_bf16 v[144:159], a[232:235], v[92:95], v[144:159]
    buffer_load_dwordx4 v19, s[56:59], s28 offen lds
    v_cvt_pk_bf16_f32 v88, v96, v97
    v_exp_f32 v99, v99
    v_exp_f32 v100, v100
    v_cvt_pk_bf16_f32 v89, v98, v99
    v_exp_f32 v101, v101
    v_exp_f32 v102, v102
    v_cvt_pk_bf16_f32 v90, v100, v101
    v_exp_f32 v103, v103
    v_exp_f32 v104, v104
    v_cvt_pk_bf16_f32 v91, v102, v103
    v_exp_f32 v105, v105
    v_exp_f32 v106, v106
    v_mfma_f32_32x32x16_bf16 v[160:175], a[216:219], v[88:91], v[160:175]
    s_waitcnt vmcnt(23)
    v_cvt_pk_bf16_f32 v92, v104, v105
    v_exp_f32 v107, v107
    v_exp_f32 v108, v108
    v_cvt_pk_bf16_f32 v93, v106, v107
    v_exp_f32 v109, v109
    v_exp_f32 v110, v110
    v_exp_f32 v111, v111
    v_cvt_pk_bf16_f32 v94, v108, v109
    v_cvt_pk_bf16_f32 v95, v110, v111
    v_mfma_f32_32x32x16_bf16 v[96:111], a[204:207], v[24:27], v[192:207]
    v_exp_f32 v112, v112
    v_exp_f32 v113, v113
    v_exp_f32 v114, v114
    v_mfma_f32_32x32x16_bf16 v[160:175], a[232:235], v[92:95], v[160:175]
    v_cvt_pk_bf16_f32 v88, v112, v113
    v_exp_f32 v115, v115
    v_exp_f32 v116, v116
    v_cvt_pk_bf16_f32 v89, v114, v115
    v_exp_f32 v117, v117
    v_exp_f32 v118, v118
    v_cvt_pk_bf16_f32 v90, v116, v117
    v_exp_f32 v119, v119
    v_exp_f32 v120, v120
    v_cvt_pk_bf16_f32 v91, v118, v119
    v_exp_f32 v121, v121
    v_exp_f32 v122, v122
    v_mfma_f32_32x32x16_bf16 v[176:191], a[216:219], v[88:91], v[176:191]
    v_cvt_pk_bf16_f32 v92, v120, v121
    v_exp_f32 v123, v123
    v_exp_f32 v124, v124
    v_cvt_pk_bf16_f32 v93, v122, v123
    v_exp_f32 v125, v125
    v_exp_f32 v126, v126
    v_exp_f32 v127, v127
    v_cvt_pk_bf16_f32 v94, v124, v125
    v_cvt_pk_bf16_f32 v95, v126, v127
    v_mfma_f32_32x32x16_bf16 v[112:127], a[204:207], v[28:31], v[208:223]
    s_xor_b32 s37, s38, 65792
    v_exp_f32 v96, v96
    v_exp_f32 v97, v97
    v_exp_f32 v98, v98
    v_mfma_f32_32x32x16_bf16 v[176:191], a[232:235], v[92:95], v[176:191]
    s_add_u32 m0, s39, 4096
    v_cvt_pk_bf16_f32 v88, v96, v97
    v_exp_f32 v99, v99
    v_exp_f32 v100, v100
    v_cvt_pk_bf16_f32 v89, v98, v99
    v_exp_f32 v101, v101
    v_exp_f32 v102, v102
    v_cvt_pk_bf16_f32 v90, v100, v101
    v_exp_f32 v103, v103
    v_exp_f32 v104, v104
    v_cvt_pk_bf16_f32 v91, v102, v103
    v_exp_f32 v105, v105
    v_exp_f32 v106, v106
    v_mfma_f32_32x32x16_bf16 v[128:143], a[220:223], v[88:91], v[128:143]
    buffer_load_dwordx4 v15, s[24:27], s37 offen offset:0 lds
    buffer_load_dwordx4 v16, s[24:27], s37 offen offset:1024 lds
    buffer_load_dwordx4 v17, s[24:27], s37 offen offset:2048 lds
    buffer_load_dwordx4 v18, s[24:27], s37 offen offset:3072 lds
    v_cvt_pk_bf16_f32 v92, v104, v105
    v_exp_f32 v107, v107
    v_exp_f32 v108, v108
    v_cvt_pk_bf16_f32 v93, v106, v107
    v_exp_f32 v109, v109
    v_exp_f32 v110, v110
    v_exp_f32 v111, v111
    v_cvt_pk_bf16_f32 v94, v108, v109
    v_cvt_pk_bf16_f32 v95, v110, v111
    v_mfma_f32_32x32x16_bf16 v[96:111], a[204:207], v[32:35], v[224:239]
    v_exp_f32 v112, v112
    v_exp_f32 v113, v113
    v_exp_f32 v114, v114
    v_mfma_f32_32x32x16_bf16 v[128:143], a[236:239], v[92:95], v[128:143]
    buffer_load_dwordx4 a[200:203], v8, s[20:23], s29 offen offset:3072
    buffer_load_dwordx4 a[216:219], v13, s[20:23], s29 offen offset:3072
    buffer_load_dwordx4 a[232:235], v13, s[20:23], s29 offen offset:3584
    v_cvt_pk_bf16_f32 v88, v112, v113
    v_exp_f32 v115, v115
    v_exp_f32 v116, v116
    v_cvt_pk_bf16_f32 v89, v114, v115
    v_exp_f32 v117, v117
    v_exp_f32 v118, v118
    v_cvt_pk_bf16_f32 v90, v116, v117
    v_exp_f32 v119, v119
    v_exp_f32 v120, v120
    v_cvt_pk_bf16_f32 v91, v118, v119
    v_exp_f32 v121, v121
    v_exp_f32 v122, v122
    v_mfma_f32_32x32x16_bf16 v[144:159], a[220:223], v[88:91], v[144:159]
    s_add_u32 s29, s29, 4096
    v_cvt_pk_bf16_f32 v92, v120, v121
    v_exp_f32 v123, v123
    v_exp_f32 v124, v124
    v_cvt_pk_bf16_f32 v93, v122, v123
    v_exp_f32 v125, v125
    v_exp_f32 v126, v126
    v_exp_f32 v127, v127
    v_cvt_pk_bf16_f32 v94, v124, v125
    v_cvt_pk_bf16_f32 v95, v126, v127
    v_mfma_f32_32x32x16_bf16 v[112:127], a[204:207], v[36:39], v[240:255]
    v_exp_f32 v96, v96
    v_exp_f32 v97, v97
    v_exp_f32 v98, v98
    v_mfma_f32_32x32x16_bf16 v[144:159], a[236:239], v[92:95], v[144:159]
    v_cvt_pk_bf16_f32 v88, v96, v97
    v_exp_f32 v99, v99
    v_exp_f32 v100, v100
    v_cvt_pk_bf16_f32 v89, v98, v99
    v_exp_f32 v101, v101
    v_exp_f32 v102, v102
    v_cvt_pk_bf16_f32 v90, v100, v101
    v_exp_f32 v103, v103
    v_exp_f32 v104, v104
    v_cvt_pk_bf16_f32 v91, v102, v103
    v_exp_f32 v105, v105
    v_exp_f32 v106, v106
    v_mfma_f32_32x32x16_bf16 v[160:175], a[220:223], v[88:91], v[160:175]
    s_waitcnt vmcnt(24)
    v_cvt_pk_bf16_f32 v92, v104, v105
    v_exp_f32 v107, v107
    v_exp_f32 v108, v108
    v_cvt_pk_bf16_f32 v93, v106, v107
    v_exp_f32 v109, v109
    v_exp_f32 v110, v110
    v_exp_f32 v111, v111
    v_cvt_pk_bf16_f32 v94, v108, v109
    v_cvt_pk_bf16_f32 v95, v110, v111
    v_mfma_f32_32x32x16_bf16 v[96:111], v[40:43], v[24:27], v[192:207]
    v_exp_f32 v112, v112
    v_exp_f32 v113, v113
    v_exp_f32 v114, v114
    v_mfma_f32_32x32x16_bf16 v[160:175], a[236:239], v[92:95], v[160:175]
    v_cvt_pk_bf16_f32 v88, v112, v113
    v_exp_f32 v115, v115
    v_exp_f32 v116, v116
    v_cvt_pk_bf16_f32 v89, v114, v115
    v_exp_f32 v117, v117
    v_exp_f32 v118, v118
    v_cvt_pk_bf16_f32 v90, v116, v117
    v_exp_f32 v119, v119
    v_exp_f32 v120, v120
    v_cvt_pk_bf16_f32 v91, v118, v119
    v_exp_f32 v121, v121
    v_exp_f32 v122, v122
    v_mfma_f32_32x32x16_bf16 v[176:191], a[220:223], v[88:91], v[176:191]
    v_cvt_pk_bf16_f32 v92, v120, v121
    v_exp_f32 v123, v123
    v_exp_f32 v124, v124
    v_cvt_pk_bf16_f32 v93, v122, v123
    v_exp_f32 v125, v125
    v_exp_f32 v126, v126
    v_exp_f32 v127, v127
    v_cvt_pk_bf16_f32 v94, v124, v125
    v_cvt_pk_bf16_f32 v95, v126, v127
    v_mfma_f32_32x32x16_bf16 v[112:127], v[40:43], v[28:31], v[208:223]
    s_add_u32 m0, s42, 1024
    v_exp_f32 v96, v96
    v_exp_f32 v97, v97
    v_exp_f32 v98, v98
    v_mfma_f32_32x32x16_bf16 v[176:191], a[236:239], v[92:95], v[176:191]
    s_xor_b32 s28, s41, 8192
    v_cvt_pk_bf16_f32 v88, v96, v97
    v_exp_f32 v99, v99
    v_exp_f32 v100, v100
    v_cvt_pk_bf16_f32 v89, v98, v99
    v_exp_f32 v101, v101
    v_exp_f32 v102, v102
    v_cvt_pk_bf16_f32 v90, v100, v101
    v_exp_f32 v103, v103
    v_exp_f32 v104, v104
    v_cvt_pk_bf16_f32 v91, v102, v103
    v_exp_f32 v105, v105
    v_exp_f32 v106, v106
    v_mfma_f32_32x32x16_bf16 v[128:143], v[56:59], v[88:91], v[128:143]
    buffer_load_dwordx4 v19, s[56:59], s28 offen lds
    v_cvt_pk_bf16_f32 v92, v104, v105
    v_exp_f32 v107, v107
    v_exp_f32 v108, v108
    v_cvt_pk_bf16_f32 v93, v106, v107
    v_exp_f32 v109, v109
    v_exp_f32 v110, v110
    v_exp_f32 v111, v111
    v_cvt_pk_bf16_f32 v94, v108, v109
    v_cvt_pk_bf16_f32 v95, v110, v111
    v_mfma_f32_32x32x16_bf16 v[96:111], v[40:43], v[32:35], v[224:239]
    v_exp_f32 v112, v112
    v_exp_f32 v113, v113
    v_exp_f32 v114, v114
    v_mfma_f32_32x32x16_bf16 v[128:143], v[72:75], v[92:95], v[128:143]
    buffer_load_dwordx4 a[204:207], v8, s[20:23], s29 offen offset:0
    buffer_load_dwordx4 a[220:223], v13, s[20:23], s29 offen offset:0
    buffer_load_dwordx4 a[236:239], v13, s[20:23], s29 offen offset:512
    v_cvt_pk_bf16_f32 v88, v112, v113
    v_exp_f32 v115, v115
    v_exp_f32 v116, v116
    v_cvt_pk_bf16_f32 v89, v114, v115
    v_exp_f32 v117, v117
    v_exp_f32 v118, v118
    v_cvt_pk_bf16_f32 v90, v116, v117
    v_exp_f32 v119, v119
    v_exp_f32 v120, v120
    v_cvt_pk_bf16_f32 v91, v118, v119
    v_exp_f32 v121, v121
    v_exp_f32 v122, v122
    v_mfma_f32_32x32x16_bf16 v[144:159], v[56:59], v[88:91], v[144:159]
    v_cvt_pk_bf16_f32 v92, v120, v121
    v_exp_f32 v123, v123
    v_exp_f32 v124, v124
    v_cvt_pk_bf16_f32 v93, v122, v123
    v_exp_f32 v125, v125
    v_exp_f32 v126, v126
    v_exp_f32 v127, v127
    v_cvt_pk_bf16_f32 v94, v124, v125
    v_cvt_pk_bf16_f32 v95, v126, v127
    v_mfma_f32_32x32x16_bf16 v[112:127], v[40:43], v[36:39], v[240:255]
    v_exp_f32 v96, v96
    v_exp_f32 v97, v97
    v_exp_f32 v98, v98
    v_mfma_f32_32x32x16_bf16 v[144:159], v[72:75], v[92:95], v[144:159]
    v_cvt_pk_bf16_f32 v88, v96, v97
    v_exp_f32 v99, v99
    v_exp_f32 v100, v100
    v_cvt_pk_bf16_f32 v89, v98, v99
    v_exp_f32 v101, v101
    v_exp_f32 v102, v102
    v_cvt_pk_bf16_f32 v90, v100, v101
    v_exp_f32 v103, v103
    v_exp_f32 v104, v104
    v_cvt_pk_bf16_f32 v91, v102, v103
    v_exp_f32 v105, v105
    v_exp_f32 v106, v106
    v_mfma_f32_32x32x16_bf16 v[160:175], v[56:59], v[88:91], v[160:175]
    s_waitcnt vmcnt(25)
    v_cvt_pk_bf16_f32 v92, v104, v105
    v_exp_f32 v107, v107
    v_exp_f32 v108, v108
    v_cvt_pk_bf16_f32 v93, v106, v107
    v_exp_f32 v109, v109
    v_exp_f32 v110, v110
    v_exp_f32 v111, v111
    v_cvt_pk_bf16_f32 v94, v108, v109
    v_cvt_pk_bf16_f32 v95, v110, v111
    v_mfma_f32_32x32x16_bf16 v[96:111], v[44:47], v[24:27], v[192:207]
    s_xor_b32 s37, s38, 131584
    v_exp_f32 v112, v112
    v_exp_f32 v113, v113
    v_exp_f32 v114, v114
    v_mfma_f32_32x32x16_bf16 v[160:175], v[72:75], v[92:95], v[160:175]
    s_add_u32 m0, s39, 8192
    v_cvt_pk_bf16_f32 v88, v112, v113
    v_exp_f32 v115, v115
    v_exp_f32 v116, v116
    v_cvt_pk_bf16_f32 v89, v114, v115
    v_exp_f32 v117, v117
    v_exp_f32 v118, v118
    v_cvt_pk_bf16_f32 v90, v116, v117
    v_exp_f32 v119, v119
    v_exp_f32 v120, v120
    v_cvt_pk_bf16_f32 v91, v118, v119
    v_exp_f32 v121, v121
    v_exp_f32 v122, v122
    v_mfma_f32_32x32x16_bf16 v[176:191], v[56:59], v[88:91], v[176:191]
    buffer_load_dwordx4 v15, s[24:27], s37 offen offset:0 lds
    buffer_load_dwordx4 v16, s[24:27], s37 offen offset:1024 lds
    buffer_load_dwordx4 v17, s[24:27], s37 offen offset:2048 lds
    buffer_load_dwordx4 v18, s[24:27], s37 offen offset:3072 lds
    v_cvt_pk_bf16_f32 v92, v120, v121
    v_exp_f32 v123, v123
    v_exp_f32 v124, v124
    v_cvt_pk_bf16_f32 v93, v122, v123
    v_exp_f32 v125, v125
    v_exp_f32 v126, v126
    v_exp_f32 v127, v127
    v_cvt_pk_bf16_f32 v94, v124, v125
    v_cvt_pk_bf16_f32 v95, v126, v127
    v_mfma_f32_32x32x16_bf16 v[112:127], v[44:47], v[28:31], v[208:223]
    v_exp_f32 v96, v96
    v_exp_f32 v97, v97
    v_exp_f32 v98, v98
    v_mfma_f32_32x32x16_bf16 v[176:191], v[72:75], v[92:95], v[176:191]
    v_cvt_pk_bf16_f32 v88, v96, v97
    v_exp_f32 v99, v99
    v_exp_f32 v100, v100
    v_cvt_pk_bf16_f32 v89, v98, v99
    v_exp_f32 v101, v101
    v_exp_f32 v102, v102
    v_cvt_pk_bf16_f32 v90, v100, v101
    v_exp_f32 v103, v103
    v_exp_f32 v104, v104
    v_cvt_pk_bf16_f32 v91, v102, v103
    v_exp_f32 v105, v105
    v_exp_f32 v106, v106
    v_mfma_f32_32x32x16_bf16 v[128:143], v[60:63], v[88:91], v[128:143]
    v_cvt_pk_bf16_f32 v92, v104, v105
    v_exp_f32 v107, v107
    v_exp_f32 v108, v108
    v_cvt_pk_bf16_f32 v93, v106, v107
    v_exp_f32 v109, v109
    v_exp_f32 v110, v110
    v_exp_f32 v111, v111
    v_cvt_pk_bf16_f32 v94, v108, v109
    v_cvt_pk_bf16_f32 v95, v110, v111
    v_mfma_f32_32x32x16_bf16 v[96:111], v[44:47], v[32:35], v[224:239]
    v_exp_f32 v112, v112
    v_exp_f32 v113, v113
    v_exp_f32 v114, v114
    v_mfma_f32_32x32x16_bf16 v[128:143], v[76:79], v[92:95], v[128:143]
    buffer_load_dwordx4 v[40:43], v8, s[20:23], s29 offen offset:1024
    buffer_load_dwordx4 v[56:59], v13, s[20:23], s29 offen offset:1024
    buffer_load_dwordx4 v[72:75], v13, s[20:23], s29 offen offset:1536
    v_cvt_pk_bf16_f32 v88, v112, v113
    v_exp_f32 v115, v115
    v_exp_f32 v116, v116
    v_cvt_pk_bf16_f32 v89, v114, v115
    v_exp_f32 v117, v117
    v_exp_f32 v118, v118
    v_cvt_pk_bf16_f32 v90, v116, v117
    v_exp_f32 v119, v119
    v_exp_f32 v120, v120
    v_cvt_pk_bf16_f32 v91, v118, v119
    v_exp_f32 v121, v121
    v_exp_f32 v122, v122
    v_mfma_f32_32x32x16_bf16 v[144:159], v[60:63], v[88:91], v[144:159]
    v_cvt_pk_bf16_f32 v92, v120, v121
    v_exp_f32 v123, v123
    v_exp_f32 v124, v124
    v_cvt_pk_bf16_f32 v93, v122, v123
    v_exp_f32 v125, v125
    v_exp_f32 v126, v126
    v_exp_f32 v127, v127
    v_cvt_pk_bf16_f32 v94, v124, v125
    v_cvt_pk_bf16_f32 v95, v126, v127
    v_mfma_f32_32x32x16_bf16 v[112:127], v[44:47], v[36:39], v[240:255]
    s_add_u32 m0, s42, 2048
    v_exp_f32 v96, v96
    v_exp_f32 v97, v97
    v_exp_f32 v98, v98
    v_mfma_f32_32x32x16_bf16 v[144:159], v[76:79], v[92:95], v[144:159]
    s_xor_b32 s28, s41, 16384
    v_cvt_pk_bf16_f32 v88, v96, v97
    v_exp_f32 v99, v99
    v_exp_f32 v100, v100
    v_cvt_pk_bf16_f32 v89, v98, v99
    v_exp_f32 v101, v101
    v_exp_f32 v102, v102
    v_cvt_pk_bf16_f32 v90, v100, v101
    v_exp_f32 v103, v103
    v_exp_f32 v104, v104
    v_cvt_pk_bf16_f32 v91, v102, v103
    v_exp_f32 v105, v105
    v_exp_f32 v106, v106
    v_mfma_f32_32x32x16_bf16 v[160:175], v[60:63], v[88:91], v[160:175]
    s_waitcnt vmcnt(29)
    v_cvt_pk_bf16_f32 v92, v104, v105
    v_exp_f32 v107, v107
    v_exp_f32 v108, v108
    v_cvt_pk_bf16_f32 v93, v106, v107
    v_exp_f32 v109, v109
    v_exp_f32 v110, v110
    v_exp_f32 v111, v111
    v_cvt_pk_bf16_f32 v94, v108, v109
    v_cvt_pk_bf16_f32 v95, v110, v111
    v_mfma_f32_32x32x16_bf16 v[96:111], v[48:51], v[24:27], v[192:207]
    buffer_load_dwordx4 v19, s[56:59], s28 offen lds
    v_exp_f32 v112, v112
    v_exp_f32 v113, v113
    v_exp_f32 v114, v114
    v_mfma_f32_32x32x16_bf16 v[160:175], v[76:79], v[92:95], v[160:175]
    v_cvt_pk_bf16_f32 v88, v112, v113
    v_exp_f32 v115, v115
    v_exp_f32 v116, v116
    v_cvt_pk_bf16_f32 v89, v114, v115
    v_exp_f32 v117, v117
    v_exp_f32 v118, v118
    v_cvt_pk_bf16_f32 v90, v116, v117
    v_exp_f32 v119, v119
    v_exp_f32 v120, v120
    v_cvt_pk_bf16_f32 v91, v118, v119
    v_exp_f32 v121, v121
    v_exp_f32 v122, v122
    v_mfma_f32_32x32x16_bf16 v[176:191], v[60:63], v[88:91], v[176:191]
    v_cvt_pk_bf16_f32 v92, v120, v121
    v_exp_f32 v123, v123
    v_exp_f32 v124, v124
    v_cvt_pk_bf16_f32 v93, v122, v123
    v_exp_f32 v125, v125
    v_exp_f32 v126, v126
    v_exp_f32 v127, v127
    v_cvt_pk_bf16_f32 v94, v124, v125
    v_cvt_pk_bf16_f32 v95, v126, v127
    v_mfma_f32_32x32x16_bf16 v[112:127], v[48:51], v[28:31], v[208:223]
    v_exp_f32 v96, v96
    v_exp_f32 v97, v97
    v_exp_f32 v98, v98
    v_mfma_f32_32x32x16_bf16 v[176:191], v[76:79], v[92:95], v[176:191]
    v_cvt_pk_bf16_f32 v88, v96, v97
    v_exp_f32 v99, v99
    v_exp_f32 v100, v100
    v_cvt_pk_bf16_f32 v89, v98, v99
    v_exp_f32 v101, v101
    v_exp_f32 v102, v102
    v_cvt_pk_bf16_f32 v90, v100, v101
    v_exp_f32 v103, v103
    v_exp_f32 v104, v104
    v_cvt_pk_bf16_f32 v91, v102, v103
    v_exp_f32 v105, v105
    v_exp_f32 v106, v106
    v_mfma_f32_32x32x16_bf16 v[128:143], v[64:67], v[88:91], v[128:143]
    s_xor_b32 s37, s38, 196608
    v_cvt_pk_bf16_f32 v92, v104, v105
    v_exp_f32 v107, v107
    v_exp_f32 v108, v108
    v_cvt_pk_bf16_f32 v93, v106, v107
    v_exp_f32 v109, v109
    v_exp_f32 v110, v110
    v_exp_f32 v111, v111
    v_cvt_pk_bf16_f32 v94, v108, v109
    v_cvt_pk_bf16_f32 v95, v110, v111
    v_mfma_f32_32x32x16_bf16 v[96:111], v[48:51], v[32:35], v[224:239]
    s_add_u32 m0, s39, 12288
    v_exp_f32 v112, v112
    v_exp_f32 v113, v113
    v_exp_f32 v114, v114
    v_mfma_f32_32x32x16_bf16 v[128:143], v[80:83], v[92:95], v[128:143]
    buffer_load_dwordx4 v[44:47], v8, s[20:23], s29 offen offset:2048
    buffer_load_dwordx4 v[60:63], v13, s[20:23], s29 offen offset:2048
    buffer_load_dwordx4 v[76:79], v13, s[20:23], s29 offen offset:2560
    v_cvt_pk_bf16_f32 v88, v112, v113
    v_exp_f32 v115, v115
    v_exp_f32 v116, v116
    v_cvt_pk_bf16_f32 v89, v114, v115
    v_exp_f32 v117, v117
    v_exp_f32 v118, v118
    v_cvt_pk_bf16_f32 v90, v116, v117
    v_exp_f32 v119, v119
    v_exp_f32 v120, v120
    v_cvt_pk_bf16_f32 v91, v118, v119
    v_exp_f32 v121, v121
    v_exp_f32 v122, v122
    v_mfma_f32_32x32x16_bf16 v[144:159], v[64:67], v[88:91], v[144:159]
    buffer_load_dwordx4 v15, s[24:27], s37 offen offset:0 lds
    buffer_load_dwordx4 v16, s[24:27], s37 offen offset:1024 lds
    buffer_load_dwordx4 v17, s[24:27], s37 offen offset:2048 lds
    buffer_load_dwordx4 v18, s[24:27], s37 offen offset:3072 lds
    v_cvt_pk_bf16_f32 v92, v120, v121
    v_exp_f32 v123, v123
    v_exp_f32 v124, v124
    v_cvt_pk_bf16_f32 v93, v122, v123
    v_exp_f32 v125, v125
    v_exp_f32 v126, v126
    v_exp_f32 v127, v127
    v_cvt_pk_bf16_f32 v94, v124, v125
    v_cvt_pk_bf16_f32 v95, v126, v127
    v_mfma_f32_32x32x16_bf16 v[112:127], v[48:51], v[36:39], v[240:255]
    v_exp_f32 v96, v96
    v_exp_f32 v97, v97
    v_exp_f32 v98, v98
    v_mfma_f32_32x32x16_bf16 v[144:159], v[80:83], v[92:95], v[144:159]
    v_cvt_pk_bf16_f32 v88, v96, v97
    v_exp_f32 v99, v99
    v_exp_f32 v100, v100
    v_cvt_pk_bf16_f32 v89, v98, v99
    v_exp_f32 v101, v101
    v_exp_f32 v102, v102
    v_cvt_pk_bf16_f32 v90, v100, v101
    v_exp_f32 v103, v103
    v_exp_f32 v104, v104
    v_cvt_pk_bf16_f32 v91, v102, v103
    v_exp_f32 v105, v105
    v_exp_f32 v106, v106
    v_mfma_f32_32x32x16_bf16 v[160:175], v[64:67], v[88:91], v[160:175]
    s_waitcnt vmcnt(46)
    v_cvt_pk_bf16_f32 v92, v104, v105
    v_exp_f32 v107, v107
    v_exp_f32 v108, v108
    v_cvt_pk_bf16_f32 v93, v106, v107
    v_exp_f32 v109, v109
    v_exp_f32 v110, v110
    v_exp_f32 v111, v111
    v_cvt_pk_bf16_f32 v94, v108, v109
    v_cvt_pk_bf16_f32 v95, v110, v111
    v_mfma_f32_32x32x16_bf16 v[96:111], v[52:55], v[24:27], v[192:207]
    s_waitcnt vmcnt(30)
    v_exp_f32 v112, v112
    v_exp_f32 v113, v113
    v_exp_f32 v114, v114
    v_mfma_f32_32x32x16_bf16 v[160:175], v[80:83], v[92:95], v[160:175]
    ds_read_b128 a[0:3], v20 offset:0
    v_cvt_pk_bf16_f32 v88, v112, v113
    v_exp_f32 v115, v115
    v_exp_f32 v116, v116
    v_cvt_pk_bf16_f32 v89, v114, v115
    v_exp_f32 v117, v117
    v_exp_f32 v118, v118
    v_cvt_pk_bf16_f32 v90, v116, v117
    v_exp_f32 v119, v119
    v_exp_f32 v120, v120
    v_cvt_pk_bf16_f32 v91, v118, v119
    v_exp_f32 v121, v121
    v_exp_f32 v122, v122
    v_mfma_f32_32x32x16_bf16 v[176:191], v[64:67], v[88:91], v[176:191]
    ds_read_b128 a[16:19], v21 offset:0
    v_cvt_pk_bf16_f32 v92, v120, v121
    v_exp_f32 v123, v123
    v_exp_f32 v124, v124
    v_cvt_pk_bf16_f32 v93, v122, v123
    v_exp_f32 v125, v125
    v_exp_f32 v126, v126
    v_exp_f32 v127, v127
    v_cvt_pk_bf16_f32 v94, v124, v125
    v_cvt_pk_bf16_f32 v95, v126, v127
    v_mfma_f32_32x32x16_bf16 v[112:127], v[52:55], v[28:31], v[208:223]
    ds_read_b128 a[32:35], v22 offset:0
    v_exp_f32 v96, v96
    v_exp_f32 v97, v97
    v_exp_f32 v98, v98
    v_mfma_f32_32x32x16_bf16 v[176:191], v[80:83], v[92:95], v[176:191]
    ds_read_b128 a[48:51], v23 offset:0
    v_cvt_pk_bf16_f32 v88, v96, v97
    v_exp_f32 v99, v99
    v_exp_f32 v100, v100
    v_cvt_pk_bf16_f32 v89, v98, v99
    v_exp_f32 v101, v101
    v_exp_f32 v102, v102
    v_cvt_pk_bf16_f32 v90, v100, v101
    v_exp_f32 v103, v103
    v_exp_f32 v104, v104
    v_cvt_pk_bf16_f32 v91, v102, v103
    v_exp_f32 v105, v105
    v_exp_f32 v106, v106
    v_mfma_f32_32x32x16_bf16 v[128:143], v[68:71], v[88:91], v[128:143]
    s_add_u32 m0, s42, 3072
    v_cvt_pk_bf16_f32 v92, v104, v105
    v_exp_f32 v107, v107
    v_exp_f32 v108, v108
    v_cvt_pk_bf16_f32 v93, v106, v107
    v_exp_f32 v109, v109
    v_exp_f32 v110, v110
    v_exp_f32 v111, v111
    v_cvt_pk_bf16_f32 v94, v108, v109
    v_cvt_pk_bf16_f32 v95, v110, v111
    v_mfma_f32_32x32x16_bf16 v[96:111], v[52:55], v[32:35], v[224:239]
    s_xor_b32 s28, s41, 24576
    v_exp_f32 v112, v112
    v_exp_f32 v113, v113
    v_exp_f32 v114, v114
    v_mfma_f32_32x32x16_bf16 v[128:143], v[84:87], v[92:95], v[128:143]
    buffer_load_dwordx4 v[48:51], v8, s[20:23], s29 offen offset:3072
    buffer_load_dwordx4 v[64:67], v13, s[20:23], s29 offen offset:3072
    buffer_load_dwordx4 v[80:83], v13, s[20:23], s29 offen offset:3584
    v_cvt_pk_bf16_f32 v88, v112, v113
    v_exp_f32 v115, v115
    v_exp_f32 v116, v116
    v_cvt_pk_bf16_f32 v89, v114, v115
    v_exp_f32 v117, v117
    v_exp_f32 v118, v118
    v_cvt_pk_bf16_f32 v90, v116, v117
    v_exp_f32 v119, v119
    v_exp_f32 v120, v120
    v_cvt_pk_bf16_f32 v91, v118, v119
    v_exp_f32 v121, v121
    v_exp_f32 v122, v122
    v_mfma_f32_32x32x16_bf16 v[144:159], v[68:71], v[88:91], v[144:159]
    s_add_u32 s29, s29, 4096
    v_cvt_pk_bf16_f32 v92, v120, v121
    v_exp_f32 v123, v123
    v_exp_f32 v124, v124
    v_cvt_pk_bf16_f32 v93, v122, v123
    v_exp_f32 v125, v125
    v_exp_f32 v126, v126
    v_exp_f32 v127, v127
    v_cvt_pk_bf16_f32 v94, v124, v125
    v_cvt_pk_bf16_f32 v95, v126, v127
    v_mfma_f32_32x32x16_bf16 v[112:127], v[52:55], v[36:39], v[240:255]
    buffer_load_dwordx4 v19, s[56:59], s28 offen lds
    v_exp_f32 v96, v96
    v_exp_f32 v97, v97
    v_exp_f32 v98, v98
    v_mfma_f32_32x32x16_bf16 v[144:159], v[84:87], v[92:95], v[144:159]
    s_mov_b32 s88, s50
    s_mov_b32 s89, s51
    v_cvt_pk_bf16_f32 v88, v96, v97
    v_exp_f32 v99, v99
    v_exp_f32 v100, v100
    v_cvt_pk_bf16_f32 v89, v98, v99
    v_exp_f32 v101, v101
    v_exp_f32 v102, v102
    v_cvt_pk_bf16_f32 v90, v100, v101
    v_exp_f32 v103, v103
    v_exp_f32 v104, v104
    v_cvt_pk_bf16_f32 v91, v102, v103
    v_exp_f32 v105, v105
    v_exp_f32 v106, v106
    v_mfma_f32_32x32x16_bf16 v[160:175], v[68:71], v[88:91], v[160:175]
    s_waitcnt vmcnt(38)
    v_cvt_pk_bf16_f32 v92, v104, v105
    v_exp_f32 v107, v107
    v_exp_f32 v108, v108
    v_cvt_pk_bf16_f32 v93, v106, v107
    v_exp_f32 v109, v109
    v_exp_f32 v110, v110
    v_exp_f32 v111, v111
    v_cvt_pk_bf16_f32 v94, v108, v109
    v_cvt_pk_bf16_f32 v95, v110, v111
    v_mfma_f32_32x32x16_bf16 v[96:111], a[192:195], v[24:27], v[192:207]
    s_mov_b32 s90, 0xe0000
    s_mov_b32 s91, 0x00020000
    v_exp_f32 v112, v112
    v_exp_f32 v113, v113
    v_exp_f32 v114, v114
    v_mfma_f32_32x32x16_bf16 v[160:175], v[84:87], v[92:95], v[160:175]
    s_lshl_b32 s54, s2, 2
    s_add_u32 s54, s54, s14
    v_cvt_pk_bf16_f32 v88, v112, v113
    v_exp_f32 v115, v115
    v_exp_f32 v116, v116
    v_cvt_pk_bf16_f32 v89, v114, v115
    v_exp_f32 v117, v117
    v_exp_f32 v118, v118
    v_cvt_pk_bf16_f32 v90, v116, v117
    v_exp_f32 v119, v119
    v_exp_f32 v120, v120
    v_cvt_pk_bf16_f32 v91, v118, v119
    v_exp_f32 v121, v121
    v_exp_f32 v122, v122
    v_mfma_f32_32x32x16_bf16 v[176:191], v[68:71], v[88:91], v[176:191]
    s_lshl_b32 s54, s54, 10
    buffer_load_dwordx4 v[2:5], v8, s[88:91], s54 offen
    v_cvt_pk_bf16_f32 v92, v120, v121
    v_exp_f32 v123, v123
    v_exp_f32 v124, v124
    v_cvt_pk_bf16_f32 v93, v122, v123
    v_exp_f32 v125, v125
    v_exp_f32 v126, v126
    v_exp_f32 v127, v127
    v_cvt_pk_bf16_f32 v94, v124, v125
    v_cvt_pk_bf16_f32 v95, v126, v127
    v_mfma_f32_32x32x16_bf16 v[112:127], a[192:195], v[28:31], v[208:223]
    s_waitcnt lgkmcnt(0)
    v_exp_f32 v96, v96
    v_exp_f32 v97, v97
    v_exp_f32 v98, v98
    v_mfma_f32_32x32x16_bf16 v[176:191], v[84:87], v[92:95], v[176:191]
    s_xor_b32 s37, s38, 256
    v_cvt_pk_bf16_f32 v88, v96, v97
    v_exp_f32 v99, v99
    v_exp_f32 v100, v100
    v_cvt_pk_bf16_f32 v89, v98, v99
    v_exp_f32 v101, v101
    v_exp_f32 v102, v102
    v_cvt_pk_bf16_f32 v90, v100, v101
    v_exp_f32 v103, v103
    v_exp_f32 v104, v104
    v_cvt_pk_bf16_f32 v91, v102, v103
    v_exp_f32 v105, v105
    v_exp_f32 v106, v106
    v_mfma_f32_32x32x16_bf16 v[128:143], a[208:211], v[88:91], v[128:143]
    s_add_u32 m0, s39, 0
    s_nop 0
    buffer_load_dwordx4 v15, s[24:27], s37 offen offset:0 lds
    buffer_load_dwordx4 v16, s[24:27], s37 offen offset:1024 lds
    buffer_load_dwordx4 v17, s[24:27], s37 offen offset:2048 lds
    buffer_load_dwordx4 v18, s[24:27], s37 offen offset:3072 lds
    v_cvt_pk_bf16_f32 v92, v104, v105
    v_exp_f32 v107, v107
    v_exp_f32 v108, v108
    v_cvt_pk_bf16_f32 v93, v106, v107
    v_exp_f32 v109, v109
    v_exp_f32 v110, v110
    v_exp_f32 v111, v111
    v_cvt_pk_bf16_f32 v94, v108, v109
    v_cvt_pk_bf16_f32 v95, v110, v111
    v_mfma_f32_32x32x16_bf16 v[96:111], a[192:195], v[32:35], v[224:239]
    s_waitcnt vmcnt(31)
    v_exp_f32 v112, v112
    v_exp_f32 v113, v113
    v_exp_f32 v114, v114
    v_mfma_f32_32x32x16_bf16 v[128:143], a[224:227], v[92:95], v[128:143]
    buffer_load_dwordx4 v[52:55], v8, s[20:23], s29 offen offset:0
    buffer_load_dwordx4 v[68:71], v13, s[20:23], s29 offen offset:0
    buffer_load_dwordx4 v[84:87], v13, s[20:23], s29 offen offset:512
    v_cvt_pk_bf16_f32 v88, v112, v113
    v_exp_f32 v115, v115
    v_exp_f32 v116, v116
    v_cvt_pk_bf16_f32 v89, v114, v115
    v_exp_f32 v117, v117
    v_exp_f32 v118, v118
    v_cvt_pk_bf16_f32 v90, v116, v117
    v_exp_f32 v119, v119
    v_exp_f32 v120, v120
    v_cvt_pk_bf16_f32 v91, v118, v119
    v_exp_f32 v121, v121
    v_exp_f32 v122, v122
    v_mfma_f32_32x32x16_bf16 v[144:159], a[208:211], v[88:91], v[144:159]
    ds_read_b128 a[68:71], v20 offset:4096
    v_cvt_pk_bf16_f32 v92, v120, v121
    v_exp_f32 v123, v123
    v_exp_f32 v124, v124
    v_cvt_pk_bf16_f32 v93, v122, v123
    v_exp_f32 v125, v125
    v_exp_f32 v126, v126
    v_exp_f32 v127, v127
    v_cvt_pk_bf16_f32 v94, v124, v125
    v_cvt_pk_bf16_f32 v95, v126, v127
    v_mfma_f32_32x32x16_bf16 v[112:127], a[192:195], v[36:39], v[240:255]
    ds_read_b128 a[84:87], v21 offset:4096
    v_exp_f32 v96, v96
    v_exp_f32 v97, v97
    v_exp_f32 v98, v98
    v_mfma_f32_32x32x16_bf16 v[144:159], a[224:227], v[92:95], v[144:159]
    ds_read_b128 a[100:103], v22 offset:4096
    v_cvt_pk_bf16_f32 v88, v96, v97
    v_exp_f32 v99, v99
    v_exp_f32 v100, v100
    v_cvt_pk_bf16_f32 v89, v98, v99
    v_exp_f32 v101, v101
    v_exp_f32 v102, v102
    v_cvt_pk_bf16_f32 v90, v100, v101
    v_exp_f32 v103, v103
    v_exp_f32 v104, v104
    v_cvt_pk_bf16_f32 v91, v102, v103
    v_exp_f32 v105, v105
    v_exp_f32 v106, v106
    v_mfma_f32_32x32x16_bf16 v[160:175], a[208:211], v[88:91], v[160:175]
    s_waitcnt vmcnt(39)
    v_cvt_pk_bf16_f32 v92, v104, v105
    v_exp_f32 v107, v107
    v_exp_f32 v108, v108
    v_cvt_pk_bf16_f32 v93, v106, v107
    v_exp_f32 v109, v109
    v_exp_f32 v110, v110
    v_exp_f32 v111, v111
    v_cvt_pk_bf16_f32 v94, v108, v109
    v_cvt_pk_bf16_f32 v95, v110, v111
    v_mfma_f32_32x32x16_bf16 v[96:111], a[196:199], v[24:27], v[192:207]
    ds_read_b128 a[116:119], v23 offset:4096
    v_exp_f32 v112, v112
    v_exp_f32 v113, v113
    v_exp_f32 v114, v114
    v_mfma_f32_32x32x16_bf16 v[160:175], a[224:227], v[92:95], v[160:175]
    s_add_u32 m0, s42, 4096
    v_cvt_pk_bf16_f32 v88, v112, v113
    v_exp_f32 v115, v115
    v_exp_f32 v116, v116
    v_cvt_pk_bf16_f32 v89, v114, v115
    v_exp_f32 v117, v117
    v_exp_f32 v118, v118
    v_cvt_pk_bf16_f32 v90, v116, v117
    v_exp_f32 v119, v119
    v_exp_f32 v120, v120
    v_cvt_pk_bf16_f32 v91, v118, v119
    v_exp_f32 v121, v121
    v_exp_f32 v122, v122
    v_mfma_f32_32x32x16_bf16 v[176:191], a[208:211], v[88:91], v[176:191]
    s_xor_b32 s28, s41, 32768
    v_cvt_pk_bf16_f32 v92, v120, v121
    v_exp_f32 v123, v123
    v_exp_f32 v124, v124
    v_cvt_pk_bf16_f32 v93, v122, v123
    v_exp_f32 v125, v125
    v_exp_f32 v126, v126
    v_exp_f32 v127, v127
    v_cvt_pk_bf16_f32 v94, v124, v125
    v_cvt_pk_bf16_f32 v95, v126, v127
    v_mfma_f32_32x32x16_bf16 v[112:127], a[196:199], v[28:31], v[208:223]
    buffer_load_dwordx4 v19, s[56:59], s28 offen lds
    v_exp_f32 v96, v96
    v_exp_f32 v97, v97
    v_exp_f32 v98, v98
    v_mfma_f32_32x32x16_bf16 v[176:191], a[224:227], v[92:95], v[176:191]
    v_cvt_pk_bf16_f32 v88, v96, v97
    v_exp_f32 v99, v99
    v_exp_f32 v100, v100
    v_cvt_pk_bf16_f32 v89, v98, v99
    v_exp_f32 v101, v101
    v_exp_f32 v102, v102
    v_cvt_pk_bf16_f32 v90, v100, v101
    v_exp_f32 v103, v103
    v_exp_f32 v104, v104
    v_cvt_pk_bf16_f32 v91, v102, v103
    v_exp_f32 v105, v105
    v_exp_f32 v106, v106
    v_mfma_f32_32x32x16_bf16 v[128:143], a[212:215], v[88:91], v[128:143]
    v_cvt_pk_bf16_f32 v92, v104, v105
    v_exp_f32 v107, v107
    v_exp_f32 v108, v108
    v_cvt_pk_bf16_f32 v93, v106, v107
    v_exp_f32 v109, v109
    v_exp_f32 v110, v110
    v_exp_f32 v111, v111
    v_cvt_pk_bf16_f32 v94, v108, v109
    v_cvt_pk_bf16_f32 v95, v110, v111
    v_mfma_f32_32x32x16_bf16 v[96:111], a[196:199], v[32:35], v[224:239]
    s_waitcnt lgkmcnt(0)
    v_exp_f32 v112, v112
    v_exp_f32 v113, v113
    v_exp_f32 v114, v114
    v_mfma_f32_32x32x16_bf16 v[128:143], a[228:231], v[92:95], v[128:143]
    buffer_load_dwordx4 a[192:195], v8, s[20:23], s29 offen offset:1024
    buffer_load_dwordx4 a[208:211], v13, s[20:23], s29 offen offset:1024
    buffer_load_dwordx4 a[224:227], v13, s[20:23], s29 offen offset:1536
    v_cvt_pk_bf16_f32 v88, v112, v113
    v_exp_f32 v115, v115
    v_exp_f32 v116, v116
    v_cvt_pk_bf16_f32 v89, v114, v115
    v_exp_f32 v117, v117
    v_exp_f32 v118, v118
    v_cvt_pk_bf16_f32 v90, v116, v117
    v_exp_f32 v119, v119
    v_exp_f32 v120, v120
    v_cvt_pk_bf16_f32 v91, v118, v119
    v_exp_f32 v121, v121
    v_exp_f32 v122, v122
    v_mfma_f32_32x32x16_bf16 v[144:159], a[212:215], v[88:91], v[144:159]
    s_xor_b32 s37, s38, 66048
    v_cvt_pk_bf16_f32 v92, v120, v121
    v_exp_f32 v123, v123
    v_exp_f32 v124, v124
    v_cvt_pk_bf16_f32 v93, v122, v123
    v_exp_f32 v125, v125
    v_exp_f32 v126, v126
    v_exp_f32 v127, v127
    v_cvt_pk_bf16_f32 v94, v124, v125
    v_cvt_pk_bf16_f32 v95, v126, v127
    v_mfma_f32_32x32x16_bf16 v[112:127], a[196:199], v[36:39], v[240:255]
    s_add_u32 m0, s39, 4096
    v_exp_f32 v96, v96
    v_exp_f32 v97, v97
    v_exp_f32 v98, v98
    v_mfma_f32_32x32x16_bf16 v[144:159], a[228:231], v[92:95], v[144:159]
    buffer_load_dwordx4 v15, s[24:27], s37 offen offset:0 lds
    buffer_load_dwordx4 v16, s[24:27], s37 offen offset:1024 lds
    buffer_load_dwordx4 v17, s[24:27], s37 offen offset:2048 lds
    buffer_load_dwordx4 v18, s[24:27], s37 offen offset:3072 lds
    v_cvt_pk_bf16_f32 v88, v96, v97
    v_exp_f32 v99, v99
    v_exp_f32 v100, v100
    v_cvt_pk_bf16_f32 v89, v98, v99
    v_exp_f32 v101, v101
    v_exp_f32 v102, v102
    v_cvt_pk_bf16_f32 v90, v100, v101
    v_exp_f32 v103, v103
    v_exp_f32 v104, v104
    v_cvt_pk_bf16_f32 v91, v102, v103
    v_exp_f32 v105, v105
    v_exp_f32 v106, v106
    v_mfma_f32_32x32x16_bf16 v[160:175], a[212:215], v[88:91], v[160:175]
    s_waitcnt vmcnt(39)
    v_cvt_pk_bf16_f32 v92, v104, v105
    v_exp_f32 v107, v107
    v_exp_f32 v108, v108
    v_cvt_pk_bf16_f32 v93, v106, v107
    v_exp_f32 v109, v109
    v_exp_f32 v110, v110
    v_exp_f32 v111, v111
    v_cvt_pk_bf16_f32 v94, v108, v109
    v_cvt_pk_bf16_f32 v95, v110, v111
    v_mfma_f32_32x32x16_bf16 v[96:111], a[200:203], v[24:27], v[192:207]
    s_waitcnt vmcnt(31)
    v_exp_f32 v112, v112
    v_exp_f32 v113, v113
    v_exp_f32 v114, v114
    v_mfma_f32_32x32x16_bf16 v[160:175], a[228:231], v[92:95], v[160:175]
    ds_read_b128 a[136:139], v20 offset:8192
    v_cvt_pk_bf16_f32 v88, v112, v113
    v_exp_f32 v115, v115
    v_exp_f32 v116, v116
    v_cvt_pk_bf16_f32 v89, v114, v115
    v_exp_f32 v117, v117
    v_exp_f32 v118, v118
    v_cvt_pk_bf16_f32 v90, v116, v117
    v_exp_f32 v119, v119
    v_exp_f32 v120, v120
    v_cvt_pk_bf16_f32 v91, v118, v119
    v_exp_f32 v121, v121
    v_exp_f32 v122, v122
    v_mfma_f32_32x32x16_bf16 v[176:191], a[212:215], v[88:91], v[176:191]
    ds_read_b128 a[152:155], v21 offset:8192
    v_cvt_pk_bf16_f32 v92, v120, v121
    v_exp_f32 v123, v123
    v_exp_f32 v124, v124
    v_cvt_pk_bf16_f32 v93, v122, v123
    v_exp_f32 v125, v125
    v_exp_f32 v126, v126
    v_exp_f32 v127, v127
    v_cvt_pk_bf16_f32 v94, v124, v125
    v_cvt_pk_bf16_f32 v95, v126, v127
    v_mfma_f32_32x32x16_bf16 v[112:127], a[200:203], v[28:31], v[208:223]
    ds_read_b128 a[168:171], v22 offset:8192
    v_exp_f32 v96, v96
    v_exp_f32 v97, v97
    v_exp_f32 v98, v98
    v_mfma_f32_32x32x16_bf16 v[176:191], a[228:231], v[92:95], v[176:191]
    ds_read_b128 a[184:187], v23 offset:8192
    v_cvt_pk_bf16_f32 v88, v96, v97
    v_exp_f32 v99, v99
    v_exp_f32 v100, v100
    v_cvt_pk_bf16_f32 v89, v98, v99
    v_exp_f32 v101, v101
    v_exp_f32 v102, v102
    v_cvt_pk_bf16_f32 v90, v100, v101
    v_exp_f32 v103, v103
    v_exp_f32 v104, v104
    v_cvt_pk_bf16_f32 v91, v102, v103
    v_exp_f32 v105, v105
    v_exp_f32 v106, v106
    v_mfma_f32_32x32x16_bf16 v[128:143], a[216:219], v[88:91], v[128:143]
    v_cvt_pk_bf16_f32 v92, v104, v105
    v_exp_f32 v107, v107
    v_exp_f32 v108, v108
    v_cvt_pk_bf16_f32 v93, v106, v107
    v_exp_f32 v109, v109
    v_exp_f32 v110, v110
    v_exp_f32 v111, v111
    v_cvt_pk_bf16_f32 v94, v108, v109
    v_cvt_pk_bf16_f32 v95, v110, v111
    v_mfma_f32_32x32x16_bf16 v[96:111], a[200:203], v[32:35], v[224:239]
    s_add_u32 m0, s42, 5120
    v_exp_f32 v112, v112
    v_exp_f32 v113, v113
    v_exp_f32 v114, v114
    v_mfma_f32_32x32x16_bf16 v[128:143], a[232:235], v[92:95], v[128:143]
    buffer_load_dwordx4 a[196:199], v8, s[20:23], s29 offen offset:2048
    buffer_load_dwordx4 a[212:215], v13, s[20:23], s29 offen offset:2048
    buffer_load_dwordx4 a[228:231], v13, s[20:23], s29 offen offset:2560
    v_cvt_pk_bf16_f32 v88, v112, v113
    v_exp_f32 v115, v115
    v_exp_f32 v116, v116
    v_cvt_pk_bf16_f32 v89, v114, v115
    v_exp_f32 v117, v117
    v_exp_f32 v118, v118
    v_cvt_pk_bf16_f32 v90, v116, v117
    v_exp_f32 v119, v119
    v_exp_f32 v120, v120
    v_cvt_pk_bf16_f32 v91, v118, v119
    v_exp_f32 v121, v121
    v_exp_f32 v122, v122
    v_mfma_f32_32x32x16_bf16 v[144:159], a[216:219], v[88:91], v[144:159]
    s_xor_b32 s28, s41, 40960
    v_cvt_pk_bf16_f32 v92, v120, v121
    v_exp_f32 v123, v123
    v_exp_f32 v124, v124
    v_cvt_pk_bf16_f32 v93, v122, v123
    v_exp_f32 v125, v125
    v_exp_f32 v126, v126
    v_exp_f32 v127, v127
    v_cvt_pk_bf16_f32 v94, v124, v125
    v_cvt_pk_bf16_f32 v95, v126, v127
    v_mfma_f32_32x32x16_bf16 v[112:127], a[200:203], v[36:39], v[240:255]
    buffer_load_dwordx4 v19, s[56:59], s28 offen lds
    v_exp_f32 v96, v96
    v_exp_f32 v97, v97
    v_exp_f32 v98, v98
    v_mfma_f32_32x32x16_bf16 v[144:159], a[232:235], v[92:95], v[144:159]
    v_cvt_pk_bf16_f32 v88, v96, v97
    v_exp_f32 v99, v99
    v_exp_f32 v100, v100
    v_cvt_pk_bf16_f32 v89, v98, v99
    v_exp_f32 v101, v101
    v_exp_f32 v102, v102
    v_cvt_pk_bf16_f32 v90, v100, v101
    v_exp_f32 v103, v103
    v_exp_f32 v104, v104
    v_cvt_pk_bf16_f32 v91, v102, v103
    v_exp_f32 v105, v105
    v_exp_f32 v106, v106
    v_mfma_f32_32x32x16_bf16 v[160:175], a[216:219], v[88:91], v[160:175]
    s_waitcnt vmcnt(39)
    v_cvt_pk_bf16_f32 v92, v104, v105
    v_exp_f32 v107, v107
    v_exp_f32 v108, v108
    v_cvt_pk_bf16_f32 v93, v106, v107
    v_exp_f32 v109, v109
    v_exp_f32 v110, v110
    v_exp_f32 v111, v111
    v_cvt_pk_bf16_f32 v94, v108, v109
    v_cvt_pk_bf16_f32 v95, v110, v111
    v_mfma_f32_32x32x16_bf16 v[96:111], a[204:207], v[24:27], v[192:207]
    v_exp_f32 v112, v112
    v_exp_f32 v113, v113
    v_exp_f32 v114, v114
    v_mfma_f32_32x32x16_bf16 v[160:175], a[232:235], v[92:95], v[160:175]
    v_cvt_pk_bf16_f32 v88, v112, v113
    v_exp_f32 v115, v115
    v_exp_f32 v116, v116
    v_cvt_pk_bf16_f32 v89, v114, v115
    v_exp_f32 v117, v117
    v_exp_f32 v118, v118
    v_cvt_pk_bf16_f32 v90, v116, v117
    v_exp_f32 v119, v119
    v_exp_f32 v120, v120
    v_cvt_pk_bf16_f32 v91, v118, v119
    v_exp_f32 v121, v121
    v_exp_f32 v122, v122
    v_mfma_f32_32x32x16_bf16 v[176:191], a[216:219], v[88:91], v[176:191]
    s_waitcnt lgkmcnt(0)
    v_cvt_pk_bf16_f32 v92, v120, v121
    v_exp_f32 v123, v123
    v_exp_f32 v124, v124
    v_cvt_pk_bf16_f32 v93, v122, v123
    v_exp_f32 v125, v125
    v_exp_f32 v126, v126
    v_exp_f32 v127, v127
    v_cvt_pk_bf16_f32 v94, v124, v125
    v_cvt_pk_bf16_f32 v95, v126, v127
    v_mfma_f32_32x32x16_bf16 v[112:127], a[204:207], v[28:31], v[208:223]
    s_xor_b32 s37, s38, 131072
    v_exp_f32 v96, v96
    v_exp_f32 v97, v97
    v_exp_f32 v98, v98
    v_mfma_f32_32x32x16_bf16 v[176:191], a[232:235], v[92:95], v[176:191]
    s_add_u32 m0, s39, 8192
    v_cvt_pk_bf16_f32 v88, v96, v97
    v_exp_f32 v99, v99
    v_exp_f32 v100, v100
    v_cvt_pk_bf16_f32 v89, v98, v99
    v_exp_f32 v101, v101
    v_exp_f32 v102, v102
    v_cvt_pk_bf16_f32 v90, v100, v101
    v_exp_f32 v103, v103
    v_exp_f32 v104, v104
    v_cvt_pk_bf16_f32 v91, v102, v103
    v_exp_f32 v105, v105
    v_exp_f32 v106, v106
    v_mfma_f32_32x32x16_bf16 v[128:143], a[220:223], v[88:91], v[128:143]
    buffer_load_dwordx4 v15, s[24:27], s37 offen offset:0 lds
    buffer_load_dwordx4 v16, s[24:27], s37 offen offset:1024 lds
    buffer_load_dwordx4 v17, s[24:27], s37 offen offset:2048 lds
    buffer_load_dwordx4 v18, s[24:27], s37 offen offset:3072 lds
    v_cvt_pk_bf16_f32 v92, v104, v105
    v_exp_f32 v107, v107
    v_exp_f32 v108, v108
    v_cvt_pk_bf16_f32 v93, v106, v107
    v_exp_f32 v109, v109
    v_exp_f32 v110, v110
    v_exp_f32 v111, v111
    v_cvt_pk_bf16_f32 v94, v108, v109
    v_cvt_pk_bf16_f32 v95, v110, v111
    v_mfma_f32_32x32x16_bf16 v[96:111], a[204:207], v[32:35], v[224:239]
    s_waitcnt vmcnt(28)
    v_exp_f32 v112, v112
    v_exp_f32 v113, v113
    v_exp_f32 v114, v114
    v_mfma_f32_32x32x16_bf16 v[128:143], a[236:239], v[92:95], v[128:143]
    buffer_load_dwordx4 a[200:203], v8, s[20:23], s29 offen offset:3072
    buffer_load_dwordx4 a[216:219], v13, s[20:23], s29 offen offset:3072
    buffer_load_dwordx4 a[232:235], v13, s[20:23], s29 offen offset:3584
    v_cvt_pk_bf16_f32 v88, v112, v113
    v_exp_f32 v115, v115
    v_exp_f32 v116, v116
    v_cvt_pk_bf16_f32 v89, v114, v115
    v_exp_f32 v117, v117
    v_exp_f32 v118, v118
    v_cvt_pk_bf16_f32 v90, v116, v117
    v_exp_f32 v119, v119
    v_exp_f32 v120, v120
    v_cvt_pk_bf16_f32 v91, v118, v119
    v_exp_f32 v121, v121
    v_exp_f32 v122, v122
    v_mfma_f32_32x32x16_bf16 v[144:159], a[220:223], v[88:91], v[144:159]
    s_add_u32 s29, s29, 4096
    v_cvt_pk_bf16_f32 v92, v120, v121
    v_exp_f32 v123, v123
    v_exp_f32 v124, v124
    v_cvt_pk_bf16_f32 v93, v122, v123
    v_exp_f32 v125, v125
    v_exp_f32 v126, v126
    v_exp_f32 v127, v127
    v_cvt_pk_bf16_f32 v94, v124, v125
    v_cvt_pk_bf16_f32 v95, v126, v127
    v_mfma_f32_32x32x16_bf16 v[112:127], a[204:207], v[36:39], v[240:255]
    ds_read_b128 a[12:15], v20 offset:12288
    v_exp_f32 v96, v96
    v_exp_f32 v97, v97
    v_exp_f32 v98, v98
    v_mfma_f32_32x32x16_bf16 v[144:159], a[236:239], v[92:95], v[144:159]
    ds_read_b128 a[28:31], v21 offset:12288
    v_cvt_pk_bf16_f32 v88, v96, v97
    v_exp_f32 v99, v99
    v_exp_f32 v100, v100
    v_cvt_pk_bf16_f32 v89, v98, v99
    v_exp_f32 v101, v101
    v_exp_f32 v102, v102
    v_cvt_pk_bf16_f32 v90, v100, v101
    v_exp_f32 v103, v103
    v_exp_f32 v104, v104
    v_cvt_pk_bf16_f32 v91, v102, v103
    v_exp_f32 v105, v105
    v_exp_f32 v106, v106
    v_mfma_f32_32x32x16_bf16 v[160:175], a[220:223], v[88:91], v[160:175]
    s_waitcnt vmcnt(39)
    v_cvt_pk_bf16_f32 v92, v104, v105
    v_exp_f32 v107, v107
    v_exp_f32 v108, v108
    v_cvt_pk_bf16_f32 v93, v106, v107
    v_exp_f32 v109, v109
    v_exp_f32 v110, v110
    v_exp_f32 v111, v111
    v_cvt_pk_bf16_f32 v94, v108, v109
    v_cvt_pk_bf16_f32 v95, v110, v111
    v_mfma_f32_32x32x16_bf16 v[96:111], v[40:43], v[24:27], v[192:207]
    ds_read_b128 a[44:47], v22 offset:12288
    v_exp_f32 v112, v112
    v_exp_f32 v113, v113
    v_exp_f32 v114, v114
    v_mfma_f32_32x32x16_bf16 v[160:175], a[236:239], v[92:95], v[160:175]
    ds_read_b128 a[60:63], v23 offset:12288
    v_cvt_pk_bf16_f32 v88, v112, v113
    v_exp_f32 v115, v115
    v_exp_f32 v116, v116
    v_cvt_pk_bf16_f32 v89, v114, v115
    v_exp_f32 v117, v117
    v_exp_f32 v118, v118
    v_cvt_pk_bf16_f32 v90, v116, v117
    v_exp_f32 v119, v119
    v_exp_f32 v120, v120
    v_cvt_pk_bf16_f32 v91, v118, v119
    v_exp_f32 v121, v121
    v_exp_f32 v122, v122
    v_mfma_f32_32x32x16_bf16 v[176:191], a[220:223], v[88:91], v[176:191]
    s_add_u32 m0, s42, 6144
    v_cvt_pk_bf16_f32 v92, v120, v121
    v_exp_f32 v123, v123
    v_exp_f32 v124, v124
    v_cvt_pk_bf16_f32 v93, v122, v123
    v_exp_f32 v125, v125
    v_exp_f32 v126, v126
    v_exp_f32 v127, v127
    v_cvt_pk_bf16_f32 v94, v124, v125
    v_cvt_pk_bf16_f32 v95, v126, v127
    v_mfma_f32_32x32x16_bf16 v[112:127], v[40:43], v[28:31], v[208:223]
    s_xor_b32 s28, s41, 49152
    v_exp_f32 v96, v96
    v_exp_f32 v97, v97
    v_exp_f32 v98, v98
    v_mfma_f32_32x32x16_bf16 v[176:191], a[236:239], v[92:95], v[176:191]
    buffer_load_dwordx4 v19, s[56:59], s28 offen lds
    v_cvt_pk_bf16_f32 v88, v96, v97
    v_exp_f32 v99, v99
    v_exp_f32 v100, v100
    v_cvt_pk_bf16_f32 v89, v98, v99
    v_exp_f32 v101, v101
    v_exp_f32 v102, v102
    v_cvt_pk_bf16_f32 v90, v100, v101
    v_exp_f32 v103, v103
    v_exp_f32 v104, v104
    v_cvt_pk_bf16_f32 v91, v102, v103
    v_exp_f32 v105, v105
    v_exp_f32 v106, v106
    v_mfma_f32_32x32x16_bf16 v[128:143], v[56:59], v[88:91], v[128:143]
    v_cvt_pk_bf16_f32 v92, v104, v105
    v_exp_f32 v107, v107
    v_exp_f32 v108, v108
    v_cvt_pk_bf16_f32 v93, v106, v107
    v_exp_f32 v109, v109
    v_exp_f32 v110, v110
    v_exp_f32 v111, v111
    v_cvt_pk_bf16_f32 v94, v108, v109
    v_cvt_pk_bf16_f32 v95, v110, v111
    v_mfma_f32_32x32x16_bf16 v[96:111], v[40:43], v[32:35], v[224:239]
    v_exp_f32 v112, v112
    v_exp_f32 v113, v113
    v_exp_f32 v114, v114
    v_mfma_f32_32x32x16_bf16 v[128:143], v[72:75], v[92:95], v[128:143]
    buffer_load_dwordx4 a[204:207], v8, s[20:23], s29 offen offset:0
    buffer_load_dwordx4 a[220:223], v13, s[20:23], s29 offen offset:0
    buffer_load_dwordx4 a[236:239], v13, s[20:23], s29 offen offset:512
    v_cvt_pk_bf16_f32 v88, v112, v113
    v_exp_f32 v115, v115
    v_exp_f32 v116, v116
    v_cvt_pk_bf16_f32 v89, v114, v115
    v_exp_f32 v117, v117
    v_exp_f32 v118, v118
    v_cvt_pk_bf16_f32 v90, v116, v117
    v_exp_f32 v119, v119
    v_exp_f32 v120, v120
    v_cvt_pk_bf16_f32 v91, v118, v119
    v_exp_f32 v121, v121
    v_exp_f32 v122, v122
    v_mfma_f32_32x32x16_bf16 v[144:159], v[56:59], v[88:91], v[144:159]
    s_waitcnt lgkmcnt(0)
    v_cvt_pk_bf16_f32 v92, v120, v121
    v_exp_f32 v123, v123
    v_exp_f32 v124, v124
    v_cvt_pk_bf16_f32 v93, v122, v123
    v_exp_f32 v125, v125
    v_exp_f32 v126, v126
    v_exp_f32 v127, v127
    v_cvt_pk_bf16_f32 v94, v124, v125
    v_cvt_pk_bf16_f32 v95, v126, v127
    v_mfma_f32_32x32x16_bf16 v[112:127], v[40:43], v[36:39], v[240:255]
    s_xor_b32 s37, s38, 196864
    v_exp_f32 v96, v96
    v_exp_f32 v97, v97
    v_exp_f32 v98, v98
    v_mfma_f32_32x32x16_bf16 v[144:159], v[72:75], v[92:95], v[144:159]
    s_add_u32 m0, s39, 12288
    v_cvt_pk_bf16_f32 v88, v96, v97
    v_exp_f32 v99, v99
    v_exp_f32 v100, v100
    v_cvt_pk_bf16_f32 v89, v98, v99
    v_exp_f32 v101, v101
    v_exp_f32 v102, v102
    v_cvt_pk_bf16_f32 v90, v100, v101
    v_exp_f32 v103, v103
    v_exp_f32 v104, v104
    v_cvt_pk_bf16_f32 v91, v102, v103
    v_exp_f32 v105, v105
    v_exp_f32 v106, v106
    v_mfma_f32_32x32x16_bf16 v[160:175], v[56:59], v[88:91], v[160:175]
    s_waitcnt vmcnt(39)
    v_cvt_pk_bf16_f32 v92, v104, v105
    v_exp_f32 v107, v107
    v_exp_f32 v108, v108
    v_cvt_pk_bf16_f32 v93, v106, v107
    v_exp_f32 v109, v109
    v_exp_f32 v110, v110
    v_exp_f32 v111, v111
    v_cvt_pk_bf16_f32 v94, v108, v109
    v_cvt_pk_bf16_f32 v95, v110, v111
    v_mfma_f32_32x32x16_bf16 v[96:111], v[44:47], v[24:27], v[192:207]
    buffer_load_dwordx4 v15, s[24:27], s37 offen offset:0 lds
    buffer_load_dwordx4 v16, s[24:27], s37 offen offset:1024 lds
    buffer_load_dwordx4 v17, s[24:27], s37 offen offset:2048 lds
    buffer_load_dwordx4 v18, s[24:27], s37 offen offset:3072 lds
    v_exp_f32 v112, v112
    v_exp_f32 v113, v113
    v_exp_f32 v114, v114
    v_mfma_f32_32x32x16_bf16 v[160:175], v[72:75], v[92:95], v[160:175]
    v_cvt_pk_bf16_f32 v88, v112, v113
    v_exp_f32 v115, v115
    v_exp_f32 v116, v116
    v_cvt_pk_bf16_f32 v89, v114, v115
    v_exp_f32 v117, v117
    v_exp_f32 v118, v118
    v_cvt_pk_bf16_f32 v90, v116, v117
    v_exp_f32 v119, v119
    v_exp_f32 v120, v120
    v_cvt_pk_bf16_f32 v91, v118, v119
    v_exp_f32 v121, v121
    v_exp_f32 v122, v122
    v_mfma_f32_32x32x16_bf16 v[176:191], v[56:59], v[88:91], v[176:191]
    s_waitcnt vmcnt(30)
    v_cvt_pk_bf16_f32 v92, v120, v121
    v_exp_f32 v123, v123
    v_exp_f32 v124, v124
    v_cvt_pk_bf16_f32 v93, v122, v123
    v_exp_f32 v125, v125
    v_exp_f32 v126, v126
    v_exp_f32 v127, v127
    v_cvt_pk_bf16_f32 v94, v124, v125
    v_cvt_pk_bf16_f32 v95, v126, v127
    v_mfma_f32_32x32x16_bf16 v[112:127], v[44:47], v[28:31], v[208:223]
    ds_read_b128 a[64:67], v20 offset:0
    v_exp_f32 v96, v96
    v_exp_f32 v97, v97
    v_exp_f32 v98, v98
    v_mfma_f32_32x32x16_bf16 v[176:191], v[72:75], v[92:95], v[176:191]
    ds_read_b128 a[80:83], v21 offset:0
    v_cvt_pk_bf16_f32 v88, v96, v97
    v_exp_f32 v99, v99
    v_exp_f32 v100, v100
    v_cvt_pk_bf16_f32 v89, v98, v99
    v_exp_f32 v101, v101
    v_exp_f32 v102, v102
    v_cvt_pk_bf16_f32 v90, v100, v101
    v_exp_f32 v103, v103
    v_exp_f32 v104, v104
    v_cvt_pk_bf16_f32 v91, v102, v103
    v_exp_f32 v105, v105
    v_exp_f32 v106, v106
    v_mfma_f32_32x32x16_bf16 v[128:143], v[60:63], v[88:91], v[128:143]
    ds_read_b128 a[96:99], v22 offset:0
    v_cvt_pk_bf16_f32 v92, v104, v105
    v_exp_f32 v107, v107
    v_exp_f32 v108, v108
    v_cvt_pk_bf16_f32 v93, v106, v107
    v_exp_f32 v109, v109
    v_exp_f32 v110, v110
    v_exp_f32 v111, v111
    v_cvt_pk_bf16_f32 v94, v108, v109
    v_cvt_pk_bf16_f32 v95, v110, v111
    v_mfma_f32_32x32x16_bf16 v[96:111], v[44:47], v[32:35], v[224:239]
    ds_read_b128 a[112:115], v23 offset:0
    v_exp_f32 v112, v112
    v_exp_f32 v113, v113
    v_exp_f32 v114, v114
    v_mfma_f32_32x32x16_bf16 v[128:143], v[76:79], v[92:95], v[128:143]
    buffer_load_dwordx4 v[40:43], v8, s[20:23], s29 offen offset:1024
    buffer_load_dwordx4 v[56:59], v13, s[20:23], s29 offen offset:1024
    buffer_load_dwordx4 v[72:75], v13, s[20:23], s29 offen offset:1536
    v_cvt_pk_bf16_f32 v88, v112, v113
    v_exp_f32 v115, v115
    v_exp_f32 v116, v116
    v_cvt_pk_bf16_f32 v89, v114, v115
    v_exp_f32 v117, v117
    v_exp_f32 v118, v118
    v_cvt_pk_bf16_f32 v90, v116, v117
    v_exp_f32 v119, v119
    v_exp_f32 v120, v120
    v_cvt_pk_bf16_f32 v91, v118, v119
    v_exp_f32 v121, v121
    v_exp_f32 v122, v122
    v_mfma_f32_32x32x16_bf16 v[144:159], v[60:63], v[88:91], v[144:159]
    s_add_u32 m0, s42, 7168
    v_cvt_pk_bf16_f32 v92, v120, v121
    v_exp_f32 v123, v123
    v_exp_f32 v124, v124
    v_cvt_pk_bf16_f32 v93, v122, v123
    v_exp_f32 v125, v125
    v_exp_f32 v126, v126
    v_exp_f32 v127, v127
    v_cvt_pk_bf16_f32 v94, v124, v125
    v_cvt_pk_bf16_f32 v95, v126, v127
    v_mfma_f32_32x32x16_bf16 v[112:127], v[44:47], v[36:39], v[240:255]
    s_xor_b32 s28, s41, 57344
    v_exp_f32 v96, v96
    v_exp_f32 v97, v97
    v_exp_f32 v98, v98
    v_mfma_f32_32x32x16_bf16 v[144:159], v[76:79], v[92:95], v[144:159]
    buffer_load_dwordx4 v19, s[56:59], s28 offen lds
    v_cvt_pk_bf16_f32 v88, v96, v97
    v_exp_f32 v99, v99
    v_exp_f32 v100, v100
    v_cvt_pk_bf16_f32 v89, v98, v99
    v_exp_f32 v101, v101
    v_exp_f32 v102, v102
    v_cvt_pk_bf16_f32 v90, v100, v101
    v_exp_f32 v103, v103
    v_exp_f32 v104, v104
    v_cvt_pk_bf16_f32 v91, v102, v103
    v_exp_f32 v105, v105
    v_exp_f32 v106, v106
    v_mfma_f32_32x32x16_bf16 v[160:175], v[60:63], v[88:91], v[160:175]
    s_waitcnt vmcnt(40)
    v_cvt_pk_bf16_f32 v92, v104, v105
    v_exp_f32 v107, v107
    v_exp_f32 v108, v108
    v_cvt_pk_bf16_f32 v93, v106, v107
    v_exp_f32 v109, v109
    v_exp_f32 v110, v110
    v_exp_f32 v111, v111
    v_cvt_pk_bf16_f32 v94, v108, v109
    v_cvt_pk_bf16_f32 v95, v110, v111
    v_mfma_f32_32x32x16_bf16 v[96:111], v[48:51], v[24:27], v[192:207]
    v_exp_f32 v112, v112
    v_exp_f32 v113, v113
    v_exp_f32 v114, v114
    v_mfma_f32_32x32x16_bf16 v[160:175], v[76:79], v[92:95], v[160:175]
    v_cvt_pk_bf16_f32 v88, v112, v113
    v_exp_f32 v115, v115
    v_exp_f32 v116, v116
    v_cvt_pk_bf16_f32 v89, v114, v115
    v_exp_f32 v117, v117
    v_exp_f32 v118, v118
    v_cvt_pk_bf16_f32 v90, v116, v117
    v_exp_f32 v119, v119
    v_exp_f32 v120, v120
    v_cvt_pk_bf16_f32 v91, v118, v119
    v_exp_f32 v121, v121
    v_exp_f32 v122, v122
    v_mfma_f32_32x32x16_bf16 v[176:191], v[60:63], v[88:91], v[176:191]
    v_cvt_pk_bf16_f32 v92, v120, v121
    v_exp_f32 v123, v123
    v_exp_f32 v124, v124
    v_cvt_pk_bf16_f32 v93, v122, v123
    v_exp_f32 v125, v125
    v_exp_f32 v126, v126
    v_exp_f32 v127, v127
    v_cvt_pk_bf16_f32 v94, v124, v125
    v_cvt_pk_bf16_f32 v95, v126, v127
    v_mfma_f32_32x32x16_bf16 v[112:127], v[48:51], v[28:31], v[208:223]
    s_waitcnt lgkmcnt(0)
    v_exp_f32 v96, v96
    v_exp_f32 v97, v97
    v_exp_f32 v98, v98
    v_mfma_f32_32x32x16_bf16 v[176:191], v[76:79], v[92:95], v[176:191]
    s_xor_b32 s37, s38, 512
    v_cvt_pk_bf16_f32 v88, v96, v97
    v_exp_f32 v99, v99
    v_exp_f32 v100, v100
    v_cvt_pk_bf16_f32 v89, v98, v99
    v_exp_f32 v101, v101
    v_exp_f32 v102, v102
    v_cvt_pk_bf16_f32 v90, v100, v101
    v_exp_f32 v103, v103
    v_exp_f32 v104, v104
    v_cvt_pk_bf16_f32 v91, v102, v103
    v_exp_f32 v105, v105
    v_exp_f32 v106, v106
    v_mfma_f32_32x32x16_bf16 v[128:143], v[64:67], v[88:91], v[128:143]
    s_add_u32 m0, s39, 0
    v_cvt_pk_bf16_f32 v92, v104, v105
    v_exp_f32 v107, v107
    v_exp_f32 v108, v108
    v_cvt_pk_bf16_f32 v93, v106, v107
    v_exp_f32 v109, v109
    v_exp_f32 v110, v110
    v_exp_f32 v111, v111
    v_cvt_pk_bf16_f32 v94, v108, v109
    v_cvt_pk_bf16_f32 v95, v110, v111
    v_mfma_f32_32x32x16_bf16 v[96:111], v[48:51], v[32:35], v[224:239]
    buffer_load_dwordx4 v15, s[24:27], s37 offen offset:0 lds
    buffer_load_dwordx4 v16, s[24:27], s37 offen offset:1024 lds
    buffer_load_dwordx4 v17, s[24:27], s37 offen offset:2048 lds
    buffer_load_dwordx4 v18, s[24:27], s37 offen offset:3072 lds
    v_exp_f32 v112, v112
    v_exp_f32 v113, v113
    v_exp_f32 v114, v114
    v_mfma_f32_32x32x16_bf16 v[128:143], v[80:83], v[92:95], v[128:143]
    buffer_load_dwordx4 v[44:47], v8, s[20:23], s29 offen offset:2048
    buffer_load_dwordx4 v[60:63], v13, s[20:23], s29 offen offset:2048
    buffer_load_dwordx4 v[76:79], v13, s[20:23], s29 offen offset:2560
    v_cvt_pk_bf16_f32 v88, v112, v113
    v_exp_f32 v115, v115
    v_exp_f32 v116, v116
    v_cvt_pk_bf16_f32 v89, v114, v115
    v_exp_f32 v117, v117
    v_exp_f32 v118, v118
    v_cvt_pk_bf16_f32 v90, v116, v117
    v_exp_f32 v119, v119
    v_exp_f32 v120, v120
    v_cvt_pk_bf16_f32 v91, v118, v119
    v_exp_f32 v121, v121
    v_exp_f32 v122, v122
    v_mfma_f32_32x32x16_bf16 v[144:159], v[64:67], v[88:91], v[144:159]
    s_waitcnt vmcnt(30)
    v_cvt_pk_bf16_f32 v92, v120, v121
    v_exp_f32 v123, v123
    v_exp_f32 v124, v124
    v_cvt_pk_bf16_f32 v93, v122, v123
    v_exp_f32 v125, v125
    v_exp_f32 v126, v126
    v_exp_f32 v127, v127
    v_cvt_pk_bf16_f32 v94, v124, v125
    v_cvt_pk_bf16_f32 v95, v126, v127
    v_mfma_f32_32x32x16_bf16 v[112:127], v[48:51], v[36:39], v[240:255]
    ds_read_b128 a[132:135], v20 offset:4096
    v_exp_f32 v96, v96
    v_exp_f32 v97, v97
    v_exp_f32 v98, v98
    v_mfma_f32_32x32x16_bf16 v[144:159], v[80:83], v[92:95], v[144:159]
    ds_read_b128 a[148:151], v21 offset:4096
    v_cvt_pk_bf16_f32 v88, v96, v97
    v_exp_f32 v99, v99
    v_exp_f32 v100, v100
    v_cvt_pk_bf16_f32 v89, v98, v99
    v_exp_f32 v101, v101
    v_exp_f32 v102, v102
    v_cvt_pk_bf16_f32 v90, v100, v101
    v_exp_f32 v103, v103
    v_exp_f32 v104, v104
    v_cvt_pk_bf16_f32 v91, v102, v103
    v_exp_f32 v105, v105
    v_exp_f32 v106, v106
    v_mfma_f32_32x32x16_bf16 v[160:175], v[64:67], v[88:91], v[160:175]
    s_waitcnt vmcnt(38)
    v_cvt_pk_bf16_f32 v92, v104, v105
    v_exp_f32 v107, v107
    v_exp_f32 v108, v108
    v_cvt_pk_bf16_f32 v93, v106, v107
    v_exp_f32 v109, v109
    v_exp_f32 v110, v110
    v_exp_f32 v111, v111
    v_cvt_pk_bf16_f32 v94, v108, v109
    v_cvt_pk_bf16_f32 v95, v110, v111
    v_mfma_f32_32x32x16_bf16 v[96:111], v[52:55], v[24:27], v[192:207]
    ds_read_b128 a[164:167], v22 offset:4096
    v_exp_f32 v112, v112
    v_exp_f32 v113, v113
    v_exp_f32 v114, v114
    v_mfma_f32_32x32x16_bf16 v[160:175], v[80:83], v[92:95], v[160:175]
    ds_read_b128 a[180:183], v23 offset:4096
    v_cvt_pk_bf16_f32 v88, v112, v113
    v_exp_f32 v115, v115
    v_exp_f32 v116, v116
    v_cvt_pk_bf16_f32 v89, v114, v115
    v_exp_f32 v117, v117
    v_exp_f32 v118, v118
    v_cvt_pk_bf16_f32 v90, v116, v117
    v_exp_f32 v119, v119
    v_exp_f32 v120, v120
    v_cvt_pk_bf16_f32 v91, v118, v119
    v_exp_f32 v121, v121
    v_exp_f32 v122, v122
    v_mfma_f32_32x32x16_bf16 v[176:191], v[64:67], v[88:91], v[176:191]
    s_add_u32 m0, s42, 8192
    v_cvt_pk_bf16_f32 v92, v120, v121
    v_exp_f32 v123, v123
    v_exp_f32 v124, v124
    v_cvt_pk_bf16_f32 v93, v122, v123
    v_exp_f32 v125, v125
    v_exp_f32 v126, v126
    v_exp_f32 v127, v127
    v_cvt_pk_bf16_f32 v94, v124, v125
    v_cvt_pk_bf16_f32 v95, v126, v127
    v_mfma_f32_32x32x16_bf16 v[112:127], v[52:55], v[28:31], v[208:223]
    s_xor_b32 s28, s41, 65536
    v_exp_f32 v96, v96
    v_exp_f32 v97, v97
    v_exp_f32 v98, v98
    v_mfma_f32_32x32x16_bf16 v[176:191], v[80:83], v[92:95], v[176:191]
    buffer_load_dwordx4 v19, s[56:59], s28 offen lds
    v_cvt_pk_bf16_f32 v88, v96, v97
    v_exp_f32 v99, v99
    v_exp_f32 v100, v100
    v_cvt_pk_bf16_f32 v89, v98, v99
    v_exp_f32 v101, v101
    v_exp_f32 v102, v102
    v_cvt_pk_bf16_f32 v90, v100, v101
    v_exp_f32 v103, v103
    v_exp_f32 v104, v104
    v_cvt_pk_bf16_f32 v91, v102, v103
    v_exp_f32 v105, v105
    v_exp_f32 v106, v106
    v_mfma_f32_32x32x16_bf16 v[128:143], v[68:71], v[88:91], v[128:143]
    v_cvt_pk_bf16_f32 v92, v104, v105
    v_exp_f32 v107, v107
    v_exp_f32 v108, v108
    v_cvt_pk_bf16_f32 v93, v106, v107
    v_exp_f32 v109, v109
    v_exp_f32 v110, v110
    v_exp_f32 v111, v111
    v_cvt_pk_bf16_f32 v94, v108, v109
    v_cvt_pk_bf16_f32 v95, v110, v111
    v_mfma_f32_32x32x16_bf16 v[96:111], v[52:55], v[32:35], v[224:239]
    v_exp_f32 v112, v112
    v_exp_f32 v113, v113
    v_exp_f32 v114, v114
    v_mfma_f32_32x32x16_bf16 v[128:143], v[84:87], v[92:95], v[128:143]
    buffer_load_dwordx4 v[48:51], v8, s[20:23], s29 offen offset:3072
    buffer_load_dwordx4 v[64:67], v13, s[20:23], s29 offen offset:3072
    buffer_load_dwordx4 v[80:83], v13, s[20:23], s29 offen offset:3584
    v_cvt_pk_bf16_f32 v88, v112, v113
    v_exp_f32 v115, v115
    v_exp_f32 v116, v116
    v_cvt_pk_bf16_f32 v89, v114, v115
    v_exp_f32 v117, v117
    v_exp_f32 v118, v118
    v_cvt_pk_bf16_f32 v90, v116, v117
    v_exp_f32 v119, v119
    v_exp_f32 v120, v120
    v_cvt_pk_bf16_f32 v91, v118, v119
    v_exp_f32 v121, v121
    v_exp_f32 v122, v122
    v_mfma_f32_32x32x16_bf16 v[144:159], v[68:71], v[88:91], v[144:159]
    s_add_u32 s29, s29, 4096
    v_cvt_pk_bf16_f32 v92, v120, v121
    v_exp_f32 v123, v123
    v_exp_f32 v124, v124
    v_cvt_pk_bf16_f32 v93, v122, v123
    v_exp_f32 v125, v125
    v_exp_f32 v126, v126
    v_exp_f32 v127, v127
    v_cvt_pk_bf16_f32 v94, v124, v125
    v_cvt_pk_bf16_f32 v95, v126, v127
    v_mfma_f32_32x32x16_bf16 v[112:127], v[52:55], v[36:39], v[240:255]
    s_waitcnt lgkmcnt(0)
    v_exp_f32 v96, v96
    v_exp_f32 v97, v97
    v_exp_f32 v98, v98
    v_mfma_f32_32x32x16_bf16 v[144:159], v[84:87], v[92:95], v[144:159]
    s_xor_b32 s37, s38, 65536
    v_cvt_pk_bf16_f32 v88, v96, v97
    v_exp_f32 v99, v99
    v_exp_f32 v100, v100
    v_cvt_pk_bf16_f32 v89, v98, v99
    v_exp_f32 v101, v101
    v_exp_f32 v102, v102
    v_cvt_pk_bf16_f32 v90, v100, v101
    v_exp_f32 v103, v103
    v_exp_f32 v104, v104
    v_cvt_pk_bf16_f32 v91, v102, v103
    v_exp_f32 v105, v105
    v_exp_f32 v106, v106
    v_mfma_f32_32x32x16_bf16 v[160:175], v[68:71], v[88:91], v[160:175]
    s_waitcnt vmcnt(38)
    v_cvt_pk_bf16_f32 v92, v104, v105
    v_exp_f32 v107, v107
    v_exp_f32 v108, v108
    v_cvt_pk_bf16_f32 v93, v106, v107
    v_exp_f32 v109, v109
    v_exp_f32 v110, v110
    v_exp_f32 v111, v111
    v_cvt_pk_bf16_f32 v94, v108, v109
    v_cvt_pk_bf16_f32 v95, v110, v111
    v_mfma_f32_32x32x16_bf16 v[96:111], a[192:195], v[24:27], v[192:207]
    s_add_u32 m0, s39, 4096
    v_exp_f32 v112, v112
    v_exp_f32 v113, v113
    v_exp_f32 v114, v114
    v_mfma_f32_32x32x16_bf16 v[160:175], v[84:87], v[92:95], v[160:175]
    buffer_load_dwordx4 v15, s[24:27], s37 offen offset:0 lds
    buffer_load_dwordx4 v16, s[24:27], s37 offen offset:1024 lds
    buffer_load_dwordx4 v17, s[24:27], s37 offen offset:2048 lds
    buffer_load_dwordx4 v18, s[24:27], s37 offen offset:3072 lds
    v_cvt_pk_bf16_f32 v88, v112, v113
    v_exp_f32 v115, v115
    v_exp_f32 v116, v116
    v_cvt_pk_bf16_f32 v89, v114, v115
    v_exp_f32 v117, v117
    v_exp_f32 v118, v118
    v_cvt_pk_bf16_f32 v90, v116, v117
    v_exp_f32 v119, v119
    v_exp_f32 v120, v120
    v_cvt_pk_bf16_f32 v91, v118, v119
    v_exp_f32 v121, v121
    v_exp_f32 v122, v122
    v_mfma_f32_32x32x16_bf16 v[176:191], v[68:71], v[88:91], v[176:191]
    v_cvt_pk_bf16_f32 v92, v120, v121
    v_exp_f32 v123, v123
    v_exp_f32 v124, v124
    v_cvt_pk_bf16_f32 v93, v122, v123
    v_exp_f32 v125, v125
    v_exp_f32 v126, v126
    v_exp_f32 v127, v127
    v_cvt_pk_bf16_f32 v94, v124, v125
    v_cvt_pk_bf16_f32 v95, v126, v127
    v_mfma_f32_32x32x16_bf16 v[112:127], a[192:195], v[28:31], v[208:223]
    s_waitcnt vmcnt(30)
    v_exp_f32 v96, v96
    v_exp_f32 v97, v97
    v_exp_f32 v98, v98
    v_mfma_f32_32x32x16_bf16 v[176:191], v[84:87], v[92:95], v[176:191]
    ds_read_b128 a[8:11], v20 offset:8192
    v_cvt_pk_bf16_f32 v88, v96, v97
    v_exp_f32 v99, v99
    v_exp_f32 v100, v100
    v_cvt_pk_bf16_f32 v89, v98, v99
    v_exp_f32 v101, v101
    v_exp_f32 v102, v102
    v_cvt_pk_bf16_f32 v90, v100, v101
    v_exp_f32 v103, v103
    v_exp_f32 v104, v104
    v_cvt_pk_bf16_f32 v91, v102, v103
    v_exp_f32 v105, v105
    v_exp_f32 v106, v106
    v_mfma_f32_32x32x16_bf16 v[128:143], a[208:211], v[88:91], v[128:143]
    ds_read_b128 a[24:27], v21 offset:8192
    v_cvt_pk_bf16_f32 v92, v104, v105
    v_exp_f32 v107, v107
    v_exp_f32 v108, v108
    v_cvt_pk_bf16_f32 v93, v106, v107
    v_exp_f32 v109, v109
    v_exp_f32 v110, v110
    v_exp_f32 v111, v111
    v_cvt_pk_bf16_f32 v94, v108, v109
    v_cvt_pk_bf16_f32 v95, v110, v111
    v_mfma_f32_32x32x16_bf16 v[96:111], a[192:195], v[32:35], v[224:239]
    ds_read_b128 a[40:43], v22 offset:8192
    v_exp_f32 v112, v112
    v_exp_f32 v113, v113
    v_exp_f32 v114, v114
    v_mfma_f32_32x32x16_bf16 v[128:143], a[224:227], v[92:95], v[128:143]
    buffer_load_dwordx4 v[52:55], v8, s[20:23], s29 offen offset:0
    buffer_load_dwordx4 v[68:71], v13, s[20:23], s29 offen offset:0
    buffer_load_dwordx4 v[84:87], v13, s[20:23], s29 offen offset:512
    v_cvt_pk_bf16_f32 v88, v112, v113
    v_exp_f32 v115, v115
    v_exp_f32 v116, v116
    v_cvt_pk_bf16_f32 v89, v114, v115
    v_exp_f32 v117, v117
    v_exp_f32 v118, v118
    v_cvt_pk_bf16_f32 v90, v116, v117
    v_exp_f32 v119, v119
    v_exp_f32 v120, v120
    v_cvt_pk_bf16_f32 v91, v118, v119
    v_exp_f32 v121, v121
    v_exp_f32 v122, v122
    v_mfma_f32_32x32x16_bf16 v[144:159], a[208:211], v[88:91], v[144:159]
    ds_read_b128 a[56:59], v23 offset:8192
    v_cvt_pk_bf16_f32 v92, v120, v121
    v_exp_f32 v123, v123
    v_exp_f32 v124, v124
    v_cvt_pk_bf16_f32 v93, v122, v123
    v_exp_f32 v125, v125
    v_exp_f32 v126, v126
    v_exp_f32 v127, v127
    v_cvt_pk_bf16_f32 v94, v124, v125
    v_cvt_pk_bf16_f32 v95, v126, v127
    v_mfma_f32_32x32x16_bf16 v[112:127], a[192:195], v[36:39], v[240:255]
    s_add_u32 m0, s42, 9216
    v_exp_f32 v96, v96
    v_exp_f32 v97, v97
    v_exp_f32 v98, v98
    v_mfma_f32_32x32x16_bf16 v[144:159], a[224:227], v[92:95], v[144:159]
    s_xor_b32 s28, s41, 73728
    v_cvt_pk_bf16_f32 v88, v96, v97
    v_exp_f32 v99, v99
    v_exp_f32 v100, v100
    v_cvt_pk_bf16_f32 v89, v98, v99
    v_exp_f32 v101, v101
    v_exp_f32 v102, v102
    v_cvt_pk_bf16_f32 v90, v100, v101
    v_exp_f32 v103, v103
    v_exp_f32 v104, v104
    v_cvt_pk_bf16_f32 v91, v102, v103
    v_exp_f32 v105, v105
    v_exp_f32 v106, v106
    v_mfma_f32_32x32x16_bf16 v[160:175], a[208:211], v[88:91], v[160:175]
    s_waitcnt vmcnt(38)
    v_cvt_pk_bf16_f32 v92, v104, v105
    v_exp_f32 v107, v107
    v_exp_f32 v108, v108
    v_cvt_pk_bf16_f32 v93, v106, v107
    v_exp_f32 v109, v109
    v_exp_f32 v110, v110
    v_exp_f32 v111, v111
    v_cvt_pk_bf16_f32 v94, v108, v109
    v_cvt_pk_bf16_f32 v95, v110, v111
    v_mfma_f32_32x32x16_bf16 v[96:111], a[196:199], v[24:27], v[192:207]
    buffer_load_dwordx4 v19, s[56:59], s28 offen lds
    v_exp_f32 v112, v112
    v_exp_f32 v113, v113
    v_exp_f32 v114, v114
    v_mfma_f32_32x32x16_bf16 v[160:175], a[224:227], v[92:95], v[160:175]
    v_cvt_pk_bf16_f32 v88, v112, v113
    v_exp_f32 v115, v115
    v_exp_f32 v116, v116
    v_cvt_pk_bf16_f32 v89, v114, v115
    v_exp_f32 v117, v117
    v_exp_f32 v118, v118
    v_cvt_pk_bf16_f32 v90, v116, v117
    v_exp_f32 v119, v119
    v_exp_f32 v120, v120
    v_cvt_pk_bf16_f32 v91, v118, v119
    v_exp_f32 v121, v121
    v_exp_f32 v122, v122
    v_mfma_f32_32x32x16_bf16 v[176:191], a[208:211], v[88:91], v[176:191]
    v_cvt_pk_bf16_f32 v92, v120, v121
    v_exp_f32 v123, v123
    v_exp_f32 v124, v124
    v_cvt_pk_bf16_f32 v93, v122, v123
    v_exp_f32 v125, v125
    v_exp_f32 v126, v126
    v_exp_f32 v127, v127
    v_cvt_pk_bf16_f32 v94, v124, v125
    v_cvt_pk_bf16_f32 v95, v126, v127
    v_mfma_f32_32x32x16_bf16 v[112:127], a[196:199], v[28:31], v[208:223]
    v_exp_f32 v96, v96
    v_exp_f32 v97, v97
    v_exp_f32 v98, v98
    v_mfma_f32_32x32x16_bf16 v[176:191], a[224:227], v[92:95], v[176:191]
    v_cvt_pk_bf16_f32 v88, v96, v97
    v_exp_f32 v99, v99
    v_exp_f32 v100, v100
    v_cvt_pk_bf16_f32 v89, v98, v99
    v_exp_f32 v101, v101
    v_exp_f32 v102, v102
    v_cvt_pk_bf16_f32 v90, v100, v101
    v_exp_f32 v103, v103
    v_exp_f32 v104, v104
    v_cvt_pk_bf16_f32 v91, v102, v103
    v_exp_f32 v105, v105
    v_exp_f32 v106, v106
    v_mfma_f32_32x32x16_bf16 v[128:143], a[212:215], v[88:91], v[128:143]
    s_waitcnt lgkmcnt(0)
    v_cvt_pk_bf16_f32 v92, v104, v105
    v_exp_f32 v107, v107
    v_exp_f32 v108, v108
    v_cvt_pk_bf16_f32 v93, v106, v107
    v_exp_f32 v109, v109
    v_exp_f32 v110, v110
    v_exp_f32 v111, v111
    v_cvt_pk_bf16_f32 v94, v108, v109
    v_cvt_pk_bf16_f32 v95, v110, v111
    v_mfma_f32_32x32x16_bf16 v[96:111], a[196:199], v[32:35], v[224:239]
    s_xor_b32 s37, s38, 131328
    v_exp_f32 v112, v112
    v_exp_f32 v113, v113
    v_exp_f32 v114, v114
    v_mfma_f32_32x32x16_bf16 v[128:143], a[228:231], v[92:95], v[128:143]
    buffer_load_dwordx4 a[192:195], v8, s[20:23], s29 offen offset:1024
    buffer_load_dwordx4 a[208:211], v13, s[20:23], s29 offen offset:1024
    buffer_load_dwordx4 a[224:227], v13, s[20:23], s29 offen offset:1536
    v_cvt_pk_bf16_f32 v88, v112, v113
    v_exp_f32 v115, v115
    v_exp_f32 v116, v116
    v_cvt_pk_bf16_f32 v89, v114, v115
    v_exp_f32 v117, v117
    v_exp_f32 v118, v118
    v_cvt_pk_bf16_f32 v90, v116, v117
    v_exp_f32 v119, v119
    v_exp_f32 v120, v120
    v_cvt_pk_bf16_f32 v91, v118, v119
    v_exp_f32 v121, v121
    v_exp_f32 v122, v122
    v_mfma_f32_32x32x16_bf16 v[144:159], a[212:215], v[88:91], v[144:159]
    s_add_u32 m0, s39, 8192
    v_cvt_pk_bf16_f32 v92, v120, v121
    v_exp_f32 v123, v123
    v_exp_f32 v124, v124
    v_cvt_pk_bf16_f32 v93, v122, v123
    v_exp_f32 v125, v125
    v_exp_f32 v126, v126
    v_exp_f32 v127, v127
    v_cvt_pk_bf16_f32 v94, v124, v125
    v_cvt_pk_bf16_f32 v95, v126, v127
    v_mfma_f32_32x32x16_bf16 v[112:127], a[196:199], v[36:39], v[240:255]
    buffer_load_dwordx4 v15, s[24:27], s37 offen offset:0 lds
    buffer_load_dwordx4 v16, s[24:27], s37 offen offset:1024 lds
    buffer_load_dwordx4 v17, s[24:27], s37 offen offset:2048 lds
    buffer_load_dwordx4 v18, s[24:27], s37 offen offset:3072 lds
    v_exp_f32 v96, v96
    v_exp_f32 v97, v97
    v_exp_f32 v98, v98
    v_mfma_f32_32x32x16_bf16 v[144:159], a[228:231], v[92:95], v[144:159]
    s_waitcnt vmcnt(30)
    v_cvt_pk_bf16_f32 v88, v96, v97
    v_exp_f32 v99, v99
    v_exp_f32 v100, v100
    v_cvt_pk_bf16_f32 v89, v98, v99
    v_exp_f32 v101, v101
    v_exp_f32 v102, v102
    v_cvt_pk_bf16_f32 v90, v100, v101
    v_exp_f32 v103, v103
    v_exp_f32 v104, v104
    v_cvt_pk_bf16_f32 v91, v102, v103
    v_exp_f32 v105, v105
    v_exp_f32 v106, v106
    v_mfma_f32_32x32x16_bf16 v[160:175], a[212:215], v[88:91], v[160:175]
    s_waitcnt vmcnt(38)
    v_cvt_pk_bf16_f32 v92, v104, v105
    v_exp_f32 v107, v107
    v_exp_f32 v108, v108
    v_cvt_pk_bf16_f32 v93, v106, v107
    v_exp_f32 v109, v109
    v_exp_f32 v110, v110
    v_exp_f32 v111, v111
    v_cvt_pk_bf16_f32 v94, v108, v109
    v_cvt_pk_bf16_f32 v95, v110, v111
    v_mfma_f32_32x32x16_bf16 v[96:111], a[200:203], v[24:27], v[192:207]
    ds_read_b128 a[76:79], v20 offset:12288
    v_exp_f32 v112, v112
    v_exp_f32 v113, v113
    v_exp_f32 v114, v114
    v_mfma_f32_32x32x16_bf16 v[160:175], a[228:231], v[92:95], v[160:175]
    ds_read_b128 a[92:95], v21 offset:12288
    v_cvt_pk_bf16_f32 v88, v112, v113
    v_exp_f32 v115, v115
    v_exp_f32 v116, v116
    v_cvt_pk_bf16_f32 v89, v114, v115
    v_exp_f32 v117, v117
    v_exp_f32 v118, v118
    v_cvt_pk_bf16_f32 v90, v116, v117
    v_exp_f32 v119, v119
    v_exp_f32 v120, v120
    v_cvt_pk_bf16_f32 v91, v118, v119
    v_exp_f32 v121, v121
    v_exp_f32 v122, v122
    v_mfma_f32_32x32x16_bf16 v[176:191], a[212:215], v[88:91], v[176:191]
    ds_read_b128 a[108:111], v22 offset:12288
    v_cvt_pk_bf16_f32 v92, v120, v121
    v_exp_f32 v123, v123
    v_exp_f32 v124, v124
    v_cvt_pk_bf16_f32 v93, v122, v123
    v_exp_f32 v125, v125
    v_exp_f32 v126, v126
    v_exp_f32 v127, v127
    v_cvt_pk_bf16_f32 v94, v124, v125
    v_cvt_pk_bf16_f32 v95, v126, v127
    v_mfma_f32_32x32x16_bf16 v[112:127], a[200:203], v[28:31], v[208:223]
    ds_read_b128 a[124:127], v23 offset:12288
    v_exp_f32 v96, v96
    v_exp_f32 v97, v97
    v_exp_f32 v98, v98
    v_mfma_f32_32x32x16_bf16 v[176:191], a[228:231], v[92:95], v[176:191]
    s_add_u32 m0, s42, 10240
    v_cvt_pk_bf16_f32 v88, v96, v97
    v_exp_f32 v99, v99
    v_exp_f32 v100, v100
    v_cvt_pk_bf16_f32 v89, v98, v99
    v_exp_f32 v101, v101
    v_exp_f32 v102, v102
    v_cvt_pk_bf16_f32 v90, v100, v101
    v_exp_f32 v103, v103
    v_exp_f32 v104, v104
    v_cvt_pk_bf16_f32 v91, v102, v103
    v_exp_f32 v105, v105
    v_exp_f32 v106, v106
    v_mfma_f32_32x32x16_bf16 v[128:143], a[216:219], v[88:91], v[128:143]
    s_xor_b32 s28, s41, 81920
    v_cvt_pk_bf16_f32 v92, v104, v105
    v_exp_f32 v107, v107
    v_exp_f32 v108, v108
    v_cvt_pk_bf16_f32 v93, v106, v107
    v_exp_f32 v109, v109
    v_exp_f32 v110, v110
    v_exp_f32 v111, v111
    v_cvt_pk_bf16_f32 v94, v108, v109
    v_cvt_pk_bf16_f32 v95, v110, v111
    v_mfma_f32_32x32x16_bf16 v[96:111], a[200:203], v[32:35], v[224:239]
    buffer_load_dwordx4 v19, s[56:59], s28 offen lds
    v_exp_f32 v112, v112
    v_exp_f32 v113, v113
    v_exp_f32 v114, v114
    v_mfma_f32_32x32x16_bf16 v[128:143], a[232:235], v[92:95], v[128:143]
    buffer_load_dwordx4 a[196:199], v8, s[20:23], s29 offen offset:2048
    buffer_load_dwordx4 a[212:215], v13, s[20:23], s29 offen offset:2048
    buffer_load_dwordx4 a[228:231], v13, s[20:23], s29 offen offset:2560
    v_cvt_pk_bf16_f32 v88, v112, v113
    v_exp_f32 v115, v115
    v_exp_f32 v116, v116
    v_cvt_pk_bf16_f32 v89, v114, v115
    v_exp_f32 v117, v117
    v_exp_f32 v118, v118
    v_cvt_pk_bf16_f32 v90, v116, v117
    v_exp_f32 v119, v119
    v_exp_f32 v120, v120
    v_cvt_pk_bf16_f32 v91, v118, v119
    v_exp_f32 v121, v121
    v_exp_f32 v122, v122
    v_mfma_f32_32x32x16_bf16 v[144:159], a[216:219], v[88:91], v[144:159]
    v_cvt_pk_bf16_f32 v92, v120, v121
    v_exp_f32 v123, v123
    v_exp_f32 v124, v124
    v_cvt_pk_bf16_f32 v93, v122, v123
    v_exp_f32 v125, v125
    v_exp_f32 v126, v126
    v_exp_f32 v127, v127
    v_cvt_pk_bf16_f32 v94, v124, v125
    v_cvt_pk_bf16_f32 v95, v126, v127
    v_mfma_f32_32x32x16_bf16 v[112:127], a[200:203], v[36:39], v[240:255]
    v_exp_f32 v96, v96
    v_exp_f32 v97, v97
    v_exp_f32 v98, v98
    v_mfma_f32_32x32x16_bf16 v[144:159], a[232:235], v[92:95], v[144:159]
    v_cvt_pk_bf16_f32 v88, v96, v97
    v_exp_f32 v99, v99
    v_exp_f32 v100, v100
    v_cvt_pk_bf16_f32 v89, v98, v99
    v_exp_f32 v101, v101
    v_exp_f32 v102, v102
    v_cvt_pk_bf16_f32 v90, v100, v101
    v_exp_f32 v103, v103
    v_exp_f32 v104, v104
    v_cvt_pk_bf16_f32 v91, v102, v103
    v_exp_f32 v105, v105
    v_exp_f32 v106, v106
    v_mfma_f32_32x32x16_bf16 v[160:175], a[216:219], v[88:91], v[160:175]
    s_waitcnt vmcnt(38)
    v_cvt_pk_bf16_f32 v92, v104, v105
    v_exp_f32 v107, v107
    v_exp_f32 v108, v108
    v_cvt_pk_bf16_f32 v93, v106, v107
    v_exp_f32 v109, v109
    v_exp_f32 v110, v110
    v_exp_f32 v111, v111
    v_cvt_pk_bf16_f32 v94, v108, v109
    v_cvt_pk_bf16_f32 v95, v110, v111
    v_mfma_f32_32x32x16_bf16 v[96:111], a[204:207], v[24:27], v[192:207]
    s_waitcnt lgkmcnt(0)
    v_exp_f32 v112, v112
    v_exp_f32 v113, v113
    v_exp_f32 v114, v114
    v_mfma_f32_32x32x16_bf16 v[160:175], a[232:235], v[92:95], v[160:175]
    s_xor_b32 s37, s38, 197120
    v_cvt_pk_bf16_f32 v88, v112, v113
    v_exp_f32 v115, v115
    v_exp_f32 v116, v116
    v_cvt_pk_bf16_f32 v89, v114, v115
    v_exp_f32 v117, v117
    v_exp_f32 v118, v118
    v_cvt_pk_bf16_f32 v90, v116, v117
    v_exp_f32 v119, v119
    v_exp_f32 v120, v120
    v_cvt_pk_bf16_f32 v91, v118, v119
    v_exp_f32 v121, v121
    v_exp_f32 v122, v122
    v_mfma_f32_32x32x16_bf16 v[176:191], a[216:219], v[88:91], v[176:191]
    s_add_u32 m0, s39, 12288
    v_cvt_pk_bf16_f32 v92, v120, v121
    v_exp_f32 v123, v123
    v_exp_f32 v124, v124
    v_cvt_pk_bf16_f32 v93, v122, v123
    v_exp_f32 v125, v125
    v_exp_f32 v126, v126
    v_exp_f32 v127, v127
    v_cvt_pk_bf16_f32 v94, v124, v125
    v_cvt_pk_bf16_f32 v95, v126, v127
    v_mfma_f32_32x32x16_bf16 v[112:127], a[204:207], v[28:31], v[208:223]
    buffer_load_dwordx4 v15, s[24:27], s37 offen offset:0 lds
    buffer_load_dwordx4 v16, s[24:27], s37 offen offset:1024 lds
    buffer_load_dwordx4 v17, s[24:27], s37 offen offset:2048 lds
    buffer_load_dwordx4 v18, s[24:27], s37 offen offset:3072 lds
    v_exp_f32 v96, v96
    v_exp_f32 v97, v97
    v_exp_f32 v98, v98
    v_mfma_f32_32x32x16_bf16 v[176:191], a[232:235], v[92:95], v[176:191]
    v_cvt_pk_bf16_f32 v88, v96, v97
    v_exp_f32 v99, v99
    v_exp_f32 v100, v100
    v_cvt_pk_bf16_f32 v89, v98, v99
    v_exp_f32 v101, v101
    v_exp_f32 v102, v102
    v_cvt_pk_bf16_f32 v90, v100, v101
    v_exp_f32 v103, v103
    v_exp_f32 v104, v104
    v_cvt_pk_bf16_f32 v91, v102, v103
    v_exp_f32 v105, v105
    v_exp_f32 v106, v106
    v_mfma_f32_32x32x16_bf16 v[128:143], a[220:223], v[88:91], v[128:143]
    s_waitcnt vmcnt(30)
    v_cvt_pk_bf16_f32 v92, v104, v105
    v_exp_f32 v107, v107
    v_exp_f32 v108, v108
    v_cvt_pk_bf16_f32 v93, v106, v107
    v_exp_f32 v109, v109
    v_exp_f32 v110, v110
    v_exp_f32 v111, v111
    v_cvt_pk_bf16_f32 v94, v108, v109
    v_cvt_pk_bf16_f32 v95, v110, v111
    v_mfma_f32_32x32x16_bf16 v[96:111], a[204:207], v[32:35], v[224:239]
    ds_read_b128 a[128:131], v20 offset:0
    v_exp_f32 v112, v112
    v_exp_f32 v113, v113
    v_exp_f32 v114, v114
    v_mfma_f32_32x32x16_bf16 v[128:143], a[236:239], v[92:95], v[128:143]
    buffer_load_dwordx4 a[200:203], v8, s[20:23], s29 offen offset:3072
    buffer_load_dwordx4 a[216:219], v13, s[20:23], s29 offen offset:3072
    buffer_load_dwordx4 a[232:235], v13, s[20:23], s29 offen offset:3584
    v_cvt_pk_bf16_f32 v88, v112, v113
    v_exp_f32 v115, v115
    v_exp_f32 v116, v116
    v_cvt_pk_bf16_f32 v89, v114, v115
    v_exp_f32 v117, v117
    v_exp_f32 v118, v118
    v_cvt_pk_bf16_f32 v90, v116, v117
    v_exp_f32 v119, v119
    v_exp_f32 v120, v120
    v_cvt_pk_bf16_f32 v91, v118, v119
    v_exp_f32 v121, v121
    v_exp_f32 v122, v122
    v_mfma_f32_32x32x16_bf16 v[144:159], a[220:223], v[88:91], v[144:159]
    s_add_u32 s29, s29, 4096
    v_cvt_pk_bf16_f32 v92, v120, v121
    v_exp_f32 v123, v123
    v_exp_f32 v124, v124
    v_cvt_pk_bf16_f32 v93, v122, v123
    v_exp_f32 v125, v125
    v_exp_f32 v126, v126
    v_exp_f32 v127, v127
    v_cvt_pk_bf16_f32 v94, v124, v125
    v_cvt_pk_bf16_f32 v95, v126, v127
    v_mfma_f32_32x32x16_bf16 v[112:127], a[204:207], v[36:39], v[240:255]
    ds_read_b128 a[144:147], v21 offset:0
    v_exp_f32 v96, v96
    v_exp_f32 v97, v97
    v_exp_f32 v98, v98
    v_mfma_f32_32x32x16_bf16 v[144:159], a[236:239], v[92:95], v[144:159]
    ds_read_b128 a[160:163], v22 offset:0
    v_cvt_pk_bf16_f32 v88, v96, v97
    v_exp_f32 v99, v99
    v_exp_f32 v100, v100
    v_cvt_pk_bf16_f32 v89, v98, v99
    v_exp_f32 v101, v101
    v_exp_f32 v102, v102
    v_cvt_pk_bf16_f32 v90, v100, v101
    v_exp_f32 v103, v103
    v_exp_f32 v104, v104
    v_cvt_pk_bf16_f32 v91, v102, v103
    v_exp_f32 v105, v105
    v_exp_f32 v106, v106
    v_mfma_f32_32x32x16_bf16 v[160:175], a[220:223], v[88:91], v[160:175]
    s_waitcnt vmcnt(38)
    v_cvt_pk_bf16_f32 v92, v104, v105
    v_exp_f32 v107, v107
    v_exp_f32 v108, v108
    v_cvt_pk_bf16_f32 v93, v106, v107
    v_exp_f32 v109, v109
    v_exp_f32 v110, v110
    v_exp_f32 v111, v111
    v_cvt_pk_bf16_f32 v94, v108, v109
    v_cvt_pk_bf16_f32 v95, v110, v111
    v_mfma_f32_32x32x16_bf16 v[96:111], v[40:43], v[24:27], v[192:207]
    ds_read_b128 a[176:179], v23 offset:0
    v_exp_f32 v112, v112
    v_exp_f32 v113, v113
    v_exp_f32 v114, v114
    v_mfma_f32_32x32x16_bf16 v[160:175], a[236:239], v[92:95], v[160:175]
    s_add_u32 m0, s42, 11264
    v_cvt_pk_bf16_f32 v88, v112, v113
    v_exp_f32 v115, v115
    v_exp_f32 v116, v116
    v_cvt_pk_bf16_f32 v89, v114, v115
    v_exp_f32 v117, v117
    v_exp_f32 v118, v118
    v_cvt_pk_bf16_f32 v90, v116, v117
    v_exp_f32 v119, v119
    v_exp_f32 v120, v120
    v_cvt_pk_bf16_f32 v91, v118, v119
    v_exp_f32 v121, v121
    v_exp_f32 v122, v122
    v_mfma_f32_32x32x16_bf16 v[176:191], a[220:223], v[88:91], v[176:191]
    s_xor_b32 s28, s41, 90112
    v_cvt_pk_bf16_f32 v92, v120, v121
    v_exp_f32 v123, v123
    v_exp_f32 v124, v124
    v_cvt_pk_bf16_f32 v93, v122, v123
    v_exp_f32 v125, v125
    v_exp_f32 v126, v126
    v_exp_f32 v127, v127
    v_cvt_pk_bf16_f32 v94, v124, v125
    v_cvt_pk_bf16_f32 v95, v126, v127
    v_mfma_f32_32x32x16_bf16 v[112:127], v[40:43], v[28:31], v[208:223]
    buffer_load_dwordx4 v19, s[56:59], s28 offen lds
    v_exp_f32 v96, v96
    v_exp_f32 v97, v97
    v_exp_f32 v98, v98
    v_mfma_f32_32x32x16_bf16 v[176:191], a[236:239], v[92:95], v[176:191]
    v_cvt_pk_bf16_f32 v88, v96, v97
    v_exp_f32 v99, v99
    v_exp_f32 v100, v100
    v_cvt_pk_bf16_f32 v89, v98, v99
    v_exp_f32 v101, v101
    v_exp_f32 v102, v102
    v_cvt_pk_bf16_f32 v90, v100, v101
    v_exp_f32 v103, v103
    v_exp_f32 v104, v104
    v_cvt_pk_bf16_f32 v91, v102, v103
    v_exp_f32 v105, v105
    v_exp_f32 v106, v106
    v_mfma_f32_32x32x16_bf16 v[128:143], v[56:59], v[88:91], v[128:143]
    v_cvt_pk_bf16_f32 v92, v104, v105
    v_exp_f32 v107, v107
    v_exp_f32 v108, v108
    v_cvt_pk_bf16_f32 v93, v106, v107
    v_exp_f32 v109, v109
    v_exp_f32 v110, v110
    v_exp_f32 v111, v111
    v_cvt_pk_bf16_f32 v94, v108, v109
    v_cvt_pk_bf16_f32 v95, v110, v111
    v_mfma_f32_32x32x16_bf16 v[96:111], v[40:43], v[32:35], v[224:239]
    s_waitcnt lgkmcnt(0)
    v_exp_f32 v112, v112
    v_exp_f32 v113, v113
    v_exp_f32 v114, v114
    v_mfma_f32_32x32x16_bf16 v[128:143], v[72:75], v[92:95], v[128:143]
    buffer_load_dwordx4 a[204:207], v8, s[20:23], s29 offen offset:0
    buffer_load_dwordx4 a[220:223], v13, s[20:23], s29 offen offset:0
    buffer_load_dwordx4 a[236:239], v13, s[20:23], s29 offen offset:512
    v_cvt_pk_bf16_f32 v88, v112, v113
    v_exp_f32 v115, v115
    v_exp_f32 v116, v116
    v_cvt_pk_bf16_f32 v89, v114, v115
    v_exp_f32 v117, v117
    v_exp_f32 v118, v118
    v_cvt_pk_bf16_f32 v90, v116, v117
    v_exp_f32 v119, v119
    v_exp_f32 v120, v120
    v_cvt_pk_bf16_f32 v91, v118, v119
    v_exp_f32 v121, v121
    v_exp_f32 v122, v122
    v_mfma_f32_32x32x16_bf16 v[144:159], v[56:59], v[88:91], v[144:159]
    s_xor_b32 s37, s38, 768
    v_cvt_pk_bf16_f32 v92, v120, v121
    v_exp_f32 v123, v123
    v_exp_f32 v124, v124
    v_cvt_pk_bf16_f32 v93, v122, v123
    v_exp_f32 v125, v125
    v_exp_f32 v126, v126
    v_exp_f32 v127, v127
    v_cvt_pk_bf16_f32 v94, v124, v125
    v_cvt_pk_bf16_f32 v95, v126, v127
    v_mfma_f32_32x32x16_bf16 v[112:127], v[40:43], v[36:39], v[240:255]
    s_add_u32 m0, s39, 0
    v_exp_f32 v96, v96
    v_exp_f32 v97, v97
    v_exp_f32 v98, v98
    v_mfma_f32_32x32x16_bf16 v[144:159], v[72:75], v[92:95], v[144:159]
    buffer_load_dwordx4 v15, s[24:27], s37 offen offset:0 lds
    buffer_load_dwordx4 v16, s[24:27], s37 offen offset:1024 lds
    buffer_load_dwordx4 v17, s[24:27], s37 offen offset:2048 lds
    buffer_load_dwordx4 v18, s[24:27], s37 offen offset:3072 lds
    v_cvt_pk_bf16_f32 v88, v96, v97
    v_exp_f32 v99, v99
    v_exp_f32 v100, v100
    v_cvt_pk_bf16_f32 v89, v98, v99
    v_exp_f32 v101, v101
    v_exp_f32 v102, v102
    v_cvt_pk_bf16_f32 v90, v100, v101
    v_exp_f32 v103, v103
    v_exp_f32 v104, v104
    v_cvt_pk_bf16_f32 v91, v102, v103
    v_exp_f32 v105, v105
    v_exp_f32 v106, v106
    v_mfma_f32_32x32x16_bf16 v[160:175], v[56:59], v[88:91], v[160:175]
    s_waitcnt vmcnt(38)
    v_cvt_pk_bf16_f32 v92, v104, v105
    v_exp_f32 v107, v107
    v_exp_f32 v108, v108
    v_cvt_pk_bf16_f32 v93, v106, v107
    v_exp_f32 v109, v109
    v_exp_f32 v110, v110
    v_exp_f32 v111, v111
    v_cvt_pk_bf16_f32 v94, v108, v109
    v_cvt_pk_bf16_f32 v95, v110, v111
    v_mfma_f32_32x32x16_bf16 v[96:111], v[44:47], v[24:27], v[192:207]
    s_waitcnt vmcnt(30)
    v_exp_f32 v112, v112
    v_exp_f32 v113, v113
    v_exp_f32 v114, v114
    v_mfma_f32_32x32x16_bf16 v[160:175], v[72:75], v[92:95], v[160:175]
    ds_read_b128 a[4:7], v20 offset:4096
    v_cvt_pk_bf16_f32 v88, v112, v113
    v_exp_f32 v115, v115
    v_exp_f32 v116, v116
    v_cvt_pk_bf16_f32 v89, v114, v115
    v_exp_f32 v117, v117
    v_exp_f32 v118, v118
    v_cvt_pk_bf16_f32 v90, v116, v117
    v_exp_f32 v119, v119
    v_exp_f32 v120, v120
    v_cvt_pk_bf16_f32 v91, v118, v119
    v_exp_f32 v121, v121
    v_exp_f32 v122, v122
    v_mfma_f32_32x32x16_bf16 v[176:191], v[56:59], v[88:91], v[176:191]
    ds_read_b128 a[20:23], v21 offset:4096
    v_cvt_pk_bf16_f32 v92, v120, v121
    v_exp_f32 v123, v123
    v_exp_f32 v124, v124
    v_cvt_pk_bf16_f32 v93, v122, v123
    v_exp_f32 v125, v125
    v_exp_f32 v126, v126
    v_exp_f32 v127, v127
    v_cvt_pk_bf16_f32 v94, v124, v125
    v_cvt_pk_bf16_f32 v95, v126, v127
    v_mfma_f32_32x32x16_bf16 v[112:127], v[44:47], v[28:31], v[208:223]
    ds_read_b128 a[36:39], v22 offset:4096
    v_exp_f32 v96, v96
    v_exp_f32 v97, v97
    v_exp_f32 v98, v98
    v_mfma_f32_32x32x16_bf16 v[176:191], v[72:75], v[92:95], v[176:191]
    ds_read_b128 a[52:55], v23 offset:4096
    v_cvt_pk_bf16_f32 v88, v96, v97
    v_exp_f32 v99, v99
    v_exp_f32 v100, v100
    v_cvt_pk_bf16_f32 v89, v98, v99
    v_exp_f32 v101, v101
    v_exp_f32 v102, v102
    v_cvt_pk_bf16_f32 v90, v100, v101
    v_exp_f32 v103, v103
    v_exp_f32 v104, v104
    v_cvt_pk_bf16_f32 v91, v102, v103
    v_exp_f32 v105, v105
    v_exp_f32 v106, v106
    v_mfma_f32_32x32x16_bf16 v[128:143], v[60:63], v[88:91], v[128:143]
    s_add_u32 m0, s42, 12288
    v_cvt_pk_bf16_f32 v92, v104, v105
    v_exp_f32 v107, v107
    v_exp_f32 v108, v108
    v_cvt_pk_bf16_f32 v93, v106, v107
    v_exp_f32 v109, v109
    v_exp_f32 v110, v110
    v_exp_f32 v111, v111
    v_cvt_pk_bf16_f32 v94, v108, v109
    v_cvt_pk_bf16_f32 v95, v110, v111
    v_mfma_f32_32x32x16_bf16 v[96:111], v[44:47], v[32:35], v[224:239]
    s_xor_b32 s28, s41, 98304
    v_exp_f32 v112, v112
    v_exp_f32 v113, v113
    v_exp_f32 v114, v114
    v_mfma_f32_32x32x16_bf16 v[128:143], v[76:79], v[92:95], v[128:143]
    buffer_load_dwordx4 v[40:43], v8, s[20:23], s29 offen offset:1024
    buffer_load_dwordx4 v[56:59], v13, s[20:23], s29 offen offset:1024
    buffer_load_dwordx4 v[72:75], v13, s[20:23], s29 offen offset:1536
    v_cvt_pk_bf16_f32 v88, v112, v113
    v_exp_f32 v115, v115
    v_exp_f32 v116, v116
    v_cvt_pk_bf16_f32 v89, v114, v115
    v_exp_f32 v117, v117
    v_exp_f32 v118, v118
    v_cvt_pk_bf16_f32 v90, v116, v117
    v_exp_f32 v119, v119
    v_exp_f32 v120, v120
    v_cvt_pk_bf16_f32 v91, v118, v119
    v_exp_f32 v121, v121
    v_exp_f32 v122, v122
    v_mfma_f32_32x32x16_bf16 v[144:159], v[60:63], v[88:91], v[144:159]
    buffer_load_dwordx4 v19, s[56:59], s28 offen lds
    v_cvt_pk_bf16_f32 v92, v120, v121
    v_exp_f32 v123, v123
    v_exp_f32 v124, v124
    v_cvt_pk_bf16_f32 v93, v122, v123
    v_exp_f32 v125, v125
    v_exp_f32 v126, v126
    v_exp_f32 v127, v127
    v_cvt_pk_bf16_f32 v94, v124, v125
    v_cvt_pk_bf16_f32 v95, v126, v127
    v_mfma_f32_32x32x16_bf16 v[112:127], v[44:47], v[36:39], v[240:255]
    v_exp_f32 v96, v96
    v_exp_f32 v97, v97
    v_exp_f32 v98, v98
    v_mfma_f32_32x32x16_bf16 v[144:159], v[76:79], v[92:95], v[144:159]
    v_cvt_pk_bf16_f32 v88, v96, v97
    v_exp_f32 v99, v99
    v_exp_f32 v100, v100
    v_cvt_pk_bf16_f32 v89, v98, v99
    v_exp_f32 v101, v101
    v_exp_f32 v102, v102
    v_cvt_pk_bf16_f32 v90, v100, v101
    v_exp_f32 v103, v103
    v_exp_f32 v104, v104
    v_cvt_pk_bf16_f32 v91, v102, v103
    v_exp_f32 v105, v105
    v_exp_f32 v106, v106
    v_mfma_f32_32x32x16_bf16 v[160:175], v[60:63], v[88:91], v[160:175]
    s_waitcnt vmcnt(38)
    v_cvt_pk_bf16_f32 v92, v104, v105
    v_exp_f32 v107, v107
    v_exp_f32 v108, v108
    v_cvt_pk_bf16_f32 v93, v106, v107
    v_exp_f32 v109, v109
    v_exp_f32 v110, v110
    v_exp_f32 v111, v111
    v_cvt_pk_bf16_f32 v94, v108, v109
    v_cvt_pk_bf16_f32 v95, v110, v111
    v_mfma_f32_32x32x16_bf16 v[96:111], v[48:51], v[24:27], v[192:207]
    s_waitcnt lgkmcnt(0)
    v_exp_f32 v112, v112
    v_exp_f32 v113, v113
    v_exp_f32 v114, v114
    v_mfma_f32_32x32x16_bf16 v[160:175], v[76:79], v[92:95], v[160:175]
    s_xor_b32 s37, s38, 66304
    v_cvt_pk_bf16_f32 v88, v112, v113
    v_exp_f32 v115, v115
    v_exp_f32 v116, v116
    v_cvt_pk_bf16_f32 v89, v114, v115
    v_exp_f32 v117, v117
    v_exp_f32 v118, v118
    v_cvt_pk_bf16_f32 v90, v116, v117
    v_exp_f32 v119, v119
    v_exp_f32 v120, v120
    v_cvt_pk_bf16_f32 v91, v118, v119
    v_exp_f32 v121, v121
    v_exp_f32 v122, v122
    v_mfma_f32_32x32x16_bf16 v[176:191], v[60:63], v[88:91], v[176:191]
    s_add_u32 m0, s39, 4096
    v_cvt_pk_bf16_f32 v92, v120, v121
    v_exp_f32 v123, v123
    v_exp_f32 v124, v124
    v_cvt_pk_bf16_f32 v93, v122, v123
    v_exp_f32 v125, v125
    v_exp_f32 v126, v126
    v_exp_f32 v127, v127
    v_cvt_pk_bf16_f32 v94, v124, v125
    v_cvt_pk_bf16_f32 v95, v126, v127
    v_mfma_f32_32x32x16_bf16 v[112:127], v[48:51], v[28:31], v[208:223]
    buffer_load_dwordx4 v15, s[24:27], s37 offen offset:0 lds
    buffer_load_dwordx4 v16, s[24:27], s37 offen offset:1024 lds
    buffer_load_dwordx4 v17, s[24:27], s37 offen offset:2048 lds
    buffer_load_dwordx4 v18, s[24:27], s37 offen offset:3072 lds
    v_exp_f32 v96, v96
    v_exp_f32 v97, v97
    v_exp_f32 v98, v98
    v_mfma_f32_32x32x16_bf16 v[176:191], v[76:79], v[92:95], v[176:191]
    v_cvt_pk_bf16_f32 v88, v96, v97
    v_exp_f32 v99, v99
    v_exp_f32 v100, v100
    v_cvt_pk_bf16_f32 v89, v98, v99
    v_exp_f32 v101, v101
    v_exp_f32 v102, v102
    v_cvt_pk_bf16_f32 v90, v100, v101
    v_exp_f32 v103, v103
    v_exp_f32 v104, v104
    v_cvt_pk_bf16_f32 v91, v102, v103
    v_exp_f32 v105, v105
    v_exp_f32 v106, v106
    v_mfma_f32_32x32x16_bf16 v[128:143], v[64:67], v[88:91], v[128:143]
    v_cvt_pk_bf16_f32 v92, v104, v105
    v_exp_f32 v107, v107
    v_exp_f32 v108, v108
    v_cvt_pk_bf16_f32 v93, v106, v107
    v_exp_f32 v109, v109
    v_exp_f32 v110, v110
    v_exp_f32 v111, v111
    v_cvt_pk_bf16_f32 v94, v108, v109
    v_cvt_pk_bf16_f32 v95, v110, v111
    v_mfma_f32_32x32x16_bf16 v[96:111], v[48:51], v[32:35], v[224:239]
    s_waitcnt vmcnt(27)
    v_exp_f32 v112, v112
    v_exp_f32 v113, v113
    v_exp_f32 v114, v114
    v_mfma_f32_32x32x16_bf16 v[128:143], v[80:83], v[92:95], v[128:143]
    buffer_load_dwordx4 v[44:47], v8, s[20:23], s29 offen offset:2048
    buffer_load_dwordx4 v[60:63], v13, s[20:23], s29 offen offset:2048
    buffer_load_dwordx4 v[76:79], v13, s[20:23], s29 offen offset:2560
    v_cvt_pk_bf16_f32 v88, v112, v113
    v_exp_f32 v115, v115
    v_exp_f32 v116, v116
    v_cvt_pk_bf16_f32 v89, v114, v115
    v_exp_f32 v117, v117
    v_exp_f32 v118, v118
    v_cvt_pk_bf16_f32 v90, v116, v117
    v_exp_f32 v119, v119
    v_exp_f32 v120, v120
    v_cvt_pk_bf16_f32 v91, v118, v119
    v_exp_f32 v121, v121
    v_exp_f32 v122, v122
    v_mfma_f32_32x32x16_bf16 v[144:159], v[64:67], v[88:91], v[144:159]
    ds_read_b128 a[72:75], v20 offset:8192
    v_cvt_pk_bf16_f32 v92, v120, v121
    v_exp_f32 v123, v123
    v_exp_f32 v124, v124
    v_cvt_pk_bf16_f32 v93, v122, v123
    v_exp_f32 v125, v125
    v_exp_f32 v126, v126
    v_exp_f32 v127, v127
    v_cvt_pk_bf16_f32 v94, v124, v125
    v_cvt_pk_bf16_f32 v95, v126, v127
    v_mfma_f32_32x32x16_bf16 v[112:127], v[48:51], v[36:39], v[240:255]
    ds_read_b128 a[88:91], v21 offset:8192
    v_exp_f32 v96, v96
    v_exp_f32 v97, v97
    v_exp_f32 v98, v98
    v_mfma_f32_32x32x16_bf16 v[144:159], v[80:83], v[92:95], v[144:159]
    ds_read_b128 a[104:107], v22 offset:8192
    v_cvt_pk_bf16_f32 v88, v96, v97
    v_exp_f32 v99, v99
    v_exp_f32 v100, v100
    v_cvt_pk_bf16_f32 v89, v98, v99
    v_exp_f32 v101, v101
    v_exp_f32 v102, v102
    v_cvt_pk_bf16_f32 v90, v100, v101
    v_exp_f32 v103, v103
    v_exp_f32 v104, v104
    v_cvt_pk_bf16_f32 v91, v102, v103
    v_exp_f32 v105, v105
    v_exp_f32 v106, v106
    v_mfma_f32_32x32x16_bf16 v[160:175], v[64:67], v[88:91], v[160:175]
    s_waitcnt vmcnt(38)
    v_cvt_pk_bf16_f32 v92, v104, v105
    v_exp_f32 v107, v107
    v_exp_f32 v108, v108
    v_cvt_pk_bf16_f32 v93, v106, v107
    v_exp_f32 v109, v109
    v_exp_f32 v110, v110
    v_exp_f32 v111, v111
    v_cvt_pk_bf16_f32 v94, v108, v109
    v_cvt_pk_bf16_f32 v95, v110, v111
    v_mfma_f32_32x32x16_bf16 v[96:111], v[52:55], v[24:27], v[192:207]
    ds_read_b128 a[120:123], v23 offset:8192
    v_exp_f32 v112, v112
    v_exp_f32 v113, v113
    v_exp_f32 v114, v114
    v_mfma_f32_32x32x16_bf16 v[160:175], v[80:83], v[92:95], v[160:175]
    s_add_u32 m0, s42, 13312
    v_cvt_pk_bf16_f32 v88, v112, v113
    v_exp_f32 v115, v115
    v_exp_f32 v116, v116
    v_cvt_pk_bf16_f32 v89, v114, v115
    v_exp_f32 v117, v117
    v_exp_f32 v118, v118
    v_cvt_pk_bf16_f32 v90, v116, v117
    v_exp_f32 v119, v119
    v_exp_f32 v120, v120
    v_cvt_pk_bf16_f32 v91, v118, v119
    v_exp_f32 v121, v121
    v_exp_f32 v122, v122
    v_mfma_f32_32x32x16_bf16 v[176:191], v[64:67], v[88:91], v[176:191]
    s_xor_b32 s28, s41, 106496
    v_cvt_pk_bf16_f32 v92, v120, v121
    v_exp_f32 v123, v123
    v_exp_f32 v124, v124
    v_cvt_pk_bf16_f32 v93, v122, v123
    v_exp_f32 v125, v125
    v_exp_f32 v126, v126
    v_exp_f32 v127, v127
    v_cvt_pk_bf16_f32 v94, v124, v125
    v_cvt_pk_bf16_f32 v95, v126, v127
    v_mfma_f32_32x32x16_bf16 v[112:127], v[52:55], v[28:31], v[208:223]
    buffer_load_dwordx4 v19, s[56:59], s28 offen lds
    v_exp_f32 v96, v96
    v_exp_f32 v97, v97
    v_exp_f32 v98, v98
    v_mfma_f32_32x32x16_bf16 v[176:191], v[80:83], v[92:95], v[176:191]
    v_cvt_pk_bf16_f32 v88, v96, v97
    v_exp_f32 v99, v99
    v_exp_f32 v100, v100
    v_cvt_pk_bf16_f32 v89, v98, v99
    v_exp_f32 v101, v101
    v_exp_f32 v102, v102
    v_cvt_pk_bf16_f32 v90, v100, v101
    v_exp_f32 v103, v103
    v_exp_f32 v104, v104
    v_cvt_pk_bf16_f32 v91, v102, v103
    v_exp_f32 v105, v105
    v_exp_f32 v106, v106
    v_mfma_f32_32x32x16_bf16 v[128:143], v[68:71], v[88:91], v[128:143]
    v_cvt_pk_bf16_f32 v92, v104, v105
    v_exp_f32 v107, v107
    v_exp_f32 v108, v108
    v_cvt_pk_bf16_f32 v93, v106, v107
    v_exp_f32 v109, v109
    v_exp_f32 v110, v110
    v_exp_f32 v111, v111
    v_cvt_pk_bf16_f32 v94, v108, v109
    v_cvt_pk_bf16_f32 v95, v110, v111
    v_mfma_f32_32x32x16_bf16 v[96:111], v[52:55], v[32:35], v[224:239]
    v_exp_f32 v112, v112
    v_exp_f32 v113, v113
    v_exp_f32 v114, v114
    v_mfma_f32_32x32x16_bf16 v[128:143], v[84:87], v[92:95], v[128:143]
    buffer_load_dwordx4 v[48:51], v8, s[20:23], s29 offen offset:3072
    buffer_load_dwordx4 v[64:67], v13, s[20:23], s29 offen offset:3072
    buffer_load_dwordx4 v[80:83], v13, s[20:23], s29 offen offset:3584
    v_cvt_pk_bf16_f32 v88, v112, v113
    v_exp_f32 v115, v115
    v_exp_f32 v116, v116
    v_cvt_pk_bf16_f32 v89, v114, v115
    v_exp_f32 v117, v117
    v_exp_f32 v118, v118
    v_cvt_pk_bf16_f32 v90, v116, v117
    v_exp_f32 v119, v119
    v_exp_f32 v120, v120
    v_cvt_pk_bf16_f32 v91, v118, v119
    v_exp_f32 v121, v121
    v_exp_f32 v122, v122
    v_mfma_f32_32x32x16_bf16 v[144:159], v[68:71], v[88:91], v[144:159]
    s_add_u32 s29, s29, 4096
    v_cvt_pk_bf16_f32 v92, v120, v121
    v_exp_f32 v123, v123
    v_exp_f32 v124, v124
    v_cvt_pk_bf16_f32 v93, v122, v123
    v_exp_f32 v125, v125
    v_exp_f32 v126, v126
    v_exp_f32 v127, v127
    v_cvt_pk_bf16_f32 v94, v124, v125
    v_cvt_pk_bf16_f32 v95, v126, v127
    v_mfma_f32_32x32x16_bf16 v[112:127], v[52:55], v[36:39], v[240:255]
    s_waitcnt lgkmcnt(0)
    v_exp_f32 v96, v96
    v_exp_f32 v97, v97
    v_exp_f32 v98, v98
    v_mfma_f32_32x32x16_bf16 v[144:159], v[84:87], v[92:95], v[144:159]
    s_xor_b32 s37, s38, 131840
    v_cvt_pk_bf16_f32 v88, v96, v97
    v_exp_f32 v99, v99
    v_exp_f32 v100, v100
    v_cvt_pk_bf16_f32 v89, v98, v99
    v_exp_f32 v101, v101
    v_exp_f32 v102, v102
    v_cvt_pk_bf16_f32 v90, v100, v101
    v_exp_f32 v103, v103
    v_exp_f32 v104, v104
    v_cvt_pk_bf16_f32 v91, v102, v103
    v_exp_f32 v105, v105
    v_exp_f32 v106, v106
    v_mfma_f32_32x32x16_bf16 v[160:175], v[68:71], v[88:91], v[160:175]
    s_waitcnt vmcnt(38)
    v_cvt_pk_bf16_f32 v92, v104, v105
    v_exp_f32 v107, v107
    v_exp_f32 v108, v108
    v_cvt_pk_bf16_f32 v93, v106, v107
    v_exp_f32 v109, v109
    v_exp_f32 v110, v110
    v_exp_f32 v111, v111
    v_cvt_pk_bf16_f32 v94, v108, v109
    v_cvt_pk_bf16_f32 v95, v110, v111
    v_mfma_f32_32x32x16_bf16 v[96:111], a[192:195], v[24:27], v[192:207]
    s_add_u32 m0, s39, 8192
    s_nop 0
    buffer_load_dwordx4 v15, s[24:27], s37 offen offset:0 lds
    buffer_load_dwordx4 v16, s[24:27], s37 offen offset:1024 lds
    buffer_load_dwordx4 v17, s[24:27], s37 offen offset:2048 lds
    buffer_load_dwordx4 v18, s[24:27], s37 offen offset:3072 lds
    v_exp_f32 v112, v112
    v_exp_f32 v113, v113
    v_exp_f32 v114, v114
    v_mfma_f32_32x32x16_bf16 v[160:175], v[84:87], v[92:95], v[160:175]
    s_waitcnt vmcnt(30)
    v_cvt_pk_bf16_f32 v88, v112, v113
    v_exp_f32 v115, v115
    v_exp_f32 v116, v116
    v_cvt_pk_bf16_f32 v89, v114, v115
    v_exp_f32 v117, v117
    v_exp_f32 v118, v118
    v_cvt_pk_bf16_f32 v90, v116, v117
    v_exp_f32 v119, v119
    v_exp_f32 v120, v120
    v_cvt_pk_bf16_f32 v91, v118, v119
    v_exp_f32 v121, v121
    v_exp_f32 v122, v122
    v_mfma_f32_32x32x16_bf16 v[176:191], v[68:71], v[88:91], v[176:191]
    ds_read_b128 a[140:143], v20 offset:12288
    v_cvt_pk_bf16_f32 v92, v120, v121
    v_exp_f32 v123, v123
    v_exp_f32 v124, v124
    v_cvt_pk_bf16_f32 v93, v122, v123
    v_exp_f32 v125, v125
    v_exp_f32 v126, v126
    v_exp_f32 v127, v127
    v_cvt_pk_bf16_f32 v94, v124, v125
    v_cvt_pk_bf16_f32 v95, v126, v127
    v_mfma_f32_32x32x16_bf16 v[112:127], a[192:195], v[28:31], v[208:223]
    ds_read_b128 a[156:159], v21 offset:12288
    v_exp_f32 v96, v96
    v_exp_f32 v97, v97
    v_exp_f32 v98, v98
    v_mfma_f32_32x32x16_bf16 v[176:191], v[84:87], v[92:95], v[176:191]
    ds_read_b128 a[172:175], v22 offset:12288
    v_cvt_pk_bf16_f32 v88, v96, v97
    v_exp_f32 v99, v99
    v_exp_f32 v100, v100
    v_cvt_pk_bf16_f32 v89, v98, v99
    v_exp_f32 v101, v101
    v_exp_f32 v102, v102
    v_cvt_pk_bf16_f32 v90, v100, v101
    v_exp_f32 v103, v103
    v_exp_f32 v104, v104
    v_cvt_pk_bf16_f32 v91, v102, v103
    v_exp_f32 v105, v105
    v_exp_f32 v106, v106
    v_mfma_f32_32x32x16_bf16 v[128:143], a[208:211], v[88:91], v[128:143]
    ds_read_b128 a[188:191], v23 offset:12288
    v_cvt_pk_bf16_f32 v92, v104, v105
    v_exp_f32 v107, v107
    v_exp_f32 v108, v108
    v_cvt_pk_bf16_f32 v93, v106, v107
    v_exp_f32 v109, v109
    v_exp_f32 v110, v110
    v_exp_f32 v111, v111
    v_cvt_pk_bf16_f32 v94, v108, v109
    v_cvt_pk_bf16_f32 v95, v110, v111
    v_mfma_f32_32x32x16_bf16 v[96:111], a[192:195], v[32:35], v[224:239]
    s_add_u32 m0, s42, 14336
    v_exp_f32 v112, v112
    v_exp_f32 v113, v113
    v_exp_f32 v114, v114
    v_mfma_f32_32x32x16_bf16 v[128:143], a[224:227], v[92:95], v[128:143]
    buffer_load_dwordx4 v[52:55], v8, s[20:23], s29 offen offset:0
    buffer_load_dwordx4 v[68:71], v13, s[20:23], s29 offen offset:0
    buffer_load_dwordx4 v[84:87], v13, s[20:23], s29 offen offset:512
    v_cvt_pk_bf16_f32 v88, v112, v113
    v_exp_f32 v115, v115
    v_exp_f32 v116, v116
    v_cvt_pk_bf16_f32 v89, v114, v115
    v_exp_f32 v117, v117
    v_exp_f32 v118, v118
    v_cvt_pk_bf16_f32 v90, v116, v117
    v_exp_f32 v119, v119
    v_exp_f32 v120, v120
    v_cvt_pk_bf16_f32 v91, v118, v119
    v_exp_f32 v121, v121
    v_exp_f32 v122, v122
    v_mfma_f32_32x32x16_bf16 v[144:159], a[208:211], v[88:91], v[144:159]
    s_xor_b32 s28, s41, 114688
    v_cvt_pk_bf16_f32 v92, v120, v121
    v_exp_f32 v123, v123
    v_exp_f32 v124, v124
    v_cvt_pk_bf16_f32 v93, v122, v123
    v_exp_f32 v125, v125
    v_exp_f32 v126, v126
    v_exp_f32 v127, v127
    v_cvt_pk_bf16_f32 v94, v124, v125
    v_cvt_pk_bf16_f32 v95, v126, v127
    v_mfma_f32_32x32x16_bf16 v[112:127], a[192:195], v[36:39], v[240:255]
    buffer_load_dwordx4 v19, s[56:59], s28 offen lds
    v_exp_f32 v96, v96
    v_exp_f32 v97, v97
    v_exp_f32 v98, v98
    v_mfma_f32_32x32x16_bf16 v[144:159], a[224:227], v[92:95], v[144:159]
    v_cvt_pk_bf16_f32 v88, v96, v97
    v_exp_f32 v99, v99
    v_exp_f32 v100, v100
    v_cvt_pk_bf16_f32 v89, v98, v99
    v_exp_f32 v101, v101
    v_exp_f32 v102, v102
    v_cvt_pk_bf16_f32 v90, v100, v101
    v_exp_f32 v103, v103
    v_exp_f32 v104, v104
    v_cvt_pk_bf16_f32 v91, v102, v103
    v_exp_f32 v105, v105
    v_exp_f32 v106, v106
    v_mfma_f32_32x32x16_bf16 v[160:175], a[208:211], v[88:91], v[160:175]
    s_waitcnt vmcnt(38)
    v_cvt_pk_bf16_f32 v92, v104, v105
    v_exp_f32 v107, v107
    v_exp_f32 v108, v108
    v_cvt_pk_bf16_f32 v93, v106, v107
    v_exp_f32 v109, v109
    v_exp_f32 v110, v110
    v_exp_f32 v111, v111
    v_cvt_pk_bf16_f32 v94, v108, v109
    v_cvt_pk_bf16_f32 v95, v110, v111
    v_mfma_f32_32x32x16_bf16 v[96:111], a[196:199], v[24:27], v[192:207]
    v_exp_f32 v112, v112
    v_exp_f32 v113, v113
    v_exp_f32 v114, v114
    v_mfma_f32_32x32x16_bf16 v[160:175], a[224:227], v[92:95], v[160:175]
    v_cvt_pk_bf16_f32 v88, v112, v113
    v_exp_f32 v115, v115
    v_exp_f32 v116, v116
    v_cvt_pk_bf16_f32 v89, v114, v115
    v_exp_f32 v117, v117
    v_exp_f32 v118, v118
    v_cvt_pk_bf16_f32 v90, v116, v117
    v_exp_f32 v119, v119
    v_exp_f32 v120, v120
    v_cvt_pk_bf16_f32 v91, v118, v119
    v_exp_f32 v121, v121
    v_exp_f32 v122, v122
    v_mfma_f32_32x32x16_bf16 v[176:191], a[208:211], v[88:91], v[176:191]
    s_waitcnt lgkmcnt(0)
    v_cvt_pk_bf16_f32 v92, v120, v121
    v_exp_f32 v123, v123
    v_exp_f32 v124, v124
    v_cvt_pk_bf16_f32 v93, v122, v123
    v_exp_f32 v125, v125
    v_exp_f32 v126, v126
    v_exp_f32 v127, v127
    v_cvt_pk_bf16_f32 v94, v124, v125
    v_cvt_pk_bf16_f32 v95, v126, v127
    v_mfma_f32_32x32x16_bf16 v[112:127], a[196:199], v[28:31], v[208:223]
    s_xor_b32 s37, s38, 197376
    v_exp_f32 v96, v96
    v_exp_f32 v97, v97
    v_exp_f32 v98, v98
    v_mfma_f32_32x32x16_bf16 v[176:191], a[224:227], v[92:95], v[176:191]
    s_add_u32 m0, s39, 12288
    v_cvt_pk_bf16_f32 v88, v96, v97
    v_exp_f32 v99, v99
    v_exp_f32 v100, v100
    v_cvt_pk_bf16_f32 v89, v98, v99
    v_exp_f32 v101, v101
    v_exp_f32 v102, v102
    v_cvt_pk_bf16_f32 v90, v100, v101
    v_exp_f32 v103, v103
    v_exp_f32 v104, v104
    v_cvt_pk_bf16_f32 v91, v102, v103
    v_exp_f32 v105, v105
    v_exp_f32 v106, v106
    v_mfma_f32_32x32x16_bf16 v[128:143], a[212:215], v[88:91], v[128:143]
    buffer_load_dwordx4 v15, s[24:27], s37 offen offset:0 lds
    buffer_load_dwordx4 v16, s[24:27], s37 offen offset:1024 lds
    buffer_load_dwordx4 v17, s[24:27], s37 offen offset:2048 lds
    buffer_load_dwordx4 v18, s[24:27], s37 offen offset:3072 lds
    v_cvt_pk_bf16_f32 v92, v104, v105
    v_exp_f32 v107, v107
    v_exp_f32 v108, v108
    v_cvt_pk_bf16_f32 v93, v106, v107
    v_exp_f32 v109, v109
    v_exp_f32 v110, v110
    v_exp_f32 v111, v111
    v_cvt_pk_bf16_f32 v94, v108, v109
    v_cvt_pk_bf16_f32 v95, v110, v111
    v_mfma_f32_32x32x16_bf16 v[96:111], a[196:199], v[32:35], v[224:239]
    v_exp_f32 v112, v112
    v_exp_f32 v113, v113
    v_exp_f32 v114, v114
    v_mfma_f32_32x32x16_bf16 v[128:143], a[228:231], v[92:95], v[128:143]
    v_cvt_pk_bf16_f32 v88, v112, v113
    v_exp_f32 v115, v115
    v_exp_f32 v116, v116
    v_cvt_pk_bf16_f32 v89, v114, v115
    v_exp_f32 v117, v117
    v_exp_f32 v118, v118
    v_cvt_pk_bf16_f32 v90, v116, v117
    v_exp_f32 v119, v119
    v_exp_f32 v120, v120
    v_cvt_pk_bf16_f32 v91, v118, v119
    v_exp_f32 v121, v121
    v_exp_f32 v122, v122
    v_mfma_f32_32x32x16_bf16 v[144:159], a[212:215], v[88:91], v[144:159]
    v_cvt_pk_bf16_f32 v92, v120, v121
    v_exp_f32 v123, v123
    v_exp_f32 v124, v124
    v_cvt_pk_bf16_f32 v93, v122, v123
    v_exp_f32 v125, v125
    v_exp_f32 v126, v126
    v_exp_f32 v127, v127
    v_cvt_pk_bf16_f32 v94, v124, v125
    v_cvt_pk_bf16_f32 v95, v126, v127
    v_mfma_f32_32x32x16_bf16 v[112:127], a[196:199], v[36:39], v[240:255]
    v_exp_f32 v96, v96
    v_exp_f32 v97, v97
    v_exp_f32 v98, v98
    v_mfma_f32_32x32x16_bf16 v[144:159], a[228:231], v[92:95], v[144:159]
    v_cvt_pk_bf16_f32 v88, v96, v97
    v_exp_f32 v99, v99
    v_exp_f32 v100, v100
    v_cvt_pk_bf16_f32 v89, v98, v99
    v_exp_f32 v101, v101
    v_exp_f32 v102, v102
    v_cvt_pk_bf16_f32 v90, v100, v101
    v_exp_f32 v103, v103
    v_exp_f32 v104, v104
    v_cvt_pk_bf16_f32 v91, v102, v103
    v_exp_f32 v105, v105
    v_exp_f32 v106, v106
    v_mfma_f32_32x32x16_bf16 v[160:175], a[212:215], v[88:91], v[160:175]
    s_waitcnt vmcnt(35)
    v_cvt_pk_bf16_f32 v92, v104, v105
    v_exp_f32 v107, v107
    v_exp_f32 v108, v108
    v_cvt_pk_bf16_f32 v93, v106, v107
    v_exp_f32 v109, v109
    v_exp_f32 v110, v110
    v_exp_f32 v111, v111
    v_cvt_pk_bf16_f32 v94, v108, v109
    v_cvt_pk_bf16_f32 v95, v110, v111
    v_mfma_f32_32x32x16_bf16 v[96:111], a[200:203], v[24:27], v[192:207]
    v_exp_f32 v112, v112
    v_exp_f32 v113, v113
    v_exp_f32 v114, v114
    v_mfma_f32_32x32x16_bf16 v[160:175], a[228:231], v[92:95], v[160:175]
    v_cvt_pk_bf16_f32 v88, v112, v113
    v_exp_f32 v115, v115
    v_exp_f32 v116, v116
    v_cvt_pk_bf16_f32 v89, v114, v115
    v_exp_f32 v117, v117
    v_exp_f32 v118, v118
    v_cvt_pk_bf16_f32 v90, v116, v117
    v_exp_f32 v119, v119
    v_exp_f32 v120, v120
    v_cvt_pk_bf16_f32 v91, v118, v119
    v_exp_f32 v121, v121
    v_exp_f32 v122, v122
    v_mfma_f32_32x32x16_bf16 v[176:191], a[212:215], v[88:91], v[176:191]
    s_add_u32 m0, s42, 15360
    v_cvt_pk_bf16_f32 v92, v120, v121
    v_exp_f32 v123, v123
    v_exp_f32 v124, v124
    v_cvt_pk_bf16_f32 v93, v122, v123
    v_exp_f32 v125, v125
    v_exp_f32 v126, v126
    v_exp_f32 v127, v127
    v_cvt_pk_bf16_f32 v94, v124, v125
    v_cvt_pk_bf16_f32 v95, v126, v127
    v_mfma_f32_32x32x16_bf16 v[112:127], a[200:203], v[28:31], v[208:223]
    s_xor_b32 s28, s41, 122880
    v_exp_f32 v96, v96
    v_exp_f32 v97, v97
    v_exp_f32 v98, v98
    v_mfma_f32_32x32x16_bf16 v[176:191], a[228:231], v[92:95], v[176:191]
    buffer_load_dwordx4 v19, s[56:59], s28 offen lds
    v_cvt_pk_bf16_f32 v88, v96, v97
    v_exp_f32 v99, v99
    v_exp_f32 v100, v100
    v_cvt_pk_bf16_f32 v89, v98, v99
    v_exp_f32 v101, v101
    v_exp_f32 v102, v102
    v_cvt_pk_bf16_f32 v90, v100, v101
    v_exp_f32 v103, v103
    v_exp_f32 v104, v104
    v_cvt_pk_bf16_f32 v91, v102, v103
    v_exp_f32 v105, v105
    v_exp_f32 v106, v106
    v_mfma_f32_32x32x16_bf16 v[128:143], a[216:219], v[88:91], v[128:143]
    v_cvt_pk_bf16_f32 v92, v104, v105
    v_exp_f32 v107, v107
    v_exp_f32 v108, v108
    v_cvt_pk_bf16_f32 v93, v106, v107
    v_exp_f32 v109, v109
    v_exp_f32 v110, v110
    v_exp_f32 v111, v111
    v_cvt_pk_bf16_f32 v94, v108, v109
    v_cvt_pk_bf16_f32 v95, v110, v111
    v_mfma_f32_32x32x16_bf16 v[96:111], a[200:203], v[32:35], v[224:239]
    s_mov_b32 s88, s4
    s_mov_b32 s89, s5
    v_exp_f32 v112, v112
    v_exp_f32 v113, v113
    v_exp_f32 v114, v114
    v_mfma_f32_32x32x16_bf16 v[128:143], a[232:235], v[92:95], v[128:143]
    s_mov_b32 s90, 0x200000
    s_mov_b32 s91, 0x00020000
    v_cvt_pk_bf16_f32 v88, v112, v113
    v_exp_f32 v115, v115
    v_exp_f32 v116, v116
    v_cvt_pk_bf16_f32 v89, v114, v115
    v_exp_f32 v117, v117
    v_exp_f32 v118, v118
    v_cvt_pk_bf16_f32 v90, v116, v117
    v_exp_f32 v119, v119
    v_exp_f32 v120, v120
    v_cvt_pk_bf16_f32 v91, v118, v119
    v_exp_f32 v121, v121
    v_exp_f32 v122, v122
    v_mfma_f32_32x32x16_bf16 v[144:159], a[216:219], v[88:91], v[144:159]
    v_lshrrev_b32 v6, 3, v1
    v_xor_b32 v7, v6, v1
    v_cvt_pk_bf16_f32 v92, v120, v121
    v_exp_f32 v123, v123
    v_exp_f32 v124, v124
    v_cvt_pk_bf16_f32 v93, v122, v123
    v_exp_f32 v125, v125
    v_exp_f32 v126, v126
    v_exp_f32 v127, v127
    v_cvt_pk_bf16_f32 v94, v124, v125
    v_cvt_pk_bf16_f32 v95, v126, v127
    v_mfma_f32_32x32x16_bf16 v[112:127], a[200:203], v[36:39], v[240:255]
    v_and_b32 v7, 7, v7
    v_lshlrev_b32 v7, 4, v7
    v_exp_f32 v96, v96
    v_exp_f32 v97, v97
    v_exp_f32 v98, v98
    v_mfma_f32_32x32x16_bf16 v[144:159], a[232:235], v[92:95], v[144:159]
    v_lshl_add_u32 v6, v6, 10, v7
    s_lshl_b32 s40, s3, 16
    v_cvt_pk_bf16_f32 v88, v96, v97
    v_exp_f32 v99, v99
    v_exp_f32 v100, v100
    v_cvt_pk_bf16_f32 v89, v98, v99
    v_exp_f32 v101, v101
    v_exp_f32 v102, v102
    v_cvt_pk_bf16_f32 v90, v100, v101
    v_exp_f32 v103, v103
    v_exp_f32 v104, v104
    v_cvt_pk_bf16_f32 v91, v102, v103
    v_exp_f32 v105, v105
    v_exp_f32 v106, v106
    v_mfma_f32_32x32x16_bf16 v[160:175], a[216:219], v[88:91], v[160:175]
    s_waitcnt vmcnt(32)
    v_cvt_pk_bf16_f32 v92, v104, v105
    v_exp_f32 v107, v107
    v_exp_f32 v108, v108
    v_cvt_pk_bf16_f32 v93, v106, v107
    v_exp_f32 v109, v109
    v_exp_f32 v110, v110
    v_exp_f32 v111, v111
    v_cvt_pk_bf16_f32 v94, v108, v109
    v_cvt_pk_bf16_f32 v95, v110, v111
    v_mfma_f32_32x32x16_bf16 v[96:111], a[204:207], v[24:27], v[192:207]
    s_lshl_b32 s28, s14, 14
    v_exp_f32 v112, v112
    v_exp_f32 v113, v113
    v_exp_f32 v114, v114
    v_mfma_f32_32x32x16_bf16 v[160:175], a[232:235], v[92:95], v[160:175]
    s_add_u32 s40, s40, s28
    v_cvt_pk_bf16_f32 v88, v112, v113
    v_exp_f32 v115, v115
    v_exp_f32 v116, v116
    v_cvt_pk_bf16_f32 v89, v114, v115
    v_exp_f32 v117, v117
    v_exp_f32 v118, v118
    v_cvt_pk_bf16_f32 v90, v116, v117
    v_exp_f32 v119, v119
    v_exp_f32 v120, v120
    v_cvt_pk_bf16_f32 v91, v118, v119
    v_exp_f32 v121, v121
    v_exp_f32 v122, v122
    v_mfma_f32_32x32x16_bf16 v[176:191], a[216:219], v[88:91], v[176:191]
    s_lshl_b32 s28, s55, 7
    v_cvt_pk_bf16_f32 v92, v120, v121
    v_exp_f32 v123, v123
    v_exp_f32 v124, v124
    v_cvt_pk_bf16_f32 v93, v122, v123
    v_exp_f32 v125, v125
    v_exp_f32 v126, v126
    v_exp_f32 v127, v127
    v_cvt_pk_bf16_f32 v94, v124, v125
    v_cvt_pk_bf16_f32 v95, v126, v127
    v_mfma_f32_32x32x16_bf16 v[112:127], a[204:207], v[28:31], v[208:223]
    s_add_u32 s40, s40, s28
    v_exp_f32 v96, v96
    v_exp_f32 v97, v97
    v_exp_f32 v98, v98
    v_mfma_f32_32x32x16_bf16 v[176:191], a[232:235], v[92:95], v[176:191]
    s_mul_i32 s32, s14, 7168
    v_cvt_pk_bf16_f32 v88, v96, v97
    v_exp_f32 v99, v99
    v_exp_f32 v100, v100
    v_cvt_pk_bf16_f32 v89, v98, v99
    v_exp_f32 v101, v101
    v_exp_f32 v102, v102
    v_cvt_pk_bf16_f32 v90, v100, v101
    v_exp_f32 v103, v103
    v_exp_f32 v104, v104
    v_cvt_pk_bf16_f32 v91, v102, v103
    v_exp_f32 v105, v105
    v_exp_f32 v106, v106
    v_mfma_f32_32x32x16_bf16 v[128:143], a[220:223], v[88:91], v[128:143]
    s_add_u32 m0, s32, 140288
    v_cvt_pk_bf16_f32 v92, v104, v105
    v_exp_f32 v107, v107
    v_exp_f32 v108, v108
    v_cvt_pk_bf16_f32 v93, v106, v107
    v_exp_f32 v109, v109
    v_exp_f32 v110, v110
    v_exp_f32 v111, v111
    v_cvt_pk_bf16_f32 v94, v108, v109
    v_cvt_pk_bf16_f32 v95, v110, v111
    v_mfma_f32_32x32x16_bf16 v[96:111], a[204:207], v[32:35], v[224:239]
    buffer_load_dwordx4 v6, s[88:91], s40 offen lds
    v_exp_f32 v112, v112
    v_exp_f32 v113, v113
    v_exp_f32 v114, v114
    v_mfma_f32_32x32x16_bf16 v[128:143], a[236:239], v[92:95], v[128:143]
    s_add_u32 m0, s32, 141312
    s_add_u32 s40, s40, 8192
    v_cvt_pk_bf16_f32 v88, v112, v113
    v_exp_f32 v115, v115
    v_exp_f32 v116, v116
    v_cvt_pk_bf16_f32 v89, v114, v115
    v_exp_f32 v117, v117
    v_exp_f32 v118, v118
    v_cvt_pk_bf16_f32 v90, v116, v117
    v_exp_f32 v119, v119
    v_exp_f32 v120, v120
    v_cvt_pk_bf16_f32 v91, v118, v119
    v_exp_f32 v121, v121
    v_exp_f32 v122, v122
    v_mfma_f32_32x32x16_bf16 v[144:159], a[220:223], v[88:91], v[144:159]
    buffer_load_dwordx4 v6, s[88:91], s40 offen lds
    v_cvt_pk_bf16_f32 v92, v120, v121
    v_exp_f32 v123, v123
    v_exp_f32 v124, v124
    v_cvt_pk_bf16_f32 v93, v122, v123
    v_exp_f32 v125, v125
    v_exp_f32 v126, v126
    v_exp_f32 v127, v127
    v_cvt_pk_bf16_f32 v94, v124, v125
    v_cvt_pk_bf16_f32 v95, v126, v127
    v_mfma_f32_32x32x16_bf16 v[112:127], a[204:207], v[36:39], v[240:255]
    s_mul_i32 s33, s14, 7168
    s_add_u32 s33, s33, 135168
    v_exp_f32 v96, v96
    v_exp_f32 v97, v97
    v_exp_f32 v98, v98
    v_mfma_f32_32x32x16_bf16 v[144:159], a[236:239], v[92:95], v[144:159]
    v_add_u32 v13, s33, v8
    s_xor_b32 s33, s14, 1
    v_cvt_pk_bf16_f32 v88, v96, v97
    v_exp_f32 v99, v99
    v_exp_f32 v100, v100
    v_cvt_pk_bf16_f32 v89, v98, v99
    v_exp_f32 v101, v101
    v_exp_f32 v102, v102
    v_cvt_pk_bf16_f32 v90, v100, v101
    v_exp_f32 v103, v103
    v_exp_f32 v104, v104
    v_cvt_pk_bf16_f32 v91, v102, v103
    v_exp_f32 v105, v105
    v_exp_f32 v106, v106
    v_mfma_f32_32x32x16_bf16 v[160:175], a[220:223], v[88:91], v[160:175]
    s_waitcnt vmcnt(27)
    v_cvt_pk_bf16_f32 v92, v104, v105
    v_exp_f32 v107, v107
    v_exp_f32 v108, v108
    v_cvt_pk_bf16_f32 v93, v106, v107
    v_exp_f32 v109, v109
    v_exp_f32 v110, v110
    v_exp_f32 v111, v111
    v_cvt_pk_bf16_f32 v94, v108, v109
    v_cvt_pk_bf16_f32 v95, v110, v111
    v_mfma_f32_32x32x16_bf16 v[96:111], v[40:43], v[24:27], v[192:207]
    s_mul_i32 s33, s33, 7168
    s_add_u32 s33, s33, 135168
    v_exp_f32 v112, v112
    v_exp_f32 v113, v113
    v_exp_f32 v114, v114
    v_mfma_f32_32x32x16_bf16 v[160:175], a[236:239], v[92:95], v[160:175]
    v_add_u32 v14, s33, v8
    s_lshl_b32 s34, s16, 1
    v_cvt_pk_bf16_f32 v88, v112, v113
    v_exp_f32 v115, v115
    v_exp_f32 v116, v116
    v_cvt_pk_bf16_f32 v89, v114, v115
    v_exp_f32 v117, v117
    v_exp_f32 v118, v118
    v_cvt_pk_bf16_f32 v90, v116, v117
    v_exp_f32 v119, v119
    v_exp_f32 v120, v120
    v_cvt_pk_bf16_f32 v91, v118, v119
    v_exp_f32 v121, v121
    v_exp_f32 v122, v122
    v_mfma_f32_32x32x16_bf16 v[176:191], a[220:223], v[88:91], v[176:191]
    s_add_u32 s34, s34, s17
    s_lshl_b32 s36, s34, 6
    v_cvt_pk_bf16_f32 v92, v120, v121
    v_exp_f32 v123, v123
    v_exp_f32 v124, v124
    v_cvt_pk_bf16_f32 v93, v122, v123
    v_exp_f32 v125, v125
    v_exp_f32 v126, v126
    v_exp_f32 v127, v127
    v_cvt_pk_bf16_f32 v94, v124, v125
    v_cvt_pk_bf16_f32 v95, v126, v127
    v_mfma_f32_32x32x16_bf16 v[112:127], v[40:43], v[28:31], v[208:223]
    s_lshl_b32 s34, s34, 5
    s_add_u32 s34, s34, s12
    v_exp_f32 v96, v96
    v_exp_f32 v97, v97
    v_exp_f32 v98, v98
    v_mfma_f32_32x32x16_bf16 v[176:191], a[236:239], v[92:95], v[176:191]
    s_lshl_b32 s34, s34, 10
    v_cvt_pk_bf16_f32 v88, v96, v97
    v_exp_f32 v99, v99
    v_exp_f32 v100, v100
    v_cvt_pk_bf16_f32 v89, v98, v99
    v_exp_f32 v101, v101
    v_exp_f32 v102, v102
    v_cvt_pk_bf16_f32 v90, v100, v101
    v_exp_f32 v103, v103
    v_exp_f32 v104, v104
    v_cvt_pk_bf16_f32 v91, v102, v103
    v_exp_f32 v105, v105
    v_exp_f32 v106, v106
    v_mfma_f32_32x32x16_bf16 v[128:143], v[56:59], v[88:91], v[128:143]
    s_add_u32 s34, s34, 0x700000
    v_cvt_pk_bf16_f32 v92, v104, v105
    v_exp_f32 v107, v107
    v_exp_f32 v108, v108
    v_cvt_pk_bf16_f32 v93, v106, v107
    v_exp_f32 v109, v109
    v_exp_f32 v110, v110
    v_exp_f32 v111, v111
    v_cvt_pk_bf16_f32 v94, v108, v109
    v_cvt_pk_bf16_f32 v95, v110, v111
    v_mfma_f32_32x32x16_bf16 v[96:111], v[40:43], v[32:35], v[224:239]
    s_add_u32 s35, s34, 0x8000
    v_exp_f32 v112, v112
    v_exp_f32 v113, v113
    v_exp_f32 v114, v114
    v_mfma_f32_32x32x16_bf16 v[128:143], v[72:75], v[92:95], v[128:143]
    s_lshl_b32 s33, s12, 2
    v_cvt_pk_bf16_f32 v88, v112, v113
    v_exp_f32 v115, v115
    v_exp_f32 v116, v116
    v_cvt_pk_bf16_f32 v89, v114, v115
    v_exp_f32 v117, v117
    v_exp_f32 v118, v118
    v_cvt_pk_bf16_f32 v90, v116, v117
    v_exp_f32 v119, v119
    v_exp_f32 v120, v120
    v_cvt_pk_bf16_f32 v91, v118, v119
    v_exp_f32 v121, v121
    v_exp_f32 v122, v122
    v_mfma_f32_32x32x16_bf16 v[144:159], v[56:59], v[88:91], v[144:159]
    s_add_u32 s36, s36, s33
    v_cvt_pk_bf16_f32 v92, v120, v121
    v_exp_f32 v123, v123
    v_exp_f32 v124, v124
    v_cvt_pk_bf16_f32 v93, v122, v123
    v_exp_f32 v125, v125
    v_exp_f32 v126, v126
    v_exp_f32 v127, v127
    v_cvt_pk_bf16_f32 v94, v124, v125
    v_cvt_pk_bf16_f32 v95, v126, v127
    v_mfma_f32_32x32x16_bf16 v[112:127], v[40:43], v[36:39], v[240:255]
    s_lshl_b32 s36, s36, 5
    v_exp_f32 v96, v96
    v_exp_f32 v97, v97
    v_exp_f32 v98, v98
    v_mfma_f32_32x32x16_bf16 v[144:159], v[72:75], v[92:95], v[144:159]
    s_add_u32 s36, s36, 0x1740000
    v_cvt_pk_bf16_f32 v88, v96, v97
    v_exp_f32 v99, v99
    v_exp_f32 v100, v100
    v_cvt_pk_bf16_f32 v89, v98, v99
    v_exp_f32 v101, v101
    v_exp_f32 v102, v102
    v_cvt_pk_bf16_f32 v90, v100, v101
    v_exp_f32 v103, v103
    v_exp_f32 v104, v104
    v_cvt_pk_bf16_f32 v91, v102, v103
    v_exp_f32 v105, v105
    v_exp_f32 v106, v106
    v_mfma_f32_32x32x16_bf16 v[160:175], v[56:59], v[88:91], v[160:175]
    s_waitcnt vmcnt(8)
    v_cvt_pk_bf16_f32 v92, v104, v105
    v_exp_f32 v107, v107
    v_exp_f32 v108, v108
    v_cvt_pk_bf16_f32 v93, v106, v107
    v_exp_f32 v109, v109
    v_exp_f32 v110, v110
    v_exp_f32 v111, v111
    v_cvt_pk_bf16_f32 v94, v108, v109
    v_cvt_pk_bf16_f32 v95, v110, v111
    v_mfma_f32_32x32x16_bf16 v[96:111], v[44:47], v[32:35], v[224:239]
    s_waitcnt vmcnt(30)
    v_exp_f32 v112, v112
    v_exp_f32 v113, v113
    v_exp_f32 v114, v114
    v_mfma_f32_32x32x16_bf16 v[160:175], v[72:75], v[92:95], v[160:175]
    ds_read_b128 a[192:195], v20 offset:0
    v_cvt_pk_bf16_f32 v88, v112, v113
    v_exp_f32 v115, v115
    v_exp_f32 v116, v116
    v_cvt_pk_bf16_f32 v89, v114, v115
    v_exp_f32 v117, v117
    v_exp_f32 v118, v118
    v_cvt_pk_bf16_f32 v90, v116, v117
    v_exp_f32 v119, v119
    v_exp_f32 v120, v120
    v_cvt_pk_bf16_f32 v91, v118, v119
    v_exp_f32 v121, v121
    v_exp_f32 v122, v122
    v_mfma_f32_32x32x16_bf16 v[176:191], v[56:59], v[88:91], v[176:191]
    ds_read_b128 a[208:211], v21 offset:0
    v_cvt_pk_bf16_f32 v92, v120, v121
    v_exp_f32 v123, v123
    v_exp_f32 v124, v124
    v_cvt_pk_bf16_f32 v93, v122, v123
    v_exp_f32 v125, v125
    v_exp_f32 v126, v126
    v_exp_f32 v127, v127
    v_cvt_pk_bf16_f32 v94, v124, v125
    v_cvt_pk_bf16_f32 v95, v126, v127
    v_mfma_f32_32x32x16_bf16 v[112:127], v[44:47], v[36:39], v[240:255]
    ds_read_b128 a[224:227], v22 offset:0
    v_exp_f32 v96, v96
    v_exp_f32 v97, v97
    v_exp_f32 v98, v98
    v_mfma_f32_32x32x16_bf16 v[176:191], v[72:75], v[92:95], v[176:191]
    ds_read_b128 a[240:243], v23 offset:0
    v_cvt_pk_bf16_f32 v88, v96, v97
    v_exp_f32 v99, v99
    v_exp_f32 v100, v100
    v_cvt_pk_bf16_f32 v89, v98, v99
    v_exp_f32 v101, v101
    v_exp_f32 v102, v102
    v_cvt_pk_bf16_f32 v90, v100, v101
    v_exp_f32 v103, v103
    v_exp_f32 v104, v104
    v_cvt_pk_bf16_f32 v91, v102, v103
    v_exp_f32 v105, v105
    v_exp_f32 v106, v106
    v_mfma_f32_32x32x16_bf16 v[160:175], v[60:63], v[88:91], v[160:175]
    s_waitcnt vmcnt(22)
    v_cvt_pk_bf16_f32 v92, v104, v105
    v_exp_f32 v107, v107
    v_exp_f32 v108, v108
    v_cvt_pk_bf16_f32 v93, v106, v107
    v_exp_f32 v109, v109
    v_exp_f32 v110, v110
    v_exp_f32 v111, v111
    v_cvt_pk_bf16_f32 v94, v108, v109
    v_cvt_pk_bf16_f32 v95, v110, v111
    v_mfma_f32_32x32x16_bf16 v[96:111], v[48:51], v[32:35], v[224:239]
    ds_read_b128 a[196:199], v20 offset:4096
    v_exp_f32 v112, v112
    v_exp_f32 v113, v113
    v_exp_f32 v114, v114
    v_mfma_f32_32x32x16_bf16 v[160:175], v[76:79], v[92:95], v[160:175]
    ds_read_b128 a[212:215], v21 offset:4096
    v_cvt_pk_bf16_f32 v88, v112, v113
    v_exp_f32 v115, v115
    v_exp_f32 v116, v116
    v_cvt_pk_bf16_f32 v89, v114, v115
    v_exp_f32 v117, v117
    v_exp_f32 v118, v118
    v_cvt_pk_bf16_f32 v90, v116, v117
    v_exp_f32 v119, v119
    v_exp_f32 v120, v120
    v_cvt_pk_bf16_f32 v91, v118, v119
    v_exp_f32 v121, v121
    v_exp_f32 v122, v122
    v_mfma_f32_32x32x16_bf16 v[176:191], v[60:63], v[88:91], v[176:191]
    ds_read_b128 a[228:231], v22 offset:4096
    v_cvt_pk_bf16_f32 v92, v120, v121
    v_exp_f32 v123, v123
    v_exp_f32 v124, v124
    v_cvt_pk_bf16_f32 v93, v122, v123
    v_exp_f32 v125, v125
    v_exp_f32 v126, v126
    v_exp_f32 v127, v127
    v_cvt_pk_bf16_f32 v94, v124, v125
    v_cvt_pk_bf16_f32 v95, v126, v127
    v_mfma_f32_32x32x16_bf16 v[112:127], v[48:51], v[36:39], v[240:255]
    ds_read_b128 a[244:247], v23 offset:4096
    v_exp_f32 v96, v96
    v_exp_f32 v97, v97
    v_exp_f32 v98, v98
    v_mfma_f32_32x32x16_bf16 v[176:191], v[76:79], v[92:95], v[176:191]
    s_waitcnt vmcnt(11)
    v_cvt_pk_bf16_f32 v88, v96, v97
    v_exp_f32 v99, v99
    v_exp_f32 v100, v100
    v_cvt_pk_bf16_f32 v89, v98, v99
    v_exp_f32 v101, v101
    v_exp_f32 v102, v102
    v_cvt_pk_bf16_f32 v90, v100, v101
    v_exp_f32 v103, v103
    v_exp_f32 v104, v104
    v_cvt_pk_bf16_f32 v91, v102, v103
    v_exp_f32 v105, v105
    v_exp_f32 v106, v106
    v_mfma_f32_32x32x16_bf16 v[160:175], v[64:67], v[88:91], v[160:175]
    ds_read_b128 a[200:203], v20 offset:8192
    v_cvt_pk_bf16_f32 v92, v104, v105
    v_exp_f32 v107, v107
    v_exp_f32 v108, v108
    v_cvt_pk_bf16_f32 v93, v106, v107
    v_exp_f32 v109, v109
    v_exp_f32 v110, v110
    v_exp_f32 v111, v111
    v_cvt_pk_bf16_f32 v94, v108, v109
    v_cvt_pk_bf16_f32 v95, v110, v111
    v_mfma_f32_32x32x16_bf16 v[96:111], v[52:55], v[32:35], v[224:239]
    ds_read_b128 a[216:219], v21 offset:8192
    v_exp_f32 v112, v112
    v_exp_f32 v113, v113
    v_exp_f32 v114, v114
    v_mfma_f32_32x32x16_bf16 v[160:175], v[80:83], v[92:95], v[160:175]
    ds_read_b128 a[232:235], v22 offset:8192
    v_cvt_pk_bf16_f32 v88, v112, v113
    v_exp_f32 v115, v115
    v_exp_f32 v116, v116
    v_cvt_pk_bf16_f32 v89, v114, v115
    v_exp_f32 v117, v117
    v_exp_f32 v118, v118
    v_cvt_pk_bf16_f32 v90, v116, v117
    v_exp_f32 v119, v119
    v_exp_f32 v120, v120
    v_cvt_pk_bf16_f32 v91, v118, v119
    v_exp_f32 v121, v121
    v_exp_f32 v122, v122
    v_mfma_f32_32x32x16_bf16 v[176:191], v[64:67], v[88:91], v[176:191]
    ds_read_b128 a[248:251], v23 offset:8192
    v_cvt_pk_bf16_f32 v92, v120, v121
    v_exp_f32 v123, v123
    v_exp_f32 v124, v124
    v_cvt_pk_bf16_f32 v93, v122, v123
    v_exp_f32 v125, v125
    v_exp_f32 v126, v126
    v_exp_f32 v127, v127
    v_cvt_pk_bf16_f32 v94, v124, v125
    v_cvt_pk_bf16_f32 v95, v126, v127
    v_mfma_f32_32x32x16_bf16 v[112:127], v[52:55], v[36:39], v[240:255]
    s_waitcnt vmcnt(3)
    v_exp_f32 v96, v96
    v_exp_f32 v97, v97
    v_exp_f32 v98, v98
    v_mfma_f32_32x32x16_bf16 v[176:191], v[80:83], v[92:95], v[176:191]
    ds_read_b128 a[204:207], v20 offset:12288
    v_cvt_pk_bf16_f32 v88, v96, v97
    v_exp_f32 v99, v99
    v_exp_f32 v100, v100
    v_cvt_pk_bf16_f32 v89, v98, v99
    v_exp_f32 v101, v101
    v_exp_f32 v102, v102
    v_cvt_pk_bf16_f32 v90, v100, v101
    v_exp_f32 v103, v103
    v_exp_f32 v104, v104
    v_cvt_pk_bf16_f32 v91, v102, v103
    v_exp_f32 v105, v105
    v_exp_f32 v106, v106
    v_mfma_f32_32x32x16_bf16 v[160:175], v[68:71], v[88:91], v[160:175]
    ds_read_b128 a[220:223], v21 offset:12288
    v_cvt_pk_bf16_f32 v92, v104, v105
    v_exp_f32 v107, v107
    v_exp_f32 v108, v108
    v_cvt_pk_bf16_f32 v93, v106, v107
    v_exp_f32 v109, v109
    v_exp_f32 v110, v110
    v_exp_f32 v111, v111
    v_cvt_pk_bf16_f32 v94, v108, v109
    v_cvt_pk_bf16_f32 v95, v110, v111
    v_mfma_f32_32x32x16_bf16 v[96:111], v[44:47], v[24:27], v[192:207]
    ds_read_b128 a[236:239], v22 offset:12288
    v_exp_f32 v112, v112
    v_exp_f32 v113, v113
    v_exp_f32 v114, v114
    v_mfma_f32_32x32x16_bf16 v[160:175], v[84:87], v[92:95], v[160:175]
    ds_read_b128 a[252:255], v23 offset:12288
    v_cvt_pk_bf16_f32 v88, v112, v113
    v_exp_f32 v115, v115
    v_exp_f32 v116, v116
    v_cvt_pk_bf16_f32 v89, v114, v115
    v_exp_f32 v117, v117
    v_exp_f32 v118, v118
    v_cvt_pk_bf16_f32 v90, v116, v117
    v_exp_f32 v119, v119
    v_exp_f32 v120, v120
    v_cvt_pk_bf16_f32 v91, v118, v119
    v_exp_f32 v121, v121
    v_exp_f32 v122, v122
    v_mfma_f32_32x32x16_bf16 v[176:191], v[68:71], v[88:91], v[176:191]
    v_cvt_pk_bf16_f32 v92, v120, v121
    v_exp_f32 v123, v123
    v_exp_f32 v124, v124
    v_cvt_pk_bf16_f32 v93, v122, v123
    v_exp_f32 v125, v125
    v_exp_f32 v126, v126
    v_exp_f32 v127, v127
    v_cvt_pk_bf16_f32 v94, v124, v125
    v_cvt_pk_bf16_f32 v95, v126, v127
    v_mfma_f32_32x32x16_bf16 v[112:127], v[44:47], v[28:31], v[208:223]
    v_exp_f32 v96, v96
    v_exp_f32 v97, v97
    v_exp_f32 v98, v98
    v_mfma_f32_32x32x16_bf16 v[176:191], v[84:87], v[92:95], v[176:191]
    v_cvt_pk_bf16_f32 v88, v96, v97
    v_exp_f32 v99, v99
    v_exp_f32 v100, v100
    v_cvt_pk_bf16_f32 v89, v98, v99
    v_exp_f32 v101, v101
    v_exp_f32 v102, v102
    v_cvt_pk_bf16_f32 v90, v100, v101
    v_exp_f32 v103, v103
    v_exp_f32 v104, v104
    v_cvt_pk_bf16_f32 v91, v102, v103
    v_exp_f32 v105, v105
    v_exp_f32 v106, v106
    v_mfma_f32_32x32x16_bf16 v[128:143], v[60:63], v[88:91], v[128:143]
    ds_write_b128 v13, v[160:163] offset:0
    v_cvt_pk_bf16_f32 v92, v104, v105
    v_exp_f32 v107, v107
    v_exp_f32 v108, v108
    v_cvt_pk_bf16_f32 v93, v106, v107
    v_exp_f32 v109, v109
    v_exp_f32 v110, v110
    v_exp_f32 v111, v111
    v_cvt_pk_bf16_f32 v94, v108, v109
    v_cvt_pk_bf16_f32 v95, v110, v111
    v_mfma_f32_32x32x16_bf16 v[96:111], v[48:51], v[24:27], v[192:207]
    ds_write_b128 v13, v[164:167] offset:1024
    v_exp_f32 v112, v112
    v_exp_f32 v113, v113
    v_exp_f32 v114, v114
    v_mfma_f32_32x32x16_bf16 v[128:143], v[76:79], v[92:95], v[128:143]
    ds_write_b128 v13, v[176:179] offset:2048
    v_cvt_pk_bf16_f32 v88, v112, v113
    v_exp_f32 v115, v115
    v_exp_f32 v116, v116
    v_cvt_pk_bf16_f32 v89, v114, v115
    v_exp_f32 v117, v117
    v_exp_f32 v118, v118
    v_cvt_pk_bf16_f32 v90, v116, v117
    v_exp_f32 v119, v119
    v_exp_f32 v120, v120
    v_cvt_pk_bf16_f32 v91, v118, v119
    v_exp_f32 v121, v121
    v_exp_f32 v122, v122
    v_mfma_f32_32x32x16_bf16 v[144:159], v[60:63], v[88:91], v[144:159]
    ds_write_b128 v13, v[180:183] offset:3072
    v_cvt_pk_bf16_f32 v92, v120, v121
    v_exp_f32 v123, v123
    v_exp_f32 v124, v124
    v_cvt_pk_bf16_f32 v93, v122, v123
    v_exp_f32 v125, v125
    v_exp_f32 v126, v126
    v_exp_f32 v127, v127
    v_cvt_pk_bf16_f32 v94, v124, v125
    v_cvt_pk_bf16_f32 v95, v126, v127
    v_mfma_f32_32x32x16_bf16 v[112:127], v[48:51], v[28:31], v[208:223]
    ds_write_b32 v13, v168 offset:4096
    v_exp_f32 v96, v96
    v_exp_f32 v97, v97
    v_exp_f32 v98, v98
    v_mfma_f32_32x32x16_bf16 v[144:159], v[76:79], v[92:95], v[144:159]
    ds_write_b32 v13, v184 offset:4100
    v_cvt_pk_bf16_f32 v88, v96, v97
    v_exp_f32 v99, v99
    v_exp_f32 v100, v100
    v_cvt_pk_bf16_f32 v89, v98, v99
    v_exp_f32 v101, v101
    v_exp_f32 v102, v102
    v_cvt_pk_bf16_f32 v90, v100, v101
    v_exp_f32 v103, v103
    v_exp_f32 v104, v104
    v_cvt_pk_bf16_f32 v91, v102, v103
    v_exp_f32 v105, v105
    v_exp_f32 v106, v106
    v_mfma_f32_32x32x16_bf16 v[128:143], v[64:67], v[88:91], v[128:143]
    v_cvt_pk_bf16_f32 v92, v104, v105
    v_exp_f32 v107, v107
    v_exp_f32 v108, v108
    v_cvt_pk_bf16_f32 v93, v106, v107
    v_exp_f32 v109, v109
    v_exp_f32 v110, v110
    v_exp_f32 v111, v111
    v_cvt_pk_bf16_f32 v94, v108, v109
    v_cvt_pk_bf16_f32 v95, v110, v111
    v_mfma_f32_32x32x16_bf16 v[96:111], v[52:55], v[24:27], v[192:207]
    s_waitcnt vmcnt(0) lgkmcnt(0)
    s_barrier
    v_exp_f32 v112, v112
    v_exp_f32 v113, v113
    v_exp_f32 v114, v114
    v_mfma_f32_32x32x16_bf16 v[128:143], v[80:83], v[92:95], v[128:143]
    ds_read_b128 v[160:163], v14 offset:0
    v_cvt_pk_bf16_f32 v88, v112, v113
    v_exp_f32 v115, v115
    v_exp_f32 v116, v116
    v_cvt_pk_bf16_f32 v89, v114, v115
    v_exp_f32 v117, v117
    v_exp_f32 v118, v118
    v_cvt_pk_bf16_f32 v90, v116, v117
    v_exp_f32 v119, v119
    v_exp_f32 v120, v120
    v_cvt_pk_bf16_f32 v91, v118, v119
    v_exp_f32 v121, v121
    v_exp_f32 v122, v122
    v_mfma_f32_32x32x16_bf16 v[144:159], v[64:67], v[88:91], v[144:159]
    ds_read_b128 v[164:167], v14 offset:1024
    v_cvt_pk_bf16_f32 v92, v120, v121
    v_exp_f32 v123, v123
    v_exp_f32 v124, v124
    v_cvt_pk_bf16_f32 v93, v122, v123
    v_exp_f32 v125, v125
    v_exp_f32 v126, v126
    v_exp_f32 v127, v127
    v_cvt_pk_bf16_f32 v94, v124, v125
    v_cvt_pk_bf16_f32 v95, v126, v127
    v_mfma_f32_32x32x16_bf16 v[112:127], v[52:55], v[28:31], v[208:223]
    ds_read_b128 v[176:179], v14 offset:2048
    v_exp_f32 v96, v96
    v_exp_f32 v97, v97
    v_exp_f32 v98, v98
    v_mfma_f32_32x32x16_bf16 v[144:159], v[80:83], v[92:95], v[144:159]
    ds_read_b128 v[180:183], v14 offset:3072
    v_cvt_pk_bf16_f32 v88, v96, v97
    v_exp_f32 v99, v99
    v_exp_f32 v100, v100
    v_cvt_pk_bf16_f32 v89, v98, v99
    v_exp_f32 v101, v101
    v_exp_f32 v102, v102
    v_cvt_pk_bf16_f32 v90, v100, v101
    v_exp_f32 v103, v103
    v_exp_f32 v104, v104
    v_cvt_pk_bf16_f32 v91, v102, v103
    v_exp_f32 v105, v105
    v_exp_f32 v106, v106
    v_mfma_f32_32x32x16_bf16 v[128:143], v[68:71], v[88:91], v[128:143]
    ds_read_b64 v[6:7], v14 offset:4096
    v_cvt_pk_bf16_f32 v92, v104, v105
    v_exp_f32 v107, v107
    v_exp_f32 v108, v108
    v_cvt_pk_bf16_f32 v93, v106, v107
    v_exp_f32 v109, v109
    v_exp_f32 v110, v110
    v_exp_f32 v111, v111
    v_cvt_pk_bf16_f32 v94, v108, v109
    v_cvt_pk_bf16_f32 v95, v110, v111
    v_exp_f32 v112, v112
    v_exp_f32 v113, v113
    v_exp_f32 v114, v114
    v_mfma_f32_32x32x16_bf16 v[128:143], v[84:87], v[92:95], v[128:143]
    v_cvt_pk_bf16_f32 v88, v112, v113
    v_exp_f32 v115, v115
    v_exp_f32 v116, v116
    v_cvt_pk_bf16_f32 v89, v114, v115
    v_exp_f32 v117, v117
    v_exp_f32 v118, v118
    v_cvt_pk_bf16_f32 v90, v116, v117
    v_exp_f32 v119, v119
    v_exp_f32 v120, v120
    v_cvt_pk_bf16_f32 v91, v118, v119
    v_exp_f32 v121, v121
    v_exp_f32 v122, v122
    v_mfma_f32_32x32x16_bf16 v[144:159], v[68:71], v[88:91], v[144:159]
    v_cvt_pk_bf16_f32 v92, v120, v121
    v_exp_f32 v123, v123
    v_exp_f32 v124, v124
    v_cvt_pk_bf16_f32 v93, v122, v123
    v_exp_f32 v125, v125
    v_exp_f32 v126, v126
    v_exp_f32 v127, v127
    v_cvt_pk_bf16_f32 v94, v124, v125
    v_cvt_pk_bf16_f32 v95, v126, v127
k2_main_kernel_tail:
    s_nop 1
    v_mfma_f32_32x32x16_bf16 v[144:159], v[84:87], v[92:95], v[144:159]
    s_waitcnt lgkmcnt(0)
    v_add_f32 v6, v136, v6
    v_rcp_f32 v6, v6
    v_add_f32 v128, v128, v160
    v_add_f32 v129, v129, v161
    v_add_f32 v130, v130, v162
    v_add_f32 v131, v131, v163
    v_add_f32 v132, v132, v164
    v_add_f32 v133, v133, v165
    v_add_f32 v134, v134, v166
    v_add_f32 v135, v135, v167
    v_mul_f32 v128, v128, v6
    v_mul_f32 v129, v129, v6
    v_mul_f32 v130, v130, v6
    v_mul_f32 v131, v131, v6
    v_mul_f32 v132, v132, v6
    v_mul_f32 v133, v133, v6
    v_mul_f32 v134, v134, v6
    v_mul_f32 v135, v135, v6
    v_cvt_pk_bf16_f32 v96, v128, v129
    v_cvt_pk_bf16_f32 v97, v130, v131
    v_cvt_pk_bf16_f32 v98, v132, v133
    v_cvt_pk_bf16_f32 v99, v134, v135
    buffer_store_dwordx4 v[96:99], v8, s[20:23], s34 offen sc1
    v_add_f32 v7, v152, v7
    v_rcp_f32 v7, v7
    v_add_f32 v144, v144, v176
    v_add_f32 v145, v145, v177
    v_add_f32 v146, v146, v178
    v_add_f32 v147, v147, v179
    v_add_f32 v148, v148, v180
    v_add_f32 v149, v149, v181
    v_add_f32 v150, v150, v182
    v_add_f32 v151, v151, v183
    v_mul_f32 v144, v144, v7
    v_mul_f32 v145, v145, v7
    v_mul_f32 v146, v146, v7
    v_mul_f32 v147, v147, v7
    v_mul_f32 v148, v148, v7
    v_mul_f32 v149, v149, v7
    v_mul_f32 v150, v150, v7
    v_mul_f32 v151, v151, v7
    v_cvt_pk_bf16_f32 v112, v144, v145
    v_cvt_pk_bf16_f32 v113, v146, v147
    v_cvt_pk_bf16_f32 v114, v148, v149
    v_cvt_pk_bf16_f32 v115, v150, v151
    buffer_store_dwordx4 v[112:115], v8, s[20:23], s35 offen sc1
    s_lshl_b32 s19, s10, 1
    s_add_u32 s19, s19, s15
    s_lshl_b32 s43, s10, 2
    s_add_u32 s43, s43, s14
    s_lshl_b32 s18, s3, 1
    s_add_u32 s18, s18, s15
    v_lshrrev_b32 v2, 2, v11
    v_lshl_add_u32 v2, v9, 2, v2
    v_lshlrev_b32 v2, 7, v2
    v_and_b32 v3, 1, v12
    v_lshl_add_u32 v2, v3, 5, v2
    v_and_b32 v3, 3, v1
    v_lshl_add_u32 v2, v3, 3, v2
    v_lshrrev_b32 v3, 3, v11
    v_xor_b32 v3, s16, v3
    v_lshl_add_u32 v15, v3, 6, v2
    s_lshl_b32 s17, s16, 15
    s_add_u32 s17, s17, 69632
    v_add_u32 v4, s17, v15
    v_xor_b32 v5, 64, v4
    s_mul_i32 s42, s14, 7168
    s_mul_i32 s41, s11, 114688
    s_add_u32 s41, s41, s42
    s_add_u32 s41, s41, 0x1300000
    s_xor_b32 s88, s31, 0
    s_mul_i32 s88, s88, 112
    s_add_u32 s88, s88, s41
    s_xor_b32 s89, s31, 256
    s_mul_i32 s89, s89, 112
    s_add_u32 s89, s89, s41
    s_xor_b32 s90, s31, 512
    s_mul_i32 s90, s90, 112
    s_add_u32 s90, s90, s41
    s_xor_b32 s91, s31, 768
    s_mul_i32 s91, s91, 112
    s_add_u32 s91, s91, s41
    s_add_u32 m0, s42, 12288
    s_add_u32 s30, s88, 917504
    buffer_load_dwordx4 v8, s[20:23], s30 offen offset:0 sc1 lds
    ds_read_b64_tr_b16 v[128:129], v4 offset:0
    ds_read_b64_tr_b16 v[130:131], v4 offset:1024
    ds_read_b64_tr_b16 v[132:133], v5 offset:0
    ds_read_b64_tr_b16 v[134:135], v5 offset:1024
    buffer_load_dwordx4 v8, s[20:23], s30 offen offset:1024 sc1 lds
    ds_read_b64_tr_b16 v[136:137], v4 offset:2048
    ds_read_b64_tr_b16 v[138:139], v4 offset:3072
    ds_read_b64_tr_b16 v[140:141], v5 offset:2048
    ds_read_b64_tr_b16 v[142:143], v5 offset:3072
    buffer_load_dwordx4 v8, s[20:23], s30 offen offset:2048 sc1 lds
    ds_read_b64_tr_b16 v[144:145], v4 offset:4096
    ds_read_b64_tr_b16 v[146:147], v4 offset:5120
    ds_read_b64_tr_b16 v[148:149], v5 offset:4096
    ds_read_b64_tr_b16 v[150:151], v5 offset:5120
    buffer_load_dwordx4 v8, s[20:23], s30 offen offset:3072 sc1 lds
    ds_read_b64_tr_b16 v[152:153], v4 offset:6144
    ds_read_b64_tr_b16 v[154:155], v4 offset:7168
    ds_read_b64_tr_b16 v[156:157], v5 offset:6144
    ds_read_b64_tr_b16 v[158:159], v5 offset:7168
    s_add_u32 m0, s42, 16384
    s_add_u32 s30, s88, 921600
    buffer_load_dwordx4 v8, s[20:23], s30 offen offset:0 sc1 lds
    ds_read_b64_tr_b16 v[160:161], v4 offset:8192
    ds_read_b64_tr_b16 v[162:163], v4 offset:9216
    ds_read_b64_tr_b16 v[164:165], v5 offset:8192
    ds_read_b64_tr_b16 v[166:167], v5 offset:9216
    buffer_load_dwordx4 v8, s[20:23], s30 offen offset:1024 sc1 lds
    ds_read_b64_tr_b16 v[168:169], v4 offset:10240
    ds_read_b64_tr_b16 v[170:171], v4 offset:11264
    ds_read_b64_tr_b16 v[172:173], v5 offset:10240
    ds_read_b64_tr_b16 v[174:175], v5 offset:11264
    buffer_load_dwordx4 v8, s[20:23], s30 offen offset:2048 sc1 lds
    ds_read_b64_tr_b16 v[176:177], v4 offset:12288
    ds_read_b64_tr_b16 v[178:179], v4 offset:13312
    ds_read_b64_tr_b16 v[180:181], v5 offset:12288
    ds_read_b64_tr_b16 v[182:183], v5 offset:13312
    s_add_u32 m0, s42, 40960
    s_add_u32 s30, s89, 917504
    buffer_load_dwordx4 v8, s[20:23], s30 offen offset:0 sc1 lds
    ds_read_b64_tr_b16 v[184:185], v4 offset:14336
    ds_read_b64_tr_b16 v[186:187], v4 offset:15360
    ds_read_b64_tr_b16 v[188:189], v5 offset:14336
    ds_read_b64_tr_b16 v[190:191], v5 offset:15360
    v_mov_b32 v2, 0
    v_mov_b32 v3, s87
    s_mov_b64 exec, 1
    s_waitcnt vmcnt(8)
    buffer_store_dword v3, v2, s[20:23], s36 offen sc1
    s_mov_b64 exec, -1
    ds_read_b64_tr_b16 v[192:193], v4 offset:16384
    ds_read_b64_tr_b16 v[194:195], v4 offset:17408
    ds_read_b64_tr_b16 v[196:197], v5 offset:16384
    ds_read_b64_tr_b16 v[198:199], v5 offset:17408
    buffer_load_dwordx4 v8, s[20:23], s30 offen offset:1024 sc1 lds
    ds_read_b64_tr_b16 v[200:201], v4 offset:18432
    ds_read_b64_tr_b16 v[202:203], v4 offset:19456
    ds_read_b64_tr_b16 v[204:205], v5 offset:18432
    ds_read_b64_tr_b16 v[206:207], v5 offset:19456
    buffer_load_dwordx4 v8, s[20:23], s30 offen offset:2048 sc1 lds
    ds_read_b64_tr_b16 v[208:209], v4 offset:20480
    ds_read_b64_tr_b16 v[210:211], v4 offset:21504
    ds_read_b64_tr_b16 v[212:213], v5 offset:20480
    ds_read_b64_tr_b16 v[214:215], v5 offset:21504
    buffer_load_dwordx4 v8, s[20:23], s30 offen offset:3072 sc1 lds
    ds_read_b64_tr_b16 v[216:217], v4 offset:22528
    ds_read_b64_tr_b16 v[218:219], v4 offset:23552
    ds_read_b64_tr_b16 v[220:221], v5 offset:22528
    ds_read_b64_tr_b16 v[222:223], v5 offset:23552
    s_add_u32 m0, s42, 45056
    s_add_u32 s30, s89, 921600
    buffer_load_dwordx4 v8, s[20:23], s30 offen offset:0 sc1 lds
    ds_read_b64_tr_b16 v[224:225], v4 offset:24576
    ds_read_b64_tr_b16 v[226:227], v4 offset:25600
    ds_read_b64_tr_b16 v[228:229], v5 offset:24576
    ds_read_b64_tr_b16 v[230:231], v5 offset:25600
    buffer_load_dwordx4 v8, s[20:23], s30 offen offset:1024 sc1 lds
    ds_read_b64_tr_b16 v[232:233], v4 offset:26624
    ds_read_b64_tr_b16 v[234:235], v4 offset:27648
    ds_read_b64_tr_b16 v[236:237], v5 offset:26624
    ds_read_b64_tr_b16 v[238:239], v5 offset:27648
    buffer_load_dwordx4 v8, s[20:23], s30 offen offset:2048 sc1 lds
    ds_read_b64_tr_b16 v[240:241], v4 offset:28672
    ds_read_b64_tr_b16 v[242:243], v4 offset:29696
    ds_read_b64_tr_b16 v[244:245], v5 offset:28672
    ds_read_b64_tr_b16 v[246:247], v5 offset:29696
    ds_read_b64_tr_b16 v[248:249], v4 offset:30720
    ds_read_b64_tr_b16 v[250:251], v4 offset:31744
    ds_read_b64_tr_b16 v[252:253], v5 offset:30720
    ds_read_b64_tr_b16 v[254:255], v5 offset:31744
    s_lshl_b32 s17, s18, 15
    s_lshl_b32 s28, s55, 7
    s_add_u32 s17, s17, s28
    s_lshl_b32 s28, s16, 6
    s_add_u32 s17, s17, s28
    v_lshlrev_b32 v2, 10, v10
    v_add_u32 v16, s17, v2
    v_and_b32 v2, 7, v1
    s_lshl_b32 s28, s16, 2
    v_xor_b32 v2, s28, v2
    v_lshlrev_b32 v2, 4, v2
    v_lshl_add_u32 v2, v11, 7, v2
    v_lshl_add_u32 v2, v9, 3, v2
    v_and_b32 v3, 1, v12
    v_mul_u32_u24 v3, 7168, v3
    s_mul_i32 s28, s15, 14336
    s_add_u32 s28, s28, 140288
    v_add3_u32 v2, v2, v3, s28
    v_xor_b32 v3, 0, v2
    ds_read_b64 v[24:25], v3
    v_xor_b32 v3, 16, v2
    ds_read_b64 v[26:27], v3
    v_xor_b32 v3, 32, v2
    ds_read_b64 v[28:29], v3
    v_xor_b32 v3, 48, v2
    ds_read_b64 v[30:31], v3
    s_lshl_b32 s17, s3, 7
    s_lshl_b32 s28, s16, 6
    s_add_u32 s17, s17, s28
    s_lshl_b32 s17, s17, 5
    s_add_u32 s17, s17, 0x1740000
    v_lshlrev_b32 v3, 7, v11
    s_lshl_b32 s34, s18, 15
    s_lshl_b32 s28, s16, 14
    s_add_u32 s34, s34, s28
    s_add_u32 s34, s34, 0x700000
    s_lshl_b32 s35, s31, 4
    s_add_u32 s35, s35, s34
    s_waitcnt lgkmcnt(0)
    s_barrier
    v_lshlrev_b32 v96, 16, v24
    v_and_b32 v97, 0xffff0000, v24
    v_lshlrev_b32 v98, 16, v25
    v_and_b32 v99, 0xffff0000, v25
    v_lshlrev_b32 v100, 16, v26
    v_and_b32 v101, 0xffff0000, v26
    v_lshlrev_b32 v102, 16, v27
    v_and_b32 v103, 0xffff0000, v27
    v_lshlrev_b32 v104, 16, v28
    v_and_b32 v105, 0xffff0000, v28
    v_lshlrev_b32 v106, 16, v29
    v_and_b32 v107, 0xffff0000, v29
    v_lshlrev_b32 v108, 16, v30
    v_and_b32 v109, 0xffff0000, v30
    v_lshlrev_b32 v110, 16, v31
    v_and_b32 v111, 0xffff0000, v31
    s_add_u32 m0, s42, 69632
    s_add_u32 s30, s90, 917504
    buffer_load_dwordx4 v8, s[20:23], s30 offen offset:0 sc1 lds
    buffer_load_dwordx4 v8, s[20:23], s30 offen offset:1024 sc1 lds
    buffer_load_dwordx4 v8, s[20:23], s30 offen offset:2048 sc1 lds
    buffer_load_dwordx4 v8, s[20:23], s30 offen offset:3072 sc1 lds
    s_add_u32 m0, s42, 73728
    s_add_u32 s30, s90, 921600
    buffer_load_dwordx4 v8, s[20:23], s30 offen offset:0 sc1 lds
    buffer_load_dwordx4 v8, s[20:23], s30 offen offset:1024 sc1 lds
    buffer_load_dwordx4 v8, s[20:23], s30 offen offset:2048 sc1 lds
    s_add_u32 m0, s42, 98304
    s_add_u32 s30, s91, 917504
    buffer_load_dwordx4 v8, s[20:23], s30 offen offset:0 sc1 lds
    buffer_load_dwordx4 v8, s[20:23], s30 offen offset:1024 sc1 lds
    buffer_load_dwordx4 v8, s[20:23], s30 offen offset:2048 sc1 lds
    buffer_load_dwordx4 v8, s[20:23], s30 offen offset:3072 sc1 lds
    s_add_u32 m0, s42, 102400
    s_add_u32 s30, s91, 921600
    buffer_load_dwordx4 v8, s[20:23], s30 offen offset:0 sc1 lds
    buffer_load_dwordx4 v8, s[20:23], s30 offen offset:1024 sc1 lds
    buffer_load_dwordx4 v8, s[20:23], s30 offen offset:2048 sc1 lds
    s_mov_b32 s40, 100000
    buffer_load_dword v4, v3, s[20:23], s17 offen sc1
k2_main_kernel_pollO:
    s_waitcnt vmcnt(0)
    v_cmp_ne_u32 vcc, s87, v4
    s_cbranch_vccz k2_main_kernel_doneO
    buffer_load_dword v4, v3, s[20:23], s17 offen sc1
    s_sub_u32 s40, s40, 1
    s_cbranch_scc0 k2_main_kernel_pollO
k2_main_kernel_doneO:
    s_xor_b32 s34, s35, 0
    buffer_load_dwordx4 v[32:35], v8, s[20:23], s34 offen offset:0 sc1
    buffer_load_dwordx4 v[36:39], v8, s[20:23], s34 offen offset:1024 sc1
    buffer_load_dwordx4 v[40:43], v8, s[20:23], s34 offen offset:2048 sc1
    buffer_load_dwordx4 v[44:47], v8, s[20:23], s34 offen offset:3072 sc1
    s_xor_b32 s34, s35, 4096
    buffer_load_dwordx4 v[48:51], v8, s[20:23], s34 offen offset:0 sc1
    buffer_load_dwordx4 v[52:55], v8, s[20:23], s34 offen offset:1024 sc1
    buffer_load_dwordx4 v[56:59], v8, s[20:23], s34 offen offset:2048 sc1
    buffer_load_dwordx4 v[60:63], v8, s[20:23], s34 offen offset:3072 sc1
    s_xor_b32 s34, s35, 8192
    buffer_load_dwordx4 v[64:67], v8, s[20:23], s34 offen offset:0 sc1
    buffer_load_dwordx4 v[68:71], v8, s[20:23], s34 offen offset:1024 sc1
    buffer_load_dwordx4 v[72:75], v8, s[20:23], s34 offen offset:2048 sc1
    buffer_load_dwordx4 v[76:79], v8, s[20:23], s34 offen offset:3072 sc1
    s_xor_b32 s34, s35, 12288
    buffer_load_dwordx4 v[80:83], v8, s[20:23], s34 offen offset:0 sc1
    buffer_load_dwordx4 v[84:87], v8, s[20:23], s34 offen offset:1024 sc1
    s_waitcnt vmcnt(13)
    v_mfma_f32_32x32x16_bf16 v[96:111], v[128:131], v[32:35], v[96:111]
    v_mfma_f32_32x32x16_bf16 v[112:127], v[132:135], v[32:35], 0
    buffer_load_dwordx4 v[88:91], v8, s[20:23], s34 offen offset:2048 sc1
    s_waitcnt vmcnt(13)
    v_mfma_f32_32x32x16_bf16 v[96:111], v[136:139], v[36:39], v[96:111]
    v_mfma_f32_32x32x16_bf16 v[112:127], v[140:143], v[36:39], v[112:127]
    buffer_load_dwordx4 v[92:95], v8, s[20:23], s34 offen offset:3072 sc1
    s_waitcnt vmcnt(13)
    v_mfma_f32_32x32x16_bf16 v[96:111], v[144:147], v[40:43], v[96:111]
    v_mfma_f32_32x32x16_bf16 v[112:127], v[148:151], v[40:43], v[112:127]
    s_waitcnt vmcnt(12)
    v_mfma_f32_32x32x16_bf16 v[96:111], v[152:155], v[44:47], v[96:111]
    v_mfma_f32_32x32x16_bf16 v[112:127], v[156:159], v[44:47], v[112:127]
    s_waitcnt vmcnt(11)
    v_mfma_f32_32x32x16_bf16 v[96:111], v[160:163], v[48:51], v[96:111]
    v_mfma_f32_32x32x16_bf16 v[112:127], v[164:167], v[48:51], v[112:127]
    s_waitcnt vmcnt(10)
    v_mfma_f32_32x32x16_bf16 v[96:111], v[168:171], v[52:55], v[96:111]
    v_mfma_f32_32x32x16_bf16 v[112:127], v[172:175], v[52:55], v[112:127]
    s_waitcnt vmcnt(9)
    v_mfma_f32_32x32x16_bf16 v[96:111], v[176:179], v[56:59], v[96:111]
    v_mfma_f32_32x32x16_bf16 v[112:127], v[180:183], v[56:59], v[112:127]
    s_waitcnt vmcnt(8)
    v_mfma_f32_32x32x16_bf16 v[96:111], v[184:187], v[60:63], v[96:111]
    v_mfma_f32_32x32x16_bf16 v[112:127], v[188:191], v[60:63], v[112:127]
    s_waitcnt vmcnt(7)
    v_mfma_f32_32x32x16_bf16 v[96:111], v[192:195], v[64:67], v[96:111]
    v_mfma_f32_32x32x16_bf16 v[112:127], v[196:199], v[64:67], v[112:127]
    s_waitcnt vmcnt(6)
    v_mfma_f32_32x32x16_bf16 v[96:111], v[200:203], v[68:71], v[96:111]
    v_mfma_f32_32x32x16_bf16 v[112:127], v[204:207], v[68:71], v[112:127]
    s_waitcnt vmcnt(5)
    v_mfma_f32_32x32x16_bf16 v[96:111], v[208:211], v[72:75], v[96:111]
    v_mfma_f32_32x32x16_bf16 v[112:127], v[212:215], v[72:75], v[112:127]
    s_waitcnt vmcnt(4)
    v_mfma_f32_32x32x16_bf16 v[96:111], v[216:219], v[76:79], v[96:111]
    v_mfma_f32_32x32x16_bf16 v[112:127], v[220:223], v[76:79], v[112:127]
    s_waitcnt vmcnt(3)
    v_mfma_f32_32x32x16_bf16 v[96:111], v[224:227], v[80:83], v[96:111]
    v_mfma_f32_32x32x16_bf16 v[112:127], v[228:231], v[80:83], v[112:127]
    s_waitcnt vmcnt(2)
    v_mfma_f32_32x32x16_bf16 v[96:111], v[232:235], v[84:87], v[96:111]
    v_mfma_f32_32x32x16_bf16 v[112:127], v[236:239], v[84:87], v[112:127]
    s_waitcnt vmcnt(1)
    v_mfma_f32_32x32x16_bf16 v[96:111], v[240:243], v[88:91], v[96:111]
    v_mfma_f32_32x32x16_bf16 v[112:127], v[244:247], v[88:91], v[112:127]
    s_waitcnt vmcnt(0)
    v_mfma_f32_32x32x16_bf16 v[96:111], v[248:251], v[92:95], v[96:111]
    v_mfma_f32_32x32x16_bf16 v[112:127], v[252:255], v[92:95], v[112:127]
    s_nop 11
    ds_write_b128 v13, v[112:115] offset:0
    ds_write_b128 v13, v[116:119] offset:1024
    ds_write_b128 v13, v[120:123] offset:2048
    ds_write_b128 v13, v[124:127] offset:3072
    s_waitcnt lgkmcnt(0)
    s_barrier
    ds_read_b128 v[32:35], v14 offset:0
    ds_read_b128 v[36:39], v14 offset:1024
    ds_read_b128 v[40:43], v14 offset:2048
    ds_read_b128 v[44:47], v14 offset:3072
    v_and_b32 v2, 1, v12
    v_lshlrev_b32 v2, 14, v2
    v_lshl_add_u32 v2, v9, 8, v2
    v_lshl_add_u32 v2, v11, 4, v2
    s_lshl_b32 s17, s18, 15
    s_lshl_b32 s28, s55, 1
    s_add_u32 s28, s28, s16
    s_lshl_b32 s29, s28, 10
    s_add_u32 s17, s17, s29
    s_add_u32 s17, s17, 0x900000
    s_waitcnt lgkmcnt(0)
    v_pk_add_f32 v[96:97], v[96:97], v[32:33]
    v_pk_add_f32 v[98:99], v[98:99], v[34:35]
    v_pk_add_f32 v[100:101], v[100:101], v[36:37]
    v_pk_add_f32 v[102:103], v[102:103], v[38:39]
    v_pk_add_f32 v[104:105], v[104:105], v[40:41]
    v_pk_add_f32 v[106:107], v[106:107], v[42:43]
    v_pk_add_f32 v[108:109], v[108:109], v[44:45]
    v_pk_add_f32 v[110:111], v[110:111], v[46:47]
    v_cvt_pk_bf16_f32 v248, v96, v97
    v_cvt_pk_bf16_f32 v249, v98, v99
    v_cvt_pk_bf16_f32 v250, v100, v101
    v_cvt_pk_bf16_f32 v251, v102, v103
    v_cvt_pk_bf16_f32 v252, v104, v105
    v_cvt_pk_bf16_f32 v253, v106, v107
    v_cvt_pk_bf16_f32 v254, v108, v109
    v_cvt_pk_bf16_f32 v255, v110, v111
    buffer_store_dwordx4 v[248:251], v2, s[20:23], s17 offen sc1
    buffer_store_dwordx4 v[252:255], v2, s[20:23], s17 offen offset:512 sc1
    v_pk_add_f32 v[32:33], v[96:97], v[98:99]
    v_pk_mul_f32 v[34:35], v[96:97], v[96:97]
    v_pk_fma_f32 v[34:35], v[98:99], v[98:99], v[34:35]
    v_pk_add_f32 v[32:33], v[32:33], v[100:101]
    v_pk_fma_f32 v[34:35], v[100:101], v[100:101], v[34:35]
    v_pk_add_f32 v[32:33], v[32:33], v[102:103]
    v_pk_fma_f32 v[34:35], v[102:103], v[102:103], v[34:35]
    v_pk_add_f32 v[32:33], v[32:33], v[104:105]
    v_pk_fma_f32 v[34:35], v[104:105], v[104:105], v[34:35]
    v_pk_add_f32 v[32:33], v[32:33], v[106:107]
    v_pk_fma_f32 v[34:35], v[106:107], v[106:107], v[34:35]
    v_pk_add_f32 v[32:33], v[32:33], v[108:109]
    v_pk_fma_f32 v[34:35], v[108:109], v[108:109], v[34:35]
    v_pk_add_f32 v[32:33], v[32:33], v[110:111]
    v_pk_fma_f32 v[34:35], v[110:111], v[110:111], v[34:35]
    v_add_f32 v32, v32, v33
    v_add_f32 v33, v34, v35
    v_mov_b32 v2, v32
    s_nop 1
    v_permlane32_swap_b32 v32, v2
    v_add_f32 v32, v32, v2
    v_mov_b32 v2, v33
    s_nop 1
    v_permlane32_swap_b32 v33, v2
    v_add_f32 v33, v33, v2
    v_and_b32 v33, 0x7fffffff, v33
    v_lshlrev_b32 v2, 3, v10
    s_lshl_b32 s54, s3, 14
    s_lshl_b32 s17, s15, 12
    s_add_u32 s54, s54, s17
    s_add_u32 s54, s54, 0x1780000
    s_lshl_b32 s29, s28, 8
    s_add_u32 s17, s54, s29
    v_add_u32 v25, 62464, v8
    v_add_u32 v30, s42, v8
    v_add_u32 v31, 57344, v30
    v_mov_b32 v244, 0x3f803f80
    v_mov_b32 v245, 0x3f803f80
    v_mov_b32 v246, 0x3f803f80
    v_mov_b32 v247, 0x3f803f80
    s_waitcnt vmcnt(2)
    ds_read_b128 v[96:99], v30 offset:12288
    ds_read_b128 v[100:103], v30 offset:13312
    ds_read_b128 v[104:107], v30 offset:14336
    ds_read_b128 v[108:111], v30 offset:15360
    ds_read_b128 v[112:115], v30 offset:16384
    ds_read_b128 v[116:119], v30 offset:17408
    s_waitcnt lgkmcnt(4)
    v_mfma_f32_16x16x32_bf16 v[152:155], v[96:99], v[244:247], 0
    ds_read_b128 v[120:123], v30 offset:18432
    v_mfma_f32_16x16x32_bf16 v[156:159], v[100:103], v[244:247], 0
    ds_read_b128 v[96:99], v30 offset:40960
    s_waitcnt lgkmcnt(4)
    v_mfma_f32_16x16x32_bf16 v[160:163], v[104:107], v[244:247], 0
    ds_read_b128 v[100:103], v30 offset:41984
    v_mfma_f32_16x16x32_bf16 v[164:167], v[108:111], v[244:247], 0
    ds_read_b128 v[104:107], v30 offset:43008
    s_waitcnt lgkmcnt(4)
    v_mfma_f32_16x16x32_bf16 v[168:171], v[112:115], v[244:247], 0
    ds_read_b128 v[108:111], v30 offset:44032
    v_mfma_f32_16x16x32_bf16 v[172:175], v[116:119], v[244:247], 0
    ds_read_b128 v[112:115], v30 offset:45056
    s_waitcnt lgkmcnt(4)
    v_mfma_f32_16x16x32_bf16 v[176:179], v[120:123], v[244:247], 0
    ds_read_b128 v[116:119], v30 offset:46080
    v_mfma_f32_16x16x32_bf16 v[152:155], v[96:99], v[244:247], v[152:155]
    ds_read_b128 v[120:123], v30 offset:47104
    s_waitcnt lgkmcnt(4)
    v_mfma_f32_16x16x32_bf16 v[156:159], v[100:103], v[244:247], v[156:159]
    ds_read_b128 v[96:99], v31 offset:12288
    v_mfma_f32_16x16x32_bf16 v[160:163], v[104:107], v[244:247], v[160:163]
    ds_read_b128 v[100:103], v31 offset:13312
    s_waitcnt lgkmcnt(4)
    v_mfma_f32_16x16x32_bf16 v[164:167], v[108:111], v[244:247], v[164:167]
    ds_read_b128 v[104:107], v31 offset:14336
    v_mfma_f32_16x16x32_bf16 v[168:171], v[112:115], v[244:247], v[168:171]
    ds_read_b128 v[108:111], v31 offset:15360
    s_waitcnt lgkmcnt(4)
    v_mfma_f32_16x16x32_bf16 v[172:175], v[116:119], v[244:247], v[172:175]
    ds_read_b128 v[112:115], v31 offset:16384
    v_mfma_f32_16x16x32_bf16 v[176:179], v[120:123], v[244:247], v[176:179]
    ds_read_b128 v[116:119], v31 offset:17408
    s_waitcnt lgkmcnt(4)
    v_mfma_f32_16x16x32_bf16 v[152:155], v[96:99], v[244:247], v[152:155]
    ds_read_b128 v[120:123], v31 offset:18432
    v_mfma_f32_16x16x32_bf16 v[156:159], v[100:103], v[244:247], v[156:159]
    ds_read_b128 v[96:99], v31 offset:40960
    s_waitcnt lgkmcnt(4)
    v_mfma_f32_16x16x32_bf16 v[160:163], v[104:107], v[244:247], v[160:163]
    ds_read_b128 v[100:103], v31 offset:41984
    v_mfma_f32_16x16x32_bf16 v[164:167], v[108:111], v[244:247], v[164:167]
    ds_read_b128 v[104:107], v31 offset:43008
    s_waitcnt lgkmcnt(4)
    v_mfma_f32_16x16x32_bf16 v[168:171], v[112:115], v[244:247], v[168:171]
    ds_read_b128 v[108:111], v31 offset:44032
    v_mfma_f32_16x16x32_bf16 v[172:175], v[116:119], v[244:247], v[172:175]
    ds_read_b128 v[112:115], v31 offset:45056
    s_waitcnt lgkmcnt(4)
    v_mfma_f32_16x16x32_bf16 v[176:179], v[120:123], v[244:247], v[176:179]
    ds_read_b128 v[116:119], v31 offset:46080
    v_mfma_f32_16x16x32_bf16 v[152:155], v[96:99], v[244:247], v[152:155]
    ds_read_b128 v[120:123], v31 offset:47104
    s_waitcnt lgkmcnt(4)
    v_mfma_f32_16x16x32_bf16 v[156:159], v[100:103], v[244:247], v[156:159]
    v_mfma_f32_16x16x32_bf16 v[160:163], v[104:107], v[244:247], v[160:163]
    s_waitcnt lgkmcnt(2)
    v_mfma_f32_16x16x32_bf16 v[164:167], v[108:111], v[244:247], v[164:167]
    v_mfma_f32_16x16x32_bf16 v[168:171], v[112:115], v[244:247], v[168:171]
    s_waitcnt lgkmcnt(0)
    v_mfma_f32_16x16x32_bf16 v[172:175], v[116:119], v[244:247], v[172:175]
    v_mfma_f32_16x16x32_bf16 v[176:179], v[120:123], v[244:247], v[176:179]
    s_mov_b32 exec_hi, 0
    s_waitcnt vmcnt(0)
    buffer_store_dwordx2 v[32:33], v2, s[20:23], s17 offen sc1
    s_mov_b64 exec, -1
    s_mul_i32 s28, s14, 448
    s_add_u32 s28, s28, 140288
    v_lshl_add_u32 v4, v12, 4, s28
    s_mov_b32 exec_lo, 0x00010001
    s_mov_b32 exec_hi, 0x00010001
    ds_write_b128 v4, v[152:155] offset:0
    ds_write_b128 v4, v[156:159] offset:64
    ds_write_b128 v4, v[160:163] offset:128
    ds_write_b128 v4, v[164:167] offset:192
    ds_write_b128 v4, v[168:171] offset:256
    ds_write_b128 v4, v[172:175] offset:320
    ds_write_b128 v4, v[176:179] offset:384
    s_mov_b64 exec, -1
    v_min_u32 v3, 27, v1
    v_lshlrev_b32 v3, 4, v3
    v_add_u32 v17, 140288, v3
    s_add_u32 s28, s42, 139776
    v_add_u32 v23, s28, v3
    v_lshl_add_u32 v24, v12, 4, s28
    v_lshlrev_b32 v5, 10, v12
    v_lshl_add_u32 v5, v11, 3, v5
    s_lshl_b32 s17, s10, 14
    s_lshl_b32 s28, s15, 12
    s_add_u32 s17, s17, s28
    s_lshl_b32 s28, s16, 7
    s_add_u32 s17, s17, s28
    s_add_u32 s17, s17, 0x1780000
    s_lshl_b32 s34, s43, 14
    s_add_u32 s34, s34, 0x900000
    s_lshl_b32 s35, s31, 4
    s_add_u32 s35, s35, s34
    s_mov_b32 s36, 0xbdd2d3e8
    s_mov_b32 s37, 0xbdd2d3e8
    v_mov_b32 v6, 0xc0135761
    v_mov_b32 v7, 0xc0135761
    s_add_u32 s28, s42, 135168
    v_mul_u32_u24 v19, 264, v11
    v_lshl_add_u32 v19, v12, 3, v19
    v_add_u32 v19, s28, v19
    v_and_b32 v3, 1, v12
    v_lshrrev_b32 v20, 2, v11
    v_lshl_add_u32 v20, v3, 3, v20
    v_mul_u32_u24 v20, 264, v20
    v_lshl_add_u32 v20, v9, 5, v20
    v_and_b32 v3, 3, v1
    v_lshl_add_u32 v20, v3, 3, v20
    v_add_u32 v20, s28, v20
    v_lshlrev_b32 v21, 10, v9
    v_lshl_add_u32 v21, v10, 4, v21
    s_lshl_b32 s38, s11, 6
    s_add_u32 s38, s38, s19
    s_mul_i32 s38, s38, 7168
    s_lshl_b32 s28, s16, 9
    s_add_u32 s38, s38, s28
    s_add_u32 s38, s38, 0xb00000
    s_add_u32 s39, s38, 4096
    s_lshl_b32 s32, s10, 14
    s_lshl_b32 s28, s14, 10
    s_add_u32 s32, s32, s28
    s_add_u32 s32, s32, 0x1782000
    s_lshl_b32 s33, s11, 7
    s_add_u32 s33, s33, s32
    v_lshlrev_b32 v3, 3, v11
    s_waitcnt lgkmcnt(0)
    s_barrier
    ds_read_b128 v[124:127], v17 offset:0
    ds_read_b128 v[128:131], v17 offset:448
    ds_read_b128 v[132:135], v17 offset:896
    ds_read_b128 v[136:139], v17 offset:1344
    s_waitcnt lgkmcnt(0)
    v_pk_add_f32 v[124:125], v[124:125], v[128:129]
    v_pk_add_f32 v[126:127], v[126:127], v[130:131]
    v_pk_add_f32 v[132:133], v[132:133], v[136:137]
    v_pk_add_f32 v[134:135], v[134:135], v[138:139]
    v_pk_add_f32 v[124:125], v[124:125], v[132:133]
    v_pk_add_f32 v[126:127], v[126:127], v[134:135]
    ds_write_b128 v23, v[124:127]
    ds_read_b128 v[152:155], v24 offset:0
    ds_read_b128 v[156:159], v24 offset:64
    ds_read_b128 v[160:163], v24 offset:128
    ds_read_b128 v[164:167], v24 offset:192
    ds_read_b128 v[168:171], v24 offset:256
    ds_read_b128 v[172:175], v24 offset:320
    ds_read_b128 v[176:179], v24 offset:384
    s_mov_b32 s40, 100000
    buffer_load_dwordx2 v[236:237], v5, s[20:23], s17 offen offset:0 sc1
    buffer_load_dwordx2 v[238:239], v5, s[20:23], s17 offen offset:256 sc1
    buffer_load_dwordx2 v[240:241], v5, s[20:23], s17 offen offset:512 sc1
    buffer_load_dwordx2 v[242:243], v5, s[20:23], s17 offen offset:768 sc1
k2_main_kernel_pollA:
    s_waitcnt vmcnt(0)
    v_max_u32 v2, v237, v239
    v_max3_u32 v2, v2, v241, v243
    v_cmp_eq_u32 vcc, -1, v2
    s_cbranch_vccz k2_main_kernel_okA0
    buffer_load_dwordx2 v[236:237], v5, s[20:23], s17 offen offset:0 sc1
    buffer_load_dwordx2 v[238:239], v5, s[20:23], s17 offen offset:256 sc1
    buffer_load_dwordx2 v[240:241], v5, s[20:23], s17 offen offset:512 sc1
    buffer_load_dwordx2 v[242:243], v5, s[20:23], s17 offen offset:768 sc1
    s_sub_u32 s40, s40, 1
    s_cbranch_scc0 k2_main_kernel_pollA
k2_main_kernel_okA0:
k2_main_kernel_doneA:
    s_xor_b32 s34, s35, 0
    buffer_load_dwordx4 v[32:35], v8, s[20:23], s34 offen offset:0 sc1
    buffer_load_dwordx4 v[36:39], v8, s[20:23], s34 offen offset:1024 sc1
    buffer_load_dwordx4 v[40:43], v8, s[20:23], s34 offen offset:2048 sc1
    buffer_load_dwordx4 v[44:47], v8, s[20:23], s34 offen offset:3072 sc1
    s_xor_b32 s34, s35, 4096
    buffer_load_dwordx4 v[48:51], v8, s[20:23], s34 offen offset:0 sc1
    buffer_load_dwordx4 v[52:55], v8, s[20:23], s34 offen offset:1024 sc1
    buffer_load_dwordx4 v[56:59], v8, s[20:23], s34 offen offset:2048 sc1
    buffer_load_dwordx4 v[60:63], v8, s[20:23], s34 offen offset:3072 sc1
    s_xor_b32 s34, s35, 8192
    buffer_load_dwordx4 v[64:67], v8, s[20:23], s34 offen offset:0 sc1
    buffer_load_dwordx4 v[68:71], v8, s[20:23], s34 offen offset:1024 sc1
    buffer_load_dwordx4 v[72:75], v8, s[20:23], s34 offen offset:2048 sc1
    buffer_load_dwordx4 v[76:79], v8, s[20:23], s34 offen offset:3072 sc1
    s_xor_b32 s34, s35, 12288
    buffer_load_dwordx4 v[80:83], v8, s[20:23], s34 offen offset:0 sc1
    buffer_load_dwordx4 v[84:87], v8, s[20:23], s34 offen offset:1024 sc1
    v_pk_add_f32 v[236:237], v[236:237], v[238:239]
    v_pk_add_f32 v[240:241], v[240:241], v[242:243]
    v_pk_add_f32 v[236:237], v[236:237], v[240:241]
    v_mov_b32 v2, v236
    v_mov_b32 v4, v237
    s_nop 0
    v_permlane32_swap_b32 v236, v2
    v_permlane32_swap_b32 v237, v4
    v_add_f32 v236, v236, v2
    v_add_f32 v237, v237, v4
    v_mov_b32 v2, v236
    v_mov_b32 v4, v237
    s_nop 0
    v_permlane16_swap_b32 v236, v2
    v_permlane16_swap_b32 v237, v4
    v_add_f32 v236, v236, v2
    v_add_f32 v237, v237, v4
    v_mul_f32 v26, 0xbb000000, v236
    v_mul_f32 v237, 0x3b000000, v237
    v_fma_f32 v237, -v26, v26, v237
    v_max_f32 v237, 0, v237
    v_add_f32 v237, 0x3727c5ac, v237
    v_rsq_f32 v28, v237
    v_mov_b32 v27, v26
    v_mov_b32 v29, v28
    s_waitcnt lgkmcnt(0)
    ds_read_b128 v[96:99], v8 offset:12288
    ds_read_b128 v[100:103], v8 offset:13312
    ds_read_b128 v[104:107], v8 offset:14336
    ds_read_b128 v[108:111], v8 offset:15360
    ds_read_b128 v[112:115], v8 offset:16384
    ds_read_b128 v[116:119], v8 offset:17408
    s_waitcnt vmcnt(13)
    s_waitcnt lgkmcnt(4)
    v_mfma_f32_16x16x32_bf16 v[208:211], v[96:99], v[32:35], 0
    ds_read_b128 v[120:123], v8 offset:18432
    buffer_load_dwordx4 v[88:91], v8, s[20:23], s34 offen offset:2048 sc1
    v_mfma_f32_16x16x32_bf16 v[212:215], v[100:103], v[32:35], 0
    ds_read_b128 v[96:99], v8 offset:19456
    s_waitcnt lgkmcnt(4)
    v_mfma_f32_16x16x32_bf16 v[216:219], v[104:107], v[32:35], 0
    ds_read_b128 v[100:103], v8 offset:20480
    buffer_load_dwordx4 v[92:95], v8, s[20:23], s34 offen offset:3072 sc1
    v_mfma_f32_16x16x32_bf16 v[220:223], v[108:111], v[32:35], 0
    ds_read_b128 v[104:107], v8 offset:21504
    s_waitcnt lgkmcnt(4)
    v_mfma_f32_16x16x32_bf16 v[224:227], v[112:115], v[32:35], 0
    ds_read_b128 v[108:111], v8 offset:22528
    v_mfma_f32_16x16x32_bf16 v[228:231], v[116:119], v[32:35], 0
    ds_read_b128 v[112:115], v8 offset:23552
    s_waitcnt lgkmcnt(4)
    v_mfma_f32_16x16x32_bf16 v[232:235], v[120:123], v[32:35], 0
    ds_read_b128 v[116:119], v8 offset:24576
    s_waitcnt vmcnt(14)
    v_mfma_f32_16x16x32_bf16 v[208:211], v[96:99], v[36:39], v[208:211]
    ds_read_b128 v[120:123], v8 offset:25600
    s_waitcnt lgkmcnt(4)
    v_mfma_f32_16x16x32_bf16 v[212:215], v[100:103], v[36:39], v[212:215]
    ds_read_b128 v[96:99], v8 offset:26624
    v_mfma_f32_16x16x32_bf16 v[216:219], v[104:107], v[36:39], v[216:219]
    ds_read_b128 v[100:103], v8 offset:27648
    s_waitcnt lgkmcnt(4)
    v_mfma_f32_16x16x32_bf16 v[220:223], v[108:111], v[36:39], v[220:223]
    ds_read_b128 v[104:107], v8 offset:28672
    v_mfma_f32_16x16x32_bf16 v[224:227], v[112:115], v[36:39], v[224:227]
    ds_read_b128 v[108:111], v8 offset:29696
    s_waitcnt lgkmcnt(4)
    v_mfma_f32_16x16x32_bf16 v[228:231], v[116:119], v[36:39], v[228:231]
    ds_read_b128 v[112:115], v8 offset:30720
    v_mfma_f32_16x16x32_bf16 v[232:235], v[120:123], v[36:39], v[232:235]
    ds_read_b128 v[116:119], v8 offset:31744
    s_waitcnt vmcnt(13)
    s_waitcnt lgkmcnt(4)
    v_mfma_f32_16x16x32_bf16 v[208:211], v[96:99], v[40:43], v[208:211]
    ds_read_b128 v[120:123], v8 offset:32768
    v_mfma_f32_16x16x32_bf16 v[212:215], v[100:103], v[40:43], v[212:215]
    ds_read_b128 v[96:99], v8 offset:33792
    s_waitcnt lgkmcnt(4)
    v_mfma_f32_16x16x32_bf16 v[216:219], v[104:107], v[40:43], v[216:219]
    ds_read_b128 v[100:103], v8 offset:34816
    v_mfma_f32_16x16x32_bf16 v[220:223], v[108:111], v[40:43], v[220:223]
    ds_read_b128 v[104:107], v8 offset:35840
    s_waitcnt lgkmcnt(4)
    v_mfma_f32_16x16x32_bf16 v[224:227], v[112:115], v[40:43], v[224:227]
    ds_read_b128 v[108:111], v8 offset:36864
    v_mfma_f32_16x16x32_bf16 v[228:231], v[116:119], v[40:43], v[228:231]
    ds_read_b128 v[112:115], v8 offset:37888
    s_waitcnt lgkmcnt(4)
    v_mfma_f32_16x16x32_bf16 v[232:235], v[120:123], v[40:43], v[232:235]
    ds_read_b128 v[116:119], v8 offset:38912
    s_waitcnt vmcnt(12)
    v_mfma_f32_16x16x32_bf16 v[208:211], v[96:99], v[44:47], v[208:211]
    ds_read_b128 v[120:123], v8 offset:39936
    s_waitcnt lgkmcnt(4)
    v_mfma_f32_16x16x32_bf16 v[212:215], v[100:103], v[44:47], v[212:215]
    ds_read_b128 v[96:99], v8 offset:40960
    v_mfma_f32_16x16x32_bf16 v[216:219], v[104:107], v[44:47], v[216:219]
    ds_read_b128 v[100:103], v8 offset:41984
    s_waitcnt lgkmcnt(4)
    v_mfma_f32_16x16x32_bf16 v[220:223], v[108:111], v[44:47], v[220:223]
    ds_read_b128 v[104:107], v8 offset:43008
    v_mfma_f32_16x16x32_bf16 v[224:227], v[112:115], v[44:47], v[224:227]
    ds_read_b128 v[108:111], v8 offset:44032
    s_waitcnt lgkmcnt(4)
    v_mfma_f32_16x16x32_bf16 v[228:231], v[116:119], v[44:47], v[228:231]
    ds_read_b128 v[112:115], v8 offset:45056
    v_mfma_f32_16x16x32_bf16 v[232:235], v[120:123], v[44:47], v[232:235]
    ds_read_b128 v[116:119], v8 offset:46080
    s_waitcnt vmcnt(11)
    s_waitcnt lgkmcnt(4)
    v_mfma_f32_16x16x32_bf16 v[208:211], v[96:99], v[48:51], v[208:211]
    ds_read_b128 v[120:123], v8 offset:47104
    v_mfma_f32_16x16x32_bf16 v[212:215], v[100:103], v[48:51], v[212:215]
    ds_read_b128 v[96:99], v8 offset:48128
    s_waitcnt lgkmcnt(4)
    v_mfma_f32_16x16x32_bf16 v[216:219], v[104:107], v[48:51], v[216:219]
    ds_read_b128 v[100:103], v8 offset:49152
    v_mfma_f32_16x16x32_bf16 v[220:223], v[108:111], v[48:51], v[220:223]
    ds_read_b128 v[104:107], v8 offset:50176
    s_waitcnt lgkmcnt(4)
    v_mfma_f32_16x16x32_bf16 v[224:227], v[112:115], v[48:51], v[224:227]
    ds_read_b128 v[108:111], v8 offset:51200
    v_mfma_f32_16x16x32_bf16 v[228:231], v[116:119], v[48:51], v[228:231]
    ds_read_b128 v[112:115], v8 offset:52224
    s_waitcnt lgkmcnt(4)
    v_mfma_f32_16x16x32_bf16 v[232:235], v[120:123], v[48:51], v[232:235]
    ds_read_b128 v[116:119], v8 offset:53248
    s_waitcnt vmcnt(10)
    v_mfma_f32_16x16x32_bf16 v[208:211], v[96:99], v[52:55], v[208:211]
    ds_read_b128 v[120:123], v8 offset:54272
    s_waitcnt lgkmcnt(4)
    v_mfma_f32_16x16x32_bf16 v[212:215], v[100:103], v[52:55], v[212:215]
    ds_read_b128 v[96:99], v8 offset:55296
    v_mfma_f32_16x16x32_bf16 v[216:219], v[104:107], v[52:55], v[216:219]
    ds_read_b128 v[100:103], v8 offset:56320
    s_waitcnt lgkmcnt(4)
    v_mfma_f32_16x16x32_bf16 v[220:223], v[108:111], v[52:55], v[220:223]
    ds_read_b128 v[104:107], v8 offset:57344
    v_mfma_f32_16x16x32_bf16 v[224:227], v[112:115], v[52:55], v[224:227]
    ds_read_b128 v[108:111], v8 offset:58368
    s_waitcnt lgkmcnt(4)
    v_mfma_f32_16x16x32_bf16 v[228:231], v[116:119], v[52:55], v[228:231]
    ds_read_b128 v[112:115], v8 offset:59392
    v_mfma_f32_16x16x32_bf16 v[232:235], v[120:123], v[52:55], v[232:235]
    ds_read_b128 v[116:119], v8 offset:60416
    s_waitcnt vmcnt(9)
    s_waitcnt lgkmcnt(4)
    v_mfma_f32_16x16x32_bf16 v[208:211], v[96:99], v[56:59], v[208:211]
    ds_read_b128 v[120:123], v8 offset:61440
    v_mfma_f32_16x16x32_bf16 v[212:215], v[100:103], v[56:59], v[212:215]
    ds_read_b128 v[96:99], v25 offset:0
    s_waitcnt lgkmcnt(4)
    v_mfma_f32_16x16x32_bf16 v[216:219], v[104:107], v[56:59], v[216:219]
    ds_read_b128 v[100:103], v25 offset:1024
    v_mfma_f32_16x16x32_bf16 v[220:223], v[108:111], v[56:59], v[220:223]
    ds_read_b128 v[104:107], v25 offset:2048
    s_waitcnt lgkmcnt(4)
    v_mfma_f32_16x16x32_bf16 v[224:227], v[112:115], v[56:59], v[224:227]
    ds_read_b128 v[108:111], v25 offset:3072
    v_mfma_f32_16x16x32_bf16 v[228:231], v[116:119], v[56:59], v[228:231]
    ds_read_b128 v[112:115], v25 offset:4096
    s_waitcnt lgkmcnt(4)
    v_mfma_f32_16x16x32_bf16 v[232:235], v[120:123], v[56:59], v[232:235]
    ds_read_b128 v[116:119], v25 offset:5120
    s_waitcnt vmcnt(8)
    v_mfma_f32_16x16x32_bf16 v[208:211], v[96:99], v[60:63], v[208:211]
    ds_read_b128 v[120:123], v25 offset:6144
    s_waitcnt lgkmcnt(4)
    v_mfma_f32_16x16x32_bf16 v[212:215], v[100:103], v[60:63], v[212:215]
    ds_read_b128 v[96:99], v25 offset:7168
    v_mfma_f32_16x16x32_bf16 v[216:219], v[104:107], v[60:63], v[216:219]
    ds_read_b128 v[100:103], v25 offset:8192
    s_waitcnt lgkmcnt(4)
    v_mfma_f32_16x16x32_bf16 v[220:223], v[108:111], v[60:63], v[220:223]
    ds_read_b128 v[104:107], v25 offset:9216
    v_mfma_f32_16x16x32_bf16 v[224:227], v[112:115], v[60:63], v[224:227]
    ds_read_b128 v[108:111], v25 offset:10240
    s_waitcnt lgkmcnt(4)
    v_mfma_f32_16x16x32_bf16 v[228:231], v[116:119], v[60:63], v[228:231]
    ds_read_b128 v[112:115], v25 offset:11264
    v_mfma_f32_16x16x32_bf16 v[232:235], v[120:123], v[60:63], v[232:235]
    ds_read_b128 v[116:119], v25 offset:12288
    s_waitcnt vmcnt(7)
    s_barrier
    s_waitcnt lgkmcnt(4)
    v_mfma_f32_16x16x32_bf16 v[208:211], v[96:99], v[64:67], v[208:211]
    ds_read_b128 v[120:123], v25 offset:13312
    s_add_u32 m0, s42, 12288
    s_add_u32 s30, s88, 0
    buffer_load_dwordx4 v8, s[20:23], s30 offen offset:0 sc1 lds
    v_mfma_f32_16x16x32_bf16 v[212:215], v[100:103], v[64:67], v[212:215]
    ds_read_b128 v[96:99], v25 offset:14336
    s_waitcnt lgkmcnt(4)
    v_mfma_f32_16x16x32_bf16 v[216:219], v[104:107], v[64:67], v[216:219]
    ds_read_b128 v[100:103], v25 offset:15360
    v_mfma_f32_16x16x32_bf16 v[220:223], v[108:111], v[64:67], v[220:223]
    ds_read_b128 v[104:107], v25 offset:16384
    s_waitcnt lgkmcnt(4)
    v_mfma_f32_16x16x32_bf16 v[224:227], v[112:115], v[64:67], v[224:227]
    ds_read_b128 v[108:111], v25 offset:17408
    buffer_load_dwordx4 v8, s[20:23], s30 offen offset:1024 sc1 lds
    v_mfma_f32_16x16x32_bf16 v[228:231], v[116:119], v[64:67], v[228:231]
    ds_read_b128 v[112:115], v25 offset:18432
    s_waitcnt lgkmcnt(4)
    v_mfma_f32_16x16x32_bf16 v[232:235], v[120:123], v[64:67], v[232:235]
    ds_read_b128 v[116:119], v25 offset:19456
    s_waitcnt vmcnt(8)
    v_mfma_f32_16x16x32_bf16 v[208:211], v[96:99], v[68:71], v[208:211]
    ds_read_b128 v[120:123], v25 offset:20480
    s_waitcnt lgkmcnt(4)
    v_mfma_f32_16x16x32_bf16 v[212:215], v[100:103], v[68:71], v[212:215]
    ds_read_b128 v[96:99], v25 offset:21504
    buffer_load_dwordx4 v8, s[20:23], s30 offen offset:2048 sc1 lds
    v_mfma_f32_16x16x32_bf16 v[216:219], v[104:107], v[68:71], v[216:219]
    ds_read_b128 v[100:103], v25 offset:22528
    s_waitcnt lgkmcnt(4)
    v_mfma_f32_16x16x32_bf16 v[220:223], v[108:111], v[68:71], v[220:223]
    ds_read_b128 v[104:107], v25 offset:23552
    v_mfma_f32_16x16x32_bf16 v[224:227], v[112:115], v[68:71], v[224:227]
    ds_read_b128 v[108:111], v25 offset:24576
    s_waitcnt lgkmcnt(4)
    v_mfma_f32_16x16x32_bf16 v[228:231], v[116:119], v[68:71], v[228:231]
    ds_read_b128 v[112:115], v25 offset:25600
    buffer_load_dwordx4 v8, s[20:23], s30 offen offset:3072 sc1 lds
    v_mfma_f32_16x16x32_bf16 v[232:235], v[120:123], v[68:71], v[232:235]
    ds_read_b128 v[116:119], v25 offset:26624
    s_waitcnt vmcnt(9)
    s_waitcnt lgkmcnt(4)
    v_mfma_f32_16x16x32_bf16 v[208:211], v[96:99], v[72:75], v[208:211]
    ds_read_b128 v[120:123], v25 offset:27648
    v_mfma_f32_16x16x32_bf16 v[212:215], v[100:103], v[72:75], v[212:215]
    ds_read_b128 v[96:99], v25 offset:28672
    s_waitcnt lgkmcnt(4)
    v_mfma_f32_16x16x32_bf16 v[216:219], v[104:107], v[72:75], v[216:219]
    ds_read_b128 v[100:103], v25 offset:29696
    s_add_u32 m0, s42, 16384
    s_add_u32 s30, s88, 4096
    buffer_load_dwordx4 v8, s[20:23], s30 offen offset:0 sc1 lds
    v_mfma_f32_16x16x32_bf16 v[220:223], v[108:111], v[72:75], v[220:223]
    ds_read_b128 v[104:107], v25 offset:30720
    s_waitcnt lgkmcnt(4)
    v_mfma_f32_16x16x32_bf16 v[224:227], v[112:115], v[72:75], v[224:227]
    ds_read_b128 v[108:111], v25 offset:31744
    v_mfma_f32_16x16x32_bf16 v[228:231], v[116:119], v[72:75], v[228:231]
    ds_read_b128 v[112:115], v25 offset:32768
    s_waitcnt lgkmcnt(4)
    v_mfma_f32_16x16x32_bf16 v[232:235], v[120:123], v[72:75], v[232:235]
    ds_read_b128 v[116:119], v25 offset:33792
    s_waitcnt vmcnt(9)
    buffer_load_dwordx4 v8, s[20:23], s30 offen offset:1024 sc1 lds
    v_mfma_f32_16x16x32_bf16 v[208:211], v[96:99], v[76:79], v[208:211]
    ds_read_b128 v[120:123], v25 offset:34816
    s_waitcnt lgkmcnt(4)
    v_mfma_f32_16x16x32_bf16 v[212:215], v[100:103], v[76:79], v[212:215]
    ds_read_b128 v[96:99], v25 offset:35840
    v_mfma_f32_16x16x32_bf16 v[216:219], v[104:107], v[76:79], v[216:219]
    ds_read_b128 v[100:103], v25 offset:36864
    s_waitcnt lgkmcnt(4)
    v_mfma_f32_16x16x32_bf16 v[220:223], v[108:111], v[76:79], v[220:223]
    ds_read_b128 v[104:107], v25 offset:37888
    buffer_load_dwordx4 v8, s[20:23], s30 offen offset:2048 sc1 lds
    v_mfma_f32_16x16x32_bf16 v[224:227], v[112:115], v[76:79], v[224:227]
    ds_read_b128 v[108:111], v25 offset:38912
    s_waitcnt lgkmcnt(4)
    v_mfma_f32_16x16x32_bf16 v[228:231], v[116:119], v[76:79], v[228:231]
    ds_read_b128 v[112:115], v25 offset:39936
    v_mfma_f32_16x16x32_bf16 v[232:235], v[120:123], v[76:79], v[232:235]
    ds_read_b128 v[116:119], v25 offset:40960
    s_waitcnt vmcnt(10)
    s_waitcnt lgkmcnt(4)
    v_mfma_f32_16x16x32_bf16 v[208:211], v[96:99], v[80:83], v[208:211]
    ds_read_b128 v[120:123], v25 offset:41984
    s_add_u32 m0, s42, 40960
    s_add_u32 s30, s89, 0
    buffer_load_dwordx4 v8, s[20:23], s30 offen offset:0 sc1 lds
    v_mfma_f32_16x16x32_bf16 v[212:215], v[100:103], v[80:83], v[212:215]
    ds_read_b128 v[96:99], v25 offset:43008
    s_waitcnt lgkmcnt(4)
    v_mfma_f32_16x16x32_bf16 v[216:219], v[104:107], v[80:83], v[216:219]
    ds_read_b128 v[100:103], v25 offset:44032
    v_mfma_f32_16x16x32_bf16 v[220:223], v[108:111], v[80:83], v[220:223]
    ds_read_b128 v[104:107], v25 offset:45056
    s_waitcnt lgkmcnt(4)
    v_mfma_f32_16x16x32_bf16 v[224:227], v[112:115], v[80:83], v[224:227]
    ds_read_b128 v[108:111], v25 offset:46080
    buffer_load_dwordx4 v8, s[20:23], s30 offen offset:1024 sc1 lds
    v_mfma_f32_16x16x32_bf16 v[228:231], v[116:119], v[80:83], v[228:231]
    ds_read_b128 v[112:115], v25 offset:47104
    s_waitcnt lgkmcnt(4)
    v_mfma_f32_16x16x32_bf16 v[232:235], v[120:123], v[80:83], v[232:235]
    ds_read_b128 v[116:119], v25 offset:48128
    s_waitcnt vmcnt(11)
    v_mfma_f32_16x16x32_bf16 v[208:211], v[96:99], v[84:87], v[208:211]
    ds_read_b128 v[120:123], v25 offset:49152
    s_waitcnt lgkmcnt(4)
    v_mfma_f32_16x16x32_bf16 v[212:215], v[100:103], v[84:87], v[212:215]
    ds_read_b128 v[96:99], v25 offset:50176
    buffer_load_dwordx4 v8, s[20:23], s30 offen offset:2048 sc1 lds
    v_mfma_f32_16x16x32_bf16 v[216:219], v[104:107], v[84:87], v[216:219]
    ds_read_b128 v[100:103], v25 offset:51200
    s_waitcnt lgkmcnt(4)
    v_mfma_f32_16x16x32_bf16 v[220:223], v[108:111], v[84:87], v[220:223]
    ds_read_b128 v[104:107], v25 offset:52224
    v_mfma_f32_16x16x32_bf16 v[224:227], v[112:115], v[84:87], v[224:227]
    ds_read_b128 v[108:111], v25 offset:53248
    s_waitcnt lgkmcnt(4)
    v_mfma_f32_16x16x32_bf16 v[228:231], v[116:119], v[84:87], v[228:231]
    ds_read_b128 v[112:115], v25 offset:54272
    buffer_load_dwordx4 v8, s[20:23], s30 offen offset:3072 sc1 lds
    v_mfma_f32_16x16x32_bf16 v[232:235], v[120:123], v[84:87], v[232:235]
    ds_read_b128 v[116:119], v25 offset:55296
    s_waitcnt vmcnt(12)
    s_waitcnt lgkmcnt(4)
    v_mfma_f32_16x16x32_bf16 v[208:211], v[96:99], v[88:91], v[208:211]
    ds_read_b128 v[120:123], v25 offset:56320
    v_mfma_f32_16x16x32_bf16 v[212:215], v[100:103], v[88:91], v[212:215]
    ds_read_b128 v[96:99], v25 offset:57344
    s_waitcnt lgkmcnt(4)
    v_mfma_f32_16x16x32_bf16 v[216:219], v[104:107], v[88:91], v[216:219]
    ds_read_b128 v[100:103], v25 offset:58368
    s_add_u32 m0, s42, 45056
    s_add_u32 s30, s89, 4096
    buffer_load_dwordx4 v8, s[20:23], s30 offen offset:0 sc1 lds
    v_mfma_f32_16x16x32_bf16 v[220:223], v[108:111], v[88:91], v[220:223]
    ds_read_b128 v[104:107], v25 offset:59392
    s_waitcnt lgkmcnt(4)
    v_mfma_f32_16x16x32_bf16 v[224:227], v[112:115], v[88:91], v[224:227]
    ds_read_b128 v[108:111], v25 offset:60416
    v_mfma_f32_16x16x32_bf16 v[228:231], v[116:119], v[88:91], v[228:231]
    ds_read_b128 v[112:115], v25 offset:61440
    s_waitcnt lgkmcnt(4)
    v_mfma_f32_16x16x32_bf16 v[232:235], v[120:123], v[88:91], v[232:235]
    ds_read_b128 v[116:119], v25 offset:62464
    s_waitcnt vmcnt(12)
    buffer_load_dwordx4 v8, s[20:23], s30 offen offset:1024 sc1 lds
    v_mfma_f32_16x16x32_bf16 v[208:211], v[96:99], v[92:95], v[208:211]
    ds_read_b128 v[120:123], v25 offset:63488
    s_waitcnt lgkmcnt(4)
    v_mfma_f32_16x16x32_bf16 v[212:215], v[100:103], v[92:95], v[212:215]
    v_mfma_f32_16x16x32_bf16 v[216:219], v[104:107], v[92:95], v[216:219]
    s_waitcnt lgkmcnt(2)
    v_mfma_f32_16x16x32_bf16 v[220:223], v[108:111], v[92:95], v[220:223]
    buffer_load_dwordx4 v8, s[20:23], s30 offen offset:2048 sc1 lds
    v_mfma_f32_16x16x32_bf16 v[224:227], v[112:115], v[92:95], v[224:227]
    s_waitcnt lgkmcnt(0)
    v_mfma_f32_16x16x32_bf16 v[228:231], v[116:119], v[92:95], v[228:231]
    v_mfma_f32_16x16x32_bf16 v[232:235], v[120:123], v[92:95], v[232:235]
    s_barrier
    v_pk_fma_f32 v[208:209], v[152:153], v[26:27], v[208:209]
    v_pk_fma_f32 v[210:211], v[154:155], v[26:27], v[210:211]
    v_pk_fma_f32 v[212:213], v[156:157], v[26:27], v[212:213]
    v_pk_fma_f32 v[214:215], v[158:159], v[26:27], v[214:215]
    v_pk_fma_f32 v[216:217], v[160:161], v[26:27], v[216:217]
    v_pk_fma_f32 v[218:219], v[162:163], v[26:27], v[218:219]
    v_pk_fma_f32 v[220:221], v[164:165], v[26:27], v[220:221]
    v_pk_fma_f32 v[222:223], v[166:167], v[26:27], v[222:223]
    v_pk_fma_f32 v[224:225], v[168:169], v[26:27], v[224:225]
    v_pk_fma_f32 v[226:227], v[170:171], v[26:27], v[226:227]
    v_pk_fma_f32 v[228:229], v[172:173], v[26:27], v[228:229]
    v_pk_fma_f32 v[230:231], v[174:175], v[26:27], v[230:231]
    v_pk_fma_f32 v[232:233], v[176:177], v[26:27], v[232:233]
    v_pk_fma_f32 v[234:235], v[178:179], v[26:27], v[234:235]
    v_pk_mul_f32 v[208:209], v[208:209], v[28:29]
    v_pk_mul_f32 v[210:211], v[210:211], v[28:29]
    v_pk_mul_f32 v[212:213], v[212:213], v[28:29]
    v_pk_mul_f32 v[214:215], v[214:215], v[28:29]
    v_pk_mul_f32 v[216:217], v[216:217], v[28:29]
    v_pk_mul_f32 v[218:219], v[218:219], v[28:29]
    v_pk_mul_f32 v[220:221], v[220:221], v[28:29]
    v_pk_mul_f32 v[222:223], v[222:223], v[28:29]
    v_pk_mul_f32 v[224:225], v[224:225], v[28:29]
    v_pk_mul_f32 v[226:227], v[226:227], v[28:29]
    v_pk_mul_f32 v[228:229], v[228:229], v[28:29]
    v_pk_mul_f32 v[230:231], v[230:231], v[28:29]
    v_pk_mul_f32 v[232:233], v[232:233], v[28:29]
    v_pk_mul_f32 v[234:235], v[234:235], v[28:29]
    v_pk_mul_f32 v[124:125], v[208:209], v[208:209]
    v_pk_mul_f32 v[126:127], v[210:211], v[210:211]
    v_pk_mul_f32 v[128:129], v[212:213], v[212:213]
    v_pk_mul_f32 v[130:131], v[214:215], v[214:215]
    v_pk_mul_f32 v[132:133], v[216:217], v[216:217]
    v_pk_mul_f32 v[134:135], v[218:219], v[218:219]
    v_pk_mul_f32 v[136:137], v[220:221], v[220:221]
    v_pk_mul_f32 v[138:139], v[222:223], v[222:223]
    v_pk_mul_f32 v[140:141], v[224:225], v[224:225]
    v_pk_mul_f32 v[142:143], v[226:227], v[226:227]
    v_pk_mul_f32 v[144:145], v[228:229], v[228:229]
    v_pk_mul_f32 v[146:147], v[230:231], v[230:231]
    v_pk_mul_f32 v[148:149], v[232:233], v[232:233]
    v_pk_mul_f32 v[150:151], v[234:235], v[234:235]
    v_pk_fma_f32 v[124:125], v[124:125], s[36:37], v[6:7]
    v_pk_fma_f32 v[126:127], v[126:127], s[36:37], v[6:7]
    v_pk_fma_f32 v[128:129], v[128:129], s[36:37], v[6:7]
    v_pk_fma_f32 v[130:131], v[130:131], s[36:37], v[6:7]
    v_pk_fma_f32 v[132:133], v[132:133], s[36:37], v[6:7]
    v_pk_fma_f32 v[134:135], v[134:135], s[36:37], v[6:7]
    v_pk_fma_f32 v[136:137], v[136:137], s[36:37], v[6:7]
    v_pk_fma_f32 v[138:139], v[138:139], s[36:37], v[6:7]
    v_pk_fma_f32 v[140:141], v[140:141], s[36:37], v[6:7]
    v_pk_fma_f32 v[142:143], v[142:143], s[36:37], v[6:7]
    v_pk_fma_f32 v[144:145], v[144:145], s[36:37], v[6:7]
    v_pk_fma_f32 v[146:147], v[146:147], s[36:37], v[6:7]
    v_pk_fma_f32 v[148:149], v[148:149], s[36:37], v[6:7]
    v_pk_fma_f32 v[150:151], v[150:151], s[36:37], v[6:7]
    v_pk_mul_f32 v[124:125], v[124:125], v[208:209]
    v_pk_mul_f32 v[126:127], v[126:127], v[210:211]
    v_pk_mul_f32 v[128:129], v[128:129], v[212:213]
    v_pk_mul_f32 v[130:131], v[130:131], v[214:215]
    v_pk_mul_f32 v[132:133], v[132:133], v[216:217]
    v_pk_mul_f32 v[134:135], v[134:135], v[218:219]
    v_pk_mul_f32 v[136:137], v[136:137], v[220:221]
    v_pk_mul_f32 v[138:139], v[138:139], v[222:223]
    v_pk_mul_f32 v[140:141], v[140:141], v[224:225]
    v_pk_mul_f32 v[142:143], v[142:143], v[226:227]
    v_pk_mul_f32 v[144:145], v[144:145], v[228:229]
    v_pk_mul_f32 v[146:147], v[146:147], v[230:231]
    v_pk_mul_f32 v[148:149], v[148:149], v[232:233]
    v_pk_mul_f32 v[150:151], v[150:151], v[234:235]
    v_exp_f32 v124, v124
    v_exp_f32 v125, v125
    v_exp_f32 v126, v126
    v_exp_f32 v127, v127
    v_exp_f32 v128, v128
    v_exp_f32 v129, v129
    v_exp_f32 v130, v130
    v_exp_f32 v131, v131
    v_exp_f32 v132, v132
    v_exp_f32 v133, v133
    v_exp_f32 v134, v134
    v_exp_f32 v135, v135
    v_exp_f32 v136, v136
    v_exp_f32 v137, v137
    v_exp_f32 v138, v138
    v_exp_f32 v139, v139
    v_exp_f32 v140, v140
    v_exp_f32 v141, v141
    v_exp_f32 v142, v142
    v_exp_f32 v143, v143
    v_exp_f32 v144, v144
    v_exp_f32 v145, v145
    v_exp_f32 v146, v146
    v_exp_f32 v147, v147
    v_exp_f32 v148, v148
    v_exp_f32 v149, v149
    v_exp_f32 v150, v150
    v_exp_f32 v151, v151
    v_pk_add_f32 v[124:125], v[124:125], 1.0 op_sel_hi:[1,0]
    v_pk_add_f32 v[126:127], v[126:127], 1.0 op_sel_hi:[1,0]
    v_pk_add_f32 v[128:129], v[128:129], 1.0 op_sel_hi:[1,0]
    v_pk_add_f32 v[130:131], v[130:131], 1.0 op_sel_hi:[1,0]
    v_pk_add_f32 v[132:133], v[132:133], 1.0 op_sel_hi:[1,0]
    v_pk_add_f32 v[134:135], v[134:135], 1.0 op_sel_hi:[1,0]
    v_pk_add_f32 v[136:137], v[136:137], 1.0 op_sel_hi:[1,0]
    v_pk_add_f32 v[138:139], v[138:139], 1.0 op_sel_hi:[1,0]
    v_pk_add_f32 v[140:141], v[140:141], 1.0 op_sel_hi:[1,0]
    v_pk_add_f32 v[142:143], v[142:143], 1.0 op_sel_hi:[1,0]
    v_pk_add_f32 v[144:145], v[144:145], 1.0 op_sel_hi:[1,0]
    v_pk_add_f32 v[146:147], v[146:147], 1.0 op_sel_hi:[1,0]
    v_pk_add_f32 v[148:149], v[148:149], 1.0 op_sel_hi:[1,0]
    v_pk_add_f32 v[150:151], v[150:151], 1.0 op_sel_hi:[1,0]
    v_rcp_f32 v124, v124
    v_rcp_f32 v125, v125
    v_rcp_f32 v126, v126
    v_rcp_f32 v127, v127
    v_rcp_f32 v128, v128
    v_rcp_f32 v129, v129
    v_rcp_f32 v130, v130
    v_rcp_f32 v131, v131
    v_rcp_f32 v132, v132
    v_rcp_f32 v133, v133
    v_rcp_f32 v134, v134
    v_rcp_f32 v135, v135
    v_rcp_f32 v136, v136
    v_rcp_f32 v137, v137
    v_rcp_f32 v138, v138
    v_rcp_f32 v139, v139
    v_rcp_f32 v140, v140
    v_rcp_f32 v141, v141
    v_rcp_f32 v142, v142
    v_rcp_f32 v143, v143
    v_rcp_f32 v144, v144
    v_rcp_f32 v145, v145
    v_rcp_f32 v146, v146
    v_rcp_f32 v147, v147
    v_rcp_f32 v148, v148
    v_rcp_f32 v149, v149
    v_rcp_f32 v150, v150
    v_rcp_f32 v151, v151
    v_pk_mul_f32 v[180:181], v[124:125], v[208:209]
    v_pk_mul_f32 v[182:183], v[126:127], v[210:211]
    v_pk_mul_f32 v[184:185], v[128:129], v[212:213]
    v_pk_mul_f32 v[186:187], v[130:131], v[214:215]
    v_pk_mul_f32 v[188:189], v[132:133], v[216:217]
    v_pk_mul_f32 v[190:191], v[134:135], v[218:219]
    v_pk_mul_f32 v[192:193], v[136:137], v[220:221]
    v_pk_mul_f32 v[194:195], v[138:139], v[222:223]
    v_pk_mul_f32 v[196:197], v[140:141], v[224:225]
    v_pk_mul_f32 v[198:199], v[142:143], v[226:227]
    v_pk_mul_f32 v[200:201], v[144:145], v[228:229]
    v_pk_mul_f32 v[202:203], v[146:147], v[230:231]
    v_pk_mul_f32 v[204:205], v[148:149], v[232:233]
    v_pk_mul_f32 v[206:207], v[150:151], v[234:235]
    v_pk_add_f32 v[236:237], v[180:181], v[182:183]
    v_pk_mul_f32 v[238:239], v[180:181], v[180:181]
    v_pk_fma_f32 v[238:239], v[182:183], v[182:183], v[238:239]
    v_pk_add_f32 v[236:237], v[236:237], v[184:185]
    v_pk_fma_f32 v[238:239], v[184:185], v[184:185], v[238:239]
    v_pk_add_f32 v[236:237], v[236:237], v[186:187]
    v_pk_fma_f32 v[238:239], v[186:187], v[186:187], v[238:239]
    v_pk_add_f32 v[236:237], v[236:237], v[188:189]
    v_pk_fma_f32 v[238:239], v[188:189], v[188:189], v[238:239]
    v_pk_add_f32 v[236:237], v[236:237], v[190:191]
    v_pk_fma_f32 v[238:239], v[190:191], v[190:191], v[238:239]
    v_pk_add_f32 v[236:237], v[236:237], v[192:193]
    v_pk_fma_f32 v[238:239], v[192:193], v[192:193], v[238:239]
    v_pk_add_f32 v[236:237], v[236:237], v[194:195]
    v_pk_fma_f32 v[238:239], v[194:195], v[194:195], v[238:239]
    v_pk_add_f32 v[236:237], v[236:237], v[196:197]
    v_pk_fma_f32 v[238:239], v[196:197], v[196:197], v[238:239]
    v_pk_add_f32 v[236:237], v[236:237], v[198:199]
    v_pk_fma_f32 v[238:239], v[198:199], v[198:199], v[238:239]
    v_pk_add_f32 v[236:237], v[236:237], v[200:201]
    v_pk_fma_f32 v[238:239], v[200:201], v[200:201], v[238:239]
    v_pk_add_f32 v[236:237], v[236:237], v[202:203]
    v_pk_fma_f32 v[238:239], v[202:203], v[202:203], v[238:239]
    v_pk_add_f32 v[236:237], v[236:237], v[204:205]
    v_pk_fma_f32 v[238:239], v[204:205], v[204:205], v[238:239]
    v_pk_add_f32 v[236:237], v[236:237], v[206:207]
    v_pk_fma_f32 v[238:239], v[206:207], v[206:207], v[238:239]
    v_add_f32 v236, v236, v237
    v_add_f32 v237, v238, v239
    v_mov_b32 v2, v236
    v_mov_b32 v4, v237
    s_nop 0
    v_permlane32_swap_b32 v236, v2
    v_permlane32_swap_b32 v237, v4
    v_add_f32 v236, v236, v2
    v_add_f32 v237, v237, v4
    v_mov_b32 v2, v236
    v_mov_b32 v4, v237
    s_nop 0
    v_permlane16_swap_b32 v236, v2
    v_permlane16_swap_b32 v237, v4
    v_add_f32 v236, v236, v2
    v_add_f32 v237, v237, v4
    v_and_b32 v237, 0x7fffffff, v237
    s_mov_b32 exec_hi, 0
    s_mov_b32 exec_lo, 0xffff
    buffer_store_dwordx2 v[236:237], v3, s[20:23], s33 offen sc1
    s_mov_b64 exec, -1
    s_waitcnt vmcnt(1)
    s_barrier
    v_lshl_add_u32 v3, v12, 8, v3
    ds_read_b128 v[96:99], v8 offset:12288
    ds_read_b128 v[100:103], v8 offset:13312
    ds_read_b128 v[104:107], v8 offset:14336
    ds_read_b128 v[108:111], v8 offset:15360
    ds_read_b128 v[112:115], v8 offset:16384
    ds_read_b128 v[116:119], v8 offset:17408
    s_add_u32 m0, s42, 69632
    s_add_u32 s30, s90, 0
    buffer_load_dwordx4 v8, s[20:23], s30 offen offset:0 sc1 lds
    s_waitcnt lgkmcnt(4)
    v_mfma_f32_16x16x32_bf16 v[208:211], v[96:99], v[32:35], 0
    ds_read_b128 v[120:123], v8 offset:18432
    v_mfma_f32_16x16x32_bf16 v[212:215], v[100:103], v[32:35], 0
    ds_read_b128 v[96:99], v8 offset:19456
    buffer_load_dwordx4 v8, s[20:23], s30 offen offset:1024 sc1 lds
    s_waitcnt lgkmcnt(4)
    v_mfma_f32_16x16x32_bf16 v[216:219], v[104:107], v[32:35], 0
    ds_read_b128 v[100:103], v8 offset:20480
    v_mfma_f32_16x16x32_bf16 v[220:223], v[108:111], v[32:35], 0
    ds_read_b128 v[104:107], v8 offset:21504
    buffer_load_dwordx4 v8, s[20:23], s30 offen offset:2048 sc1 lds
    s_waitcnt lgkmcnt(4)
    v_mfma_f32_16x16x32_bf16 v[224:227], v[112:115], v[32:35], 0
    ds_read_b128 v[108:111], v8 offset:22528
    v_mfma_f32_16x16x32_bf16 v[228:231], v[116:119], v[32:35], 0
    ds_read_b128 v[112:115], v8 offset:23552
    buffer_load_dwordx4 v8, s[20:23], s30 offen offset:3072 sc1 lds
    s_waitcnt lgkmcnt(4)
    v_mfma_f32_16x16x32_bf16 v[232:235], v[120:123], v[32:35], 0
    ds_read_b128 v[116:119], v8 offset:24576
    v_mfma_f32_16x16x32_bf16 v[208:211], v[96:99], v[36:39], v[208:211]
    ds_read_b128 v[120:123], v8 offset:25600
    s_add_u32 m0, s42, 73728
    s_add_u32 s30, s90, 4096
    buffer_load_dwordx4 v8, s[20:23], s30 offen offset:0 sc1 lds
    s_waitcnt lgkmcnt(4)
    v_mfma_f32_16x16x32_bf16 v[212:215], v[100:103], v[36:39], v[212:215]
    ds_read_b128 v[96:99], v8 offset:26624
    v_mfma_f32_16x16x32_bf16 v[216:219], v[104:107], v[36:39], v[216:219]
    ds_read_b128 v[100:103], v8 offset:27648
    buffer_load_dwordx4 v8, s[20:23], s30 offen offset:1024 sc1 lds
    s_waitcnt lgkmcnt(4)
    v_mfma_f32_16x16x32_bf16 v[220:223], v[108:111], v[36:39], v[220:223]
    ds_read_b128 v[104:107], v8 offset:28672
    v_mfma_f32_16x16x32_bf16 v[224:227], v[112:115], v[36:39], v[224:227]
    ds_read_b128 v[108:111], v8 offset:29696
    buffer_load_dwordx4 v8, s[20:23], s30 offen offset:2048 sc1 lds
    s_waitcnt lgkmcnt(4)
    v_mfma_f32_16x16x32_bf16 v[228:231], v[116:119], v[36:39], v[228:231]
    ds_read_b128 v[112:115], v8 offset:30720
    v_mfma_f32_16x16x32_bf16 v[232:235], v[120:123], v[36:39], v[232:235]
    ds_read_b128 v[116:119], v8 offset:31744
    s_add_u32 m0, s42, 98304
    s_add_u32 s30, s91, 0
    buffer_load_dwordx4 v8, s[20:23], s30 offen offset:0 sc1 lds
    s_waitcnt lgkmcnt(4)
    v_mfma_f32_16x16x32_bf16 v[208:211], v[96:99], v[40:43], v[208:211]
    ds_read_b128 v[120:123], v8 offset:32768
    v_mfma_f32_16x16x32_bf16 v[212:215], v[100:103], v[40:43], v[212:215]
    ds_read_b128 v[96:99], v8 offset:33792
    buffer_load_dwordx4 v8, s[20:23], s30 offen offset:1024 sc1 lds
    s_waitcnt lgkmcnt(4)
    v_mfma_f32_16x16x32_bf16 v[216:219], v[104:107], v[40:43], v[216:219]
    ds_read_b128 v[100:103], v8 offset:34816
    v_mfma_f32_16x16x32_bf16 v[220:223], v[108:111], v[40:43], v[220:223]
    ds_read_b128 v[104:107], v8 offset:35840
    buffer_load_dwordx4 v8, s[20:23], s30 offen offset:2048 sc1 lds
    s_waitcnt lgkmcnt(4)
    v_mfma_f32_16x16x32_bf16 v[224:227], v[112:115], v[40:43], v[224:227]
    ds_read_b128 v[108:111], v8 offset:36864
    v_mfma_f32_16x16x32_bf16 v[228:231], v[116:119], v[40:43], v[228:231]
    ds_read_b128 v[112:115], v8 offset:37888
    buffer_load_dwordx4 v8, s[20:23], s30 offen offset:3072 sc1 lds
    s_waitcnt lgkmcnt(4)
    v_mfma_f32_16x16x32_bf16 v[232:235], v[120:123], v[40:43], v[232:235]
    ds_read_b128 v[116:119], v8 offset:38912
    v_mfma_f32_16x16x32_bf16 v[208:211], v[96:99], v[44:47], v[208:211]
    ds_read_b128 v[120:123], v8 offset:39936
    s_add_u32 m0, s42, 102400
    s_add_u32 s30, s91, 4096
    buffer_load_dwordx4 v8, s[20:23], s30 offen offset:0 sc1 lds
    s_waitcnt lgkmcnt(4)
    v_mfma_f32_16x16x32_bf16 v[212:215], v[100:103], v[44:47], v[212:215]
    ds_read_b128 v[96:99], v8 offset:40960
    v_mfma_f32_16x16x32_bf16 v[216:219], v[104:107], v[44:47], v[216:219]
    ds_read_b128 v[100:103], v8 offset:41984
    buffer_load_dwordx4 v8, s[20:23], s30 offen offset:1024 sc1 lds
    s_waitcnt lgkmcnt(4)
    v_mfma_f32_16x16x32_bf16 v[220:223], v[108:111], v[44:47], v[220:223]
    ds_read_b128 v[104:107], v8 offset:43008
    v_mfma_f32_16x16x32_bf16 v[224:227], v[112:115], v[44:47], v[224:227]
    ds_read_b128 v[108:111], v8 offset:44032
    buffer_load_dwordx4 v8, s[20:23], s30 offen offset:2048 sc1 lds
    s_waitcnt lgkmcnt(4)
    v_mfma_f32_16x16x32_bf16 v[228:231], v[116:119], v[44:47], v[228:231]
    ds_read_b128 v[112:115], v8 offset:45056
    v_mfma_f32_16x16x32_bf16 v[232:235], v[120:123], v[44:47], v[232:235]
    ds_read_b128 v[116:119], v8 offset:46080
    s_waitcnt lgkmcnt(4)
    v_mfma_f32_16x16x32_bf16 v[208:211], v[96:99], v[48:51], v[208:211]
    ds_read_b128 v[120:123], v8 offset:47104
    v_mfma_f32_16x16x32_bf16 v[212:215], v[100:103], v[48:51], v[212:215]
    ds_read_b128 v[96:99], v8 offset:48128
    buffer_load_dwordx2 v[236:237], v3, s[20:23], s32 offen offset:0 sc1
    buffer_load_dwordx2 v[238:239], v3, s[20:23], s32 offen offset:128 sc1
    s_waitcnt lgkmcnt(4)
    v_mfma_f32_16x16x32_bf16 v[216:219], v[104:107], v[48:51], v[216:219]
    ds_read_b128 v[100:103], v8 offset:49152
    v_mfma_f32_16x16x32_bf16 v[220:223], v[108:111], v[48:51], v[220:223]
    ds_read_b128 v[104:107], v8 offset:50176
    s_waitcnt lgkmcnt(4)
    v_mfma_f32_16x16x32_bf16 v[224:227], v[112:115], v[48:51], v[224:227]
    ds_read_b128 v[108:111], v8 offset:51200
    v_mfma_f32_16x16x32_bf16 v[228:231], v[116:119], v[48:51], v[228:231]
    ds_read_b128 v[112:115], v8 offset:52224
    s_waitcnt lgkmcnt(4)
    v_mfma_f32_16x16x32_bf16 v[232:235], v[120:123], v[48:51], v[232:235]
    ds_read_b128 v[116:119], v8 offset:53248
    v_mfma_f32_16x16x32_bf16 v[208:211], v[96:99], v[52:55], v[208:211]
    ds_read_b128 v[120:123], v8 offset:54272
    s_waitcnt lgkmcnt(4)
    v_mfma_f32_16x16x32_bf16 v[212:215], v[100:103], v[52:55], v[212:215]
    ds_read_b128 v[96:99], v8 offset:55296
    v_mfma_f32_16x16x32_bf16 v[216:219], v[104:107], v[52:55], v[216:219]
    ds_read_b128 v[100:103], v8 offset:56320
    s_waitcnt lgkmcnt(4)
    v_mfma_f32_16x16x32_bf16 v[220:223], v[108:111], v[52:55], v[220:223]
    ds_read_b128 v[104:107], v8 offset:57344
    v_mfma_f32_16x16x32_bf16 v[224:227], v[112:115], v[52:55], v[224:227]
    ds_read_b128 v[108:111], v8 offset:58368
    s_waitcnt lgkmcnt(4)
    v_mfma_f32_16x16x32_bf16 v[228:231], v[116:119], v[52:55], v[228:231]
    ds_read_b128 v[112:115], v8 offset:59392
    v_mfma_f32_16x16x32_bf16 v[232:235], v[120:123], v[52:55], v[232:235]
    ds_read_b128 v[116:119], v8 offset:60416
    s_waitcnt lgkmcnt(4)
    v_mfma_f32_16x16x32_bf16 v[208:211], v[96:99], v[56:59], v[208:211]
    ds_read_b128 v[120:123], v8 offset:61440
    v_mfma_f32_16x16x32_bf16 v[212:215], v[100:103], v[56:59], v[212:215]
    ds_read_b128 v[96:99], v25 offset:0
    s_waitcnt lgkmcnt(4)
    v_mfma_f32_16x16x32_bf16 v[216:219], v[104:107], v[56:59], v[216:219]
    ds_read_b128 v[100:103], v25 offset:1024
    v_mfma_f32_16x16x32_bf16 v[220:223], v[108:111], v[56:59], v[220:223]
    ds_read_b128 v[104:107], v25 offset:2048
    s_waitcnt lgkmcnt(4)
    v_mfma_f32_16x16x32_bf16 v[224:227], v[112:115], v[56:59], v[224:227]
    ds_read_b128 v[108:111], v25 offset:3072
    v_mfma_f32_16x16x32_bf16 v[228:231], v[116:119], v[56:59], v[228:231]
    ds_read_b128 v[112:115], v25 offset:4096
    s_waitcnt lgkmcnt(4)
    v_mfma_f32_16x16x32_bf16 v[232:235], v[120:123], v[56:59], v[232:235]
    ds_read_b128 v[116:119], v25 offset:5120
    v_mfma_f32_16x16x32_bf16 v[208:211], v[96:99], v[60:63], v[208:211]
    ds_read_b128 v[120:123], v25 offset:6144
    s_waitcnt lgkmcnt(4)
    v_mfma_f32_16x16x32_bf16 v[212:215], v[100:103], v[60:63], v[212:215]
    v_mfma_f32_16x16x32_bf16 v[216:219], v[104:107], v[60:63], v[216:219]
    s_waitcnt lgkmcnt(2)
    v_mfma_f32_16x16x32_bf16 v[220:223], v[108:111], v[60:63], v[220:223]
    v_mfma_f32_16x16x32_bf16 v[224:227], v[112:115], v[60:63], v[224:227]
    s_waitcnt lgkmcnt(0)
    v_mfma_f32_16x16x32_bf16 v[228:231], v[116:119], v[60:63], v[228:231]
    v_mfma_f32_16x16x32_bf16 v[232:235], v[120:123], v[60:63], v[232:235]
    s_waitcnt vmcnt(0)
    v_max_u32 v2, v237, v239
    v_cmp_eq_u32 vcc, -1, v2
    s_cbranch_vccz k2_main_kernel_doneB
    s_mov_b32 s40, 100000
    buffer_load_dwordx2 v[140:141], v3, s[20:23], s32 offen offset:0 sc1
    buffer_load_dwordx2 v[142:143], v3, s[20:23], s32 offen offset:128 sc1
k2_main_kernel_pollB:
    s_waitcnt vmcnt(0)
    v_max_u32 v2, v141, v143
    v_cmp_eq_u32 vcc, -1, v2
    s_cbranch_vccz k2_main_kernel_okB0
    buffer_load_dwordx2 v[140:141], v3, s[20:23], s32 offen offset:0 sc1
    buffer_load_dwordx2 v[142:143], v3, s[20:23], s32 offen offset:128 sc1
    s_sub_u32 s40, s40, 1
    s_cbranch_scc0 k2_main_kernel_pollB
k2_main_kernel_okB0:
    v_mov_b32 v236, v140
    v_mov_b32 v237, v141
    v_mov_b32 v238, v142
    v_mov_b32 v239, v143
k2_main_kernel_doneB:
    v_pk_add_f32 v[236:237], v[236:237], v[238:239]
    v_mov_b32 v2, v236
    v_mov_b32 v4, v237
    s_nop 0
    v_permlane32_swap_b32 v236, v2
    v_permlane32_swap_b32 v237, v4
    v_add_f32 v236, v236, v2
    v_add_f32 v237, v237, v4
    v_mov_b32 v2, v236
    v_mov_b32 v4, v237
    s_nop 0
    v_permlane16_swap_b32 v236, v2
    v_permlane16_swap_b32 v237, v4
    v_add_f32 v236, v236, v2
    v_add_f32 v237, v237, v4
    v_mul_f32 v240, 0xba924925, v236
    v_mul_f32 v237, 0x3a924925, v237
    v_fma_f32 v237, -v240, v240, v237
    v_max_f32 v237, 0, v237
    v_add_f32 v237, 0x3727c5ac, v237
    v_rsq_f32 v242, v237
    s_nop 0
    v_mul_f32 v240, v240, v242
    v_pk_fma_f32 v[180:181], v[180:181], v[242:243], v[240:241] op_sel_hi:[1,0,0]
    v_pk_fma_f32 v[182:183], v[182:183], v[242:243], v[240:241] op_sel_hi:[1,0,0]
    v_cvt_pk_bf16_f32 v124, v180, v181
    v_cvt_pk_bf16_f32 v125, v182, v183
    ds_write_b64 v19, v[124:125] offset:0
    v_pk_fma_f32 v[184:185], v[184:185], v[242:243], v[240:241] op_sel_hi:[1,0,0]
    v_pk_fma_f32 v[186:187], v[186:187], v[242:243], v[240:241] op_sel_hi:[1,0,0]
    v_cvt_pk_bf16_f32 v126, v184, v185
    v_cvt_pk_bf16_f32 v127, v186, v187
    ds_write_b64 v19, v[126:127] offset:32
    ds_read_b64_tr_b16 v[152:153], v20 offset:0
    ds_read_b64_tr_b16 v[154:155], v20 offset:1056
    v_pk_fma_f32 v[188:189], v[188:189], v[242:243], v[240:241] op_sel_hi:[1,0,0]
    v_pk_fma_f32 v[190:191], v[190:191], v[242:243], v[240:241] op_sel_hi:[1,0,0]
    v_cvt_pk_bf16_f32 v128, v188, v189
    v_cvt_pk_bf16_f32 v129, v190, v191
    ds_write_b64 v19, v[128:129] offset:64
    v_pk_fma_f32 v[192:193], v[192:193], v[242:243], v[240:241] op_sel_hi:[1,0,0]
    v_pk_fma_f32 v[194:195], v[194:195], v[242:243], v[240:241] op_sel_hi:[1,0,0]
    v_cvt_pk_bf16_f32 v130, v192, v193
    v_cvt_pk_bf16_f32 v131, v194, v195
    ds_write_b64 v19, v[130:131] offset:96
    ds_read_b64_tr_b16 v[156:157], v20 offset:64
    ds_read_b64_tr_b16 v[158:159], v20 offset:1120
    v_pk_fma_f32 v[196:197], v[196:197], v[242:243], v[240:241] op_sel_hi:[1,0,0]
    v_pk_fma_f32 v[198:199], v[198:199], v[242:243], v[240:241] op_sel_hi:[1,0,0]
    v_cvt_pk_bf16_f32 v132, v196, v197
    v_cvt_pk_bf16_f32 v133, v198, v199
    ds_write_b64 v19, v[132:133] offset:128
    v_pk_fma_f32 v[200:201], v[200:201], v[242:243], v[240:241] op_sel_hi:[1,0,0]
    v_pk_fma_f32 v[202:203], v[202:203], v[242:243], v[240:241] op_sel_hi:[1,0,0]
    v_cvt_pk_bf16_f32 v134, v200, v201
    v_cvt_pk_bf16_f32 v135, v202, v203
    ds_write_b64 v19, v[134:135] offset:160
    ds_read_b64_tr_b16 v[160:161], v20 offset:128
    ds_read_b64_tr_b16 v[162:163], v20 offset:1184
    v_pk_fma_f32 v[204:205], v[204:205], v[242:243], v[240:241] op_sel_hi:[1,0,0]
    v_pk_fma_f32 v[206:207], v[206:207], v[242:243], v[240:241] op_sel_hi:[1,0,0]
    v_cvt_pk_bf16_f32 v136, v204, v205
    v_cvt_pk_bf16_f32 v137, v206, v207
    ds_write_b64 v19, v[136:137] offset:192
    ds_read_b64_tr_b16 v[164:165], v20 offset:192
    ds_read_b64_tr_b16 v[166:167], v20 offset:1248
    s_waitcnt lgkmcnt(11)
    buffer_store_dwordx4 v[152:155], v21, s[20:23], s38 offen offset:0 sc1
    s_waitcnt lgkmcnt(7)
    buffer_store_dwordx4 v[156:159], v21, s[20:23], s38 offen offset:2048 sc1
    s_waitcnt lgkmcnt(3)
    buffer_store_dwordx4 v[160:163], v21, s[20:23], s39 offen offset:0 sc1
    s_waitcnt lgkmcnt(0)
    s_mov_b32 exec_hi, 0
    buffer_store_dwordx4 v[164:167], v21, s[20:23], s39 offen offset:2048 sc1
    s_mov_b64 exec, -1
    s_lshl_b32 s34, s11, 9
    s_lshl_b32 s28, s43, 2
    s_add_u32 s34, s34, s28
    s_lshl_b32 s34, s34, 5
    s_add_u32 s34, s34, 0x1700000
    v_lshrrev_b32 v2, 3, v1
    v_lshlrev_b32 v2, 10, v2
    v_and_b32 v3, 1, v12
    v_lshlrev_b32 v3, 2, v3
    v_xor_b32 v3, v3, v1
    v_and_b32 v3, 7, v3
    v_lshl_add_u32 v2, v3, 4, v2
    s_mul_i32 s28, s15, 458752
    s_lshl_b32 s88, s16, 9
    s_xor_b32 s88, s88, s31
    s_mul_i32 s88, s88, 448
    s_lshl_b32 s89, s16, 9
    s_xor_b32 s89, s89, s31
    s_xor_b32 s89, s89, 256
    s_mul_i32 s89, s89, 448
    s_lshl_b32 s29, s55, 7
    s_add_u32 s28, s28, s29
    v_add_u32 v22, s28, v2
    s_lshl_b32 s41, s14, 14
    s_mul_i32 s90, s14, 12288
    s_mov_b32 s56, s50
    s_mov_b32 s57, s51
    s_mov_b32 s58, 0xe0000
    s_mov_b32 s59, 0x00020000
    s_mov_b32 s24, s48
    s_mov_b32 s25, s49
    s_mov_b32 s26, 0x1000
    s_mov_b32 s27, 0x00020000
    s_lshl_b32 s17, s43, 5
    v_lshlrev_b32 v2, 1, v11
    buffer_load_ushort v18, v2, s[24:27], s17 offen
    ds_read_b128 v[96:99], v30 offset:12288
    ds_read_b128 v[100:103], v30 offset:13312
    ds_read_b128 v[104:107], v30 offset:14336
    ds_read_b128 v[108:111], v30 offset:15360
    ds_read_b128 v[112:115], v30 offset:16384
    ds_read_b128 v[116:119], v30 offset:17408
    s_waitcnt lgkmcnt(4)
    v_mfma_f32_16x16x32_bf16 v[152:155], v[96:99], v[244:247], 0
    ds_read_b128 v[120:123], v30 offset:18432
    v_mfma_f32_16x16x32_bf16 v[156:159], v[100:103], v[244:247], 0
    ds_read_b128 v[96:99], v30 offset:40960
    s_waitcnt lgkmcnt(4)
    v_mfma_f32_16x16x32_bf16 v[160:163], v[104:107], v[244:247], 0
    ds_read_b128 v[100:103], v30 offset:41984
    v_mfma_f32_16x16x32_bf16 v[164:167], v[108:111], v[244:247], 0
    ds_read_b128 v[104:107], v30 offset:43008
    s_waitcnt lgkmcnt(4)
    v_mfma_f32_16x16x32_bf16 v[168:171], v[112:115], v[244:247], 0
    ds_read_b128 v[108:111], v30 offset:44032
    v_mfma_f32_16x16x32_bf16 v[172:175], v[116:119], v[244:247], 0
    ds_read_b128 v[112:115], v30 offset:45056
    s_waitcnt lgkmcnt(4)
    v_mfma_f32_16x16x32_bf16 v[176:179], v[120:123], v[244:247], 0
    ds_read_b128 v[116:119], v30 offset:46080
    v_mfma_f32_16x16x32_bf16 v[152:155], v[96:99], v[244:247], v[152:155]
    ds_read_b128 v[120:123], v30 offset:47104
    s_waitcnt lgkmcnt(4)
    v_mfma_f32_16x16x32_bf16 v[156:159], v[100:103], v[244:247], v[156:159]
    ds_read_b128 v[96:99], v31 offset:12288
    v_mfma_f32_16x16x32_bf16 v[160:163], v[104:107], v[244:247], v[160:163]
    ds_read_b128 v[100:103], v31 offset:13312
    s_waitcnt lgkmcnt(4)
    v_mfma_f32_16x16x32_bf16 v[164:167], v[108:111], v[244:247], v[164:167]
    ds_read_b128 v[104:107], v31 offset:14336
    v_mfma_f32_16x16x32_bf16 v[168:171], v[112:115], v[244:247], v[168:171]
    ds_read_b128 v[108:111], v31 offset:15360
    s_waitcnt lgkmcnt(4)
    v_mfma_f32_16x16x32_bf16 v[172:175], v[116:119], v[244:247], v[172:175]
    ds_read_b128 v[112:115], v31 offset:16384
    v_mfma_f32_16x16x32_bf16 v[176:179], v[120:123], v[244:247], v[176:179]
    ds_read_b128 v[116:119], v31 offset:17408
    s_waitcnt lgkmcnt(4)
    v_mfma_f32_16x16x32_bf16 v[152:155], v[96:99], v[244:247], v[152:155]
    ds_read_b128 v[120:123], v31 offset:18432
    v_mfma_f32_16x16x32_bf16 v[156:159], v[100:103], v[244:247], v[156:159]
    ds_read_b128 v[96:99], v31 offset:40960
    s_waitcnt lgkmcnt(4)
    v_mfma_f32_16x16x32_bf16 v[160:163], v[104:107], v[244:247], v[160:163]
    ds_read_b128 v[100:103], v31 offset:41984
    v_mfma_f32_16x16x32_bf16 v[164:167], v[108:111], v[244:247], v[164:167]
    ds_read_b128 v[104:107], v31 offset:43008
    s_waitcnt lgkmcnt(4)
    v_mfma_f32_16x16x32_bf16 v[168:171], v[112:115], v[244:247], v[168:171]
    ds_read_b128 v[108:111], v31 offset:44032
    v_mfma_f32_16x16x32_bf16 v[172:175], v[116:119], v[244:247], v[172:175]
    ds_read_b128 v[112:115], v31 offset:45056
    s_waitcnt lgkmcnt(4)
    v_mfma_f32_16x16x32_bf16 v[176:179], v[120:123], v[244:247], v[176:179]
    ds_read_b128 v[116:119], v31 offset:46080
    v_mfma_f32_16x16x32_bf16 v[152:155], v[96:99], v[244:247], v[152:155]
    ds_read_b128 v[120:123], v31 offset:47104
    s_waitcnt lgkmcnt(4)
    v_mfma_f32_16x16x32_bf16 v[156:159], v[100:103], v[244:247], v[156:159]
    v_mfma_f32_16x16x32_bf16 v[160:163], v[104:107], v[244:247], v[160:163]
    s_waitcnt lgkmcnt(2)
    v_mfma_f32_16x16x32_bf16 v[164:167], v[108:111], v[244:247], v[164:167]
    v_mfma_f32_16x16x32_bf16 v[168:171], v[112:115], v[244:247], v[168:171]
    s_waitcnt lgkmcnt(0)
    v_mfma_f32_16x16x32_bf16 v[172:175], v[116:119], v[244:247], v[172:175]
    v_mfma_f32_16x16x32_bf16 v[176:179], v[120:123], v[244:247], v[176:179]
    s_mul_i32 s28, s14, 448
    s_add_u32 s28, s28, 140288
    v_lshl_add_u32 v4, v12, 4, s28
    s_mov_b32 exec_lo, 0x00010001
    s_mov_b32 exec_hi, 0x00010001
    ds_write_b128 v4, v[152:155] offset:0
    ds_write_b128 v4, v[156:159] offset:64
    ds_write_b128 v4, v[160:163] offset:128
    ds_write_b128 v4, v[164:167] offset:192
    ds_write_b128 v4, v[168:171] offset:256
    ds_write_b128 v4, v[172:175] offset:320
    ds_write_b128 v4, v[176:179] offset:384
    s_mov_b64 exec, -1
    s_waitcnt lgkmcnt(0)
    s_barrier
    ds_read_b128 v[124:127], v17 offset:0
    ds_read_b128 v[128:131], v17 offset:448
    ds_read_b128 v[132:135], v17 offset:896
    ds_read_b128 v[136:139], v17 offset:1344
    s_lshl_b32 s17, s11, 9
    s_lshl_b32 s28, s14, 7
    s_add_u32 s17, s17, s28
    s_lshl_b32 s17, s17, 5
    s_add_u32 s17, s17, 0x1700000
    v_lshlrev_b32 v5, 7, v10
    ds_read_b128 v[96:99], v25 offset:7168
    ds_read_b128 v[100:103], v25 offset:8192
    ds_read_b128 v[104:107], v25 offset:9216
    ds_read_b128 v[108:111], v25 offset:10240
    ds_read_b128 v[112:115], v25 offset:11264
    ds_read_b128 v[116:119], v25 offset:12288
    s_waitcnt lgkmcnt(4)
    v_mfma_f32_16x16x32_bf16 v[208:211], v[96:99], v[64:67], v[208:211]
    ds_read_b128 v[120:123], v25 offset:13312
    v_mfma_f32_16x16x32_bf16 v[212:215], v[100:103], v[64:67], v[212:215]
    ds_read_b128 v[96:99], v25 offset:14336
    s_waitcnt lgkmcnt(4)
    v_mfma_f32_16x16x32_bf16 v[216:219], v[104:107], v[64:67], v[216:219]
    ds_read_b128 v[100:103], v25 offset:15360
    v_mfma_f32_16x16x32_bf16 v[220:223], v[108:111], v[64:67], v[220:223]
    ds_read_b128 v[104:107], v25 offset:16384
    s_waitcnt lgkmcnt(4)
    v_mfma_f32_16x16x32_bf16 v[224:227], v[112:115], v[64:67], v[224:227]
    ds_read_b128 v[108:111], v25 offset:17408
    v_mfma_f32_16x16x32_bf16 v[228:231], v[116:119], v[64:67], v[228:231]
    ds_read_b128 v[112:115], v25 offset:18432
    v_mov_b32 v2, 0
    v_mov_b32 v3, s87
    s_mov_b64 exec, 1
    s_waitcnt vmcnt(1)
    buffer_store_dword v3, v2, s[20:23], s34 offen sc1
    s_mov_b64 exec, -1
    s_waitcnt lgkmcnt(4)
    v_mfma_f32_16x16x32_bf16 v[232:235], v[120:123], v[64:67], v[232:235]
    ds_read_b128 v[116:119], v25 offset:19456
    v_mfma_f32_16x16x32_bf16 v[208:211], v[96:99], v[68:71], v[208:211]
    ds_read_b128 v[120:123], v25 offset:20480
    s_add_u32 m0, s41, 0
    s_add_u32 s30, s88, 0
    buffer_load_dwordx4 v22, s[56:59], s30 offen lds
    s_waitcnt lgkmcnt(4)
    v_mfma_f32_16x16x32_bf16 v[212:215], v[100:103], v[68:71], v[212:215]
    ds_read_b128 v[96:99], v25 offset:21504
    v_mfma_f32_16x16x32_bf16 v[216:219], v[104:107], v[68:71], v[216:219]
    ds_read_b128 v[100:103], v25 offset:22528
    s_add_u32 m0, s41, 1024
    s_add_u32 s30, s88, 8192
    buffer_load_dwordx4 v22, s[56:59], s30 offen lds
    s_waitcnt lgkmcnt(4)
    v_mfma_f32_16x16x32_bf16 v[220:223], v[108:111], v[68:71], v[220:223]
    ds_read_b128 v[104:107], v25 offset:23552
    v_mfma_f32_16x16x32_bf16 v[224:227], v[112:115], v[68:71], v[224:227]
    ds_read_b128 v[108:111], v25 offset:24576
    s_add_u32 m0, s41, 2048
    s_add_u32 s30, s88, 16384
    buffer_load_dwordx4 v22, s[56:59], s30 offen lds
    s_waitcnt lgkmcnt(4)
    v_mfma_f32_16x16x32_bf16 v[228:231], v[116:119], v[68:71], v[228:231]
    ds_read_b128 v[112:115], v25 offset:25600
    v_mfma_f32_16x16x32_bf16 v[232:235], v[120:123], v[68:71], v[232:235]
    ds_read_b128 v[116:119], v25 offset:26624
    s_add_u32 m0, s41, 3072
    s_add_u32 s30, s88, 24576
    buffer_load_dwordx4 v22, s[56:59], s30 offen lds
    s_waitcnt lgkmcnt(4)
    v_mfma_f32_16x16x32_bf16 v[208:211], v[96:99], v[72:75], v[208:211]
    ds_read_b128 v[120:123], v25 offset:27648
    v_mfma_f32_16x16x32_bf16 v[212:215], v[100:103], v[72:75], v[212:215]
    s_add_u32 m0, s41, 4096
    s_add_u32 s30, s88, 32768
    buffer_load_dwordx4 v22, s[56:59], s30 offen lds
    s_waitcnt lgkmcnt(3)
    v_mfma_f32_16x16x32_bf16 v[216:219], v[104:107], v[72:75], v[216:219]
    v_mfma_f32_16x16x32_bf16 v[220:223], v[108:111], v[72:75], v[220:223]
    s_add_u32 m0, s41, 5120
    s_add_u32 s30, s88, 40960
    buffer_load_dwordx4 v22, s[56:59], s30 offen lds
    s_waitcnt lgkmcnt(1)
    v_mfma_f32_16x16x32_bf16 v[224:227], v[112:115], v[72:75], v[224:227]
    v_mfma_f32_16x16x32_bf16 v[228:231], v[116:119], v[72:75], v[228:231]
    s_add_u32 m0, s41, 6144
    s_add_u32 s30, s88, 49152
    buffer_load_dwordx4 v22, s[56:59], s30 offen lds
    s_waitcnt lgkmcnt(0)
    v_mfma_f32_16x16x32_bf16 v[232:235], v[120:123], v[72:75], v[232:235]
    v_add_f32 v124, v124, v128
    v_add_f32 v125, v125, v129
    v_add_f32 v126, v126, v130
    v_add_f32 v127, v127, v131
    v_add_f32 v132, v132, v136
    v_add_f32 v133, v133, v137
    v_add_f32 v134, v134, v138
    v_add_f32 v135, v135, v139
    v_add_f32 v124, v124, v132
    v_add_f32 v125, v125, v133
    v_add_f32 v126, v126, v134
    v_add_f32 v127, v127, v135
    ds_write_b128 v23, v[124:127]
    ds_read_b128 v[152:155], v24 offset:0
    ds_read_b128 v[156:159], v24 offset:64
    ds_read_b128 v[160:163], v24 offset:128
    ds_read_b128 v[164:167], v24 offset:192
    ds_read_b128 v[168:171], v24 offset:256
    ds_read_b128 v[172:175], v24 offset:320
    ds_read_b128 v[176:179], v24 offset:384
    ds_read_b128 v[96:99], v25 offset:28672
    ds_read_b128 v[100:103], v25 offset:29696
    ds_read_b128 v[104:107], v25 offset:30720
    ds_read_b128 v[108:111], v25 offset:31744
    ds_read_b128 v[112:115], v25 offset:32768
    ds_read_b128 v[116:119], v25 offset:33792
    s_waitcnt lgkmcnt(4)
    v_mfma_f32_16x16x32_bf16 v[208:211], v[96:99], v[76:79], v[208:211]
    ds_read_b128 v[120:123], v25 offset:34816
    s_add_u32 m0, s41, 7168
    s_add_u32 s30, s88, 57344
    buffer_load_dwordx4 v22, s[56:59], s30 offen lds
    v_mfma_f32_16x16x32_bf16 v[212:215], v[100:103], v[76:79], v[212:215]
    ds_read_b128 v[96:99], v25 offset:35840
    s_waitcnt lgkmcnt(4)
    v_mfma_f32_16x16x32_bf16 v[216:219], v[104:107], v[76:79], v[216:219]
    ds_read_b128 v[100:103], v25 offset:36864
    s_add_u32 m0, s41, 8192
    s_add_u32 s30, s89, 0
    buffer_load_dwordx4 v22, s[56:59], s30 offen lds
    v_mfma_f32_16x16x32_bf16 v[220:223], v[108:111], v[76:79], v[220:223]
    ds_read_b128 v[104:107], v25 offset:37888
    s_waitcnt lgkmcnt(4)
    v_mfma_f32_16x16x32_bf16 v[224:227], v[112:115], v[76:79], v[224:227]
    ds_read_b128 v[108:111], v25 offset:38912
    s_add_u32 m0, s41, 9216
    s_add_u32 s30, s89, 8192
    buffer_load_dwordx4 v22, s[56:59], s30 offen lds
    v_mfma_f32_16x16x32_bf16 v[228:231], v[116:119], v[76:79], v[228:231]
    ds_read_b128 v[112:115], v25 offset:39936
    s_waitcnt lgkmcnt(4)
    v_mfma_f32_16x16x32_bf16 v[232:235], v[120:123], v[76:79], v[232:235]
    ds_read_b128 v[116:119], v25 offset:40960
    s_add_u32 m0, s41, 10240
    s_add_u32 s30, s89, 16384
    buffer_load_dwordx4 v22, s[56:59], s30 offen lds
    v_mfma_f32_16x16x32_bf16 v[208:211], v[96:99], v[80:83], v[208:211]
    ds_read_b128 v[120:123], v25 offset:41984
    s_waitcnt lgkmcnt(4)
    v_mfma_f32_16x16x32_bf16 v[212:215], v[100:103], v[80:83], v[212:215]
    ds_read_b128 v[96:99], v25 offset:43008
    s_add_u32 m0, s41, 11264
    s_add_u32 s30, s89, 24576
    buffer_load_dwordx4 v22, s[56:59], s30 offen lds
    v_mfma_f32_16x16x32_bf16 v[216:219], v[104:107], v[80:83], v[216:219]
    ds_read_b128 v[100:103], v25 offset:44032
    s_waitcnt lgkmcnt(4)
    v_mfma_f32_16x16x32_bf16 v[220:223], v[108:111], v[80:83], v[220:223]
    ds_read_b128 v[104:107], v25 offset:45056
    s_add_u32 m0, s41, 12288
    s_add_u32 s30, s89, 32768
    buffer_load_dwordx4 v22, s[56:59], s30 offen lds
    v_mfma_f32_16x16x32_bf16 v[224:227], v[112:115], v[80:83], v[224:227]
    ds_read_b128 v[108:111], v25 offset:46080
    s_waitcnt lgkmcnt(4)
    v_mfma_f32_16x16x32_bf16 v[228:231], v[116:119], v[80:83], v[228:231]
    ds_read_b128 v[112:115], v25 offset:47104
    s_add_u32 m0, s41, 13312
    s_add_u32 s30, s89, 40960
    buffer_load_dwordx4 v22, s[56:59], s30 offen lds
    v_mfma_f32_16x16x32_bf16 v[232:235], v[120:123], v[80:83], v[232:235]
    ds_read_b128 v[116:119], v25 offset:48128
    s_waitcnt lgkmcnt(4)
    v_mfma_f32_16x16x32_bf16 v[208:211], v[96:99], v[84:87], v[208:211]
    ds_read_b128 v[120:123], v25 offset:49152
    s_add_u32 m0, s41, 14336
    s_add_u32 s30, s89, 49152
    buffer_load_dwordx4 v22, s[56:59], s30 offen lds
    v_mfma_f32_16x16x32_bf16 v[212:215], v[100:103], v[84:87], v[212:215]
    ds_read_b128 v[96:99], v25 offset:50176
    s_waitcnt lgkmcnt(4)
    v_mfma_f32_16x16x32_bf16 v[216:219], v[104:107], v[84:87], v[216:219]
    ds_read_b128 v[100:103], v25 offset:51200
    s_add_u32 m0, s41, 15360
    s_add_u32 s30, s89, 57344
    buffer_load_dwordx4 v22, s[56:59], s30 offen lds
    v_mfma_f32_16x16x32_bf16 v[220:223], v[108:111], v[84:87], v[220:223]
    ds_read_b128 v[104:107], v25 offset:52224
    s_waitcnt lgkmcnt(4)
    v_mfma_f32_16x16x32_bf16 v[224:227], v[112:115], v[84:87], v[224:227]
    ds_read_b128 v[108:111], v25 offset:53248
    v_mfma_f32_16x16x32_bf16 v[228:231], v[116:119], v[84:87], v[228:231]
    ds_read_b128 v[112:115], v25 offset:54272
    s_waitcnt lgkmcnt(4)
    v_mfma_f32_16x16x32_bf16 v[232:235], v[120:123], v[84:87], v[232:235]
    ds_read_b128 v[116:119], v25 offset:55296
    v_mfma_f32_16x16x32_bf16 v[208:211], v[96:99], v[88:91], v[208:211]
    ds_read_b128 v[120:123], v25 offset:56320
    s_waitcnt lgkmcnt(4)
    v_mfma_f32_16x16x32_bf16 v[212:215], v[100:103], v[88:91], v[212:215]
    ds_read_b128 v[96:99], v25 offset:57344
    v_mfma_f32_16x16x32_bf16 v[216:219], v[104:107], v[88:91], v[216:219]
    ds_read_b128 v[100:103], v25 offset:58368
    s_waitcnt lgkmcnt(4)
    v_mfma_f32_16x16x32_bf16 v[220:223], v[108:111], v[88:91], v[220:223]
    ds_read_b128 v[104:107], v25 offset:59392
    buffer_load_dword v19, v5, s[20:23], s17 offen sc1
    v_mfma_f32_16x16x32_bf16 v[224:227], v[112:115], v[88:91], v[224:227]
    ds_read_b128 v[108:111], v25 offset:60416
    s_waitcnt lgkmcnt(4)
    v_mfma_f32_16x16x32_bf16 v[228:231], v[116:119], v[88:91], v[228:231]
    ds_read_b128 v[112:115], v25 offset:61440
    v_mfma_f32_16x16x32_bf16 v[232:235], v[120:123], v[88:91], v[232:235]
    ds_read_b128 v[116:119], v25 offset:62464
    s_waitcnt lgkmcnt(4)
    v_mfma_f32_16x16x32_bf16 v[208:211], v[96:99], v[92:95], v[208:211]
    ds_read_b128 v[120:123], v25 offset:63488
    v_mfma_f32_16x16x32_bf16 v[212:215], v[100:103], v[92:95], v[212:215]
    s_waitcnt lgkmcnt(3)
    v_mfma_f32_16x16x32_bf16 v[216:219], v[104:107], v[92:95], v[216:219]
    v_mfma_f32_16x16x32_bf16 v[220:223], v[108:111], v[92:95], v[220:223]
    s_waitcnt lgkmcnt(1)
    v_mfma_f32_16x16x32_bf16 v[224:227], v[112:115], v[92:95], v[224:227]
    v_mfma_f32_16x16x32_bf16 v[228:231], v[116:119], v[92:95], v[228:231]
    s_waitcnt lgkmcnt(0)
    v_mfma_f32_16x16x32_bf16 v[232:235], v[120:123], v[92:95], v[232:235]
    v_pk_fma_f32 v[208:209], v[152:153], v[26:27], v[208:209]
    v_pk_fma_f32 v[210:211], v[154:155], v[26:27], v[210:211]
    v_pk_fma_f32 v[212:213], v[156:157], v[26:27], v[212:213]
    v_pk_fma_f32 v[214:215], v[158:159], v[26:27], v[214:215]
    v_pk_fma_f32 v[216:217], v[160:161], v[26:27], v[216:217]
    v_pk_fma_f32 v[218:219], v[162:163], v[26:27], v[218:219]
    v_pk_fma_f32 v[220:221], v[164:165], v[26:27], v[220:221]
    v_pk_fma_f32 v[222:223], v[166:167], v[26:27], v[222:223]
    v_pk_fma_f32 v[224:225], v[168:169], v[26:27], v[224:225]
    v_pk_fma_f32 v[226:227], v[170:171], v[26:27], v[226:227]
    v_pk_fma_f32 v[228:229], v[172:173], v[26:27], v[228:229]
    v_pk_fma_f32 v[230:231], v[174:175], v[26:27], v[230:231]
    v_pk_fma_f32 v[232:233], v[176:177], v[26:27], v[232:233]
    v_pk_fma_f32 v[234:235], v[178:179], v[26:27], v[234:235]
    v_pk_mul_f32 v[208:209], v[208:209], v[28:29]
    v_pk_mul_f32 v[210:211], v[210:211], v[28:29]
    v_pk_mul_f32 v[212:213], v[212:213], v[28:29]
    v_pk_mul_f32 v[214:215], v[214:215], v[28:29]
    v_pk_mul_f32 v[216:217], v[216:217], v[28:29]
    v_pk_mul_f32 v[218:219], v[218:219], v[28:29]
    v_pk_mul_f32 v[220:221], v[220:221], v[28:29]
    v_pk_mul_f32 v[222:223], v[222:223], v[28:29]
    v_pk_mul_f32 v[224:225], v[224:225], v[28:29]
    v_pk_mul_f32 v[226:227], v[226:227], v[28:29]
    v_pk_mul_f32 v[228:229], v[228:229], v[28:29]
    v_pk_mul_f32 v[230:231], v[230:231], v[28:29]
    v_pk_mul_f32 v[232:233], v[232:233], v[28:29]
    v_pk_mul_f32 v[234:235], v[234:235], v[28:29]
    s_lshl_b32 s34, s11, 6
    s_lshl_b32 s28, s14, 4
    s_add_u32 s34, s34, s28
    s_mul_i32 s34, s34, 7168
    s_add_u32 s34, s34, 0xb00000
    s_and_b32 s4, s10, 3
    s_xor_b32 s4, s4, 0
    s_mul_i32 s4, s4, 7168
    s_and_b32 s5, s10, 3
    s_xor_b32 s5, s5, 1
    s_mul_i32 s5, s5, 7168
    s_and_b32 s6, s10, 3
    s_xor_b32 s6, s6, 2
    s_mul_i32 s6, s6, 7168
    s_and_b32 s7, s10, 3
    s_xor_b32 s7, s7, 3
    s_mul_i32 s7, s7, 7168
    s_waitcnt vmcnt(0)
    v_cmp_ne_u32 vcc, s87, v19
    s_cbranch_vccz k2_main_kernel_doneC
    s_mov_b32 s40, 100000
    buffer_load_dword v20, v5, s[20:23], s17 offen sc1
k2_main_kernel_pollC:
    s_waitcnt vmcnt(0)
    v_cmp_ne_u32 vcc, s87, v20
    s_cbranch_vccz k2_main_kernel_doneC
    buffer_load_dword v20, v5, s[20:23], s17 offen sc1
    s_sub_u32 s40, s40, 1
    s_cbranch_scc0 k2_main_kernel_pollC
k2_main_kernel_doneC:
    s_xor_b32 s29, s86, 0
    s_mul_i32 s29, s29, 112
    s_add_u32 s29, s29, s34
    s_add_u32 s28, s29, s4
    buffer_load_dwordx4 v[32:35], v8, s[20:23], s28 offen offset:0 sc1
    buffer_load_dwordx4 v[36:39], v8, s[20:23], s28 offen offset:1024 sc1
    buffer_load_dwordx4 v[40:43], v8, s[20:23], s28 offen offset:2048 sc1
    buffer_load_dwordx4 v[44:47], v8, s[20:23], s28 offen offset:3072 sc1
    s_add_u32 s28, s29, s5
    buffer_load_dwordx4 v[48:51], v8, s[20:23], s28 offen offset:0 sc1
    buffer_load_dwordx4 v[52:55], v8, s[20:23], s28 offen offset:1024 sc1
    buffer_load_dwordx4 v[56:59], v8, s[20:23], s28 offen offset:2048 sc1
    buffer_load_dwordx4 v[60:63], v8, s[20:23], s28 offen offset:3072 sc1
    s_add_u32 s28, s29, s6
    buffer_load_dwordx4 v[64:67], v8, s[20:23], s28 offen offset:0 sc1
    buffer_load_dwordx4 v[68:71], v8, s[20:23], s28 offen offset:1024 sc1
    s_lshl_b32 s30, s16, 15
    v_add_u32 v4, s30, v15
    v_xor_b32 v5, 64, v4
    v_lshlrev_b32 v244, 16, v18
    v_lshlrev_b32 v245, 16, v18
    v_lshlrev_b32 v246, 16, v18
    v_lshlrev_b32 v247, 16, v18
    s_barrier
    s_waitcnt vmcnt(8)
    v_mfma_f32_16x16x32_bf16 v[96:99], v[32:35], a[0:3], v[244:247]
    buffer_load_dwordx4 v[72:75], v8, s[20:23], s28 offen offset:2048 sc1
    buffer_load_dwordx4 v[76:79], v8, s[20:23], s28 offen offset:3072 sc1
    v_mfma_f32_16x16x32_bf16 v[124:127], v[32:35], a[4:7], 0
    s_add_u32 s28, s29, s7
    v_mfma_f32_16x16x32_bf16 v[152:155], v[32:35], a[8:11], 0
    s_xor_b32 s17, s14, 1
    v_mul_f32 v236, v208, v208
    v_mfma_f32_16x16x32_bf16 v[180:183], v[32:35], a[12:15], 0
    v_mul_f32 v237, v209, v209
    v_mul_f32 v238, v210, v210
    v_mfma_f32_16x16x32_bf16 v[100:103], v[36:39], a[0:3], v[244:247]
    buffer_load_dwordx4 v[80:83], v8, s[20:23], s28 offen offset:0 sc1
    buffer_load_dwordx4 v[84:87], v8, s[20:23], s28 offen offset:1024 sc1
    v_mfma_f32_16x16x32_bf16 v[128:131], v[36:39], a[4:7], 0
    v_mul_f32 v239, v211, v211
    v_fma_f32 v236, v236, s36, v6
    v_mfma_f32_16x16x32_bf16 v[156:159], v[36:39], a[8:11], 0
    s_mul_i32 s17, s17, 12288
    v_fma_f32 v237, v237, s36, v6
    v_mfma_f32_16x16x32_bf16 v[184:187], v[36:39], a[12:15], 0
    s_waitcnt vmcnt(10)
    v_mfma_f32_16x16x32_bf16 v[104:107], v[40:43], a[0:3], v[244:247]
    buffer_load_dwordx4 v[88:91], v8, s[20:23], s28 offen offset:2048 sc1
    buffer_load_dwordx4 v[92:95], v8, s[20:23], s28 offen offset:3072 sc1
    v_mfma_f32_16x16x32_bf16 v[132:135], v[40:43], a[4:7], 0
    s_xor_b32 s29, s86, 256
    s_mul_i32 s29, s29, 112
    v_mfma_f32_16x16x32_bf16 v[160:163], v[40:43], a[8:11], 0
    s_add_u32 s29, s29, s34
    s_add_u32 s28, s29, s4
    v_mfma_f32_16x16x32_bf16 v[188:191], v[40:43], a[12:15], 0
    v_fma_f32 v238, v238, s36, v6
    v_fma_f32 v239, v239, s36, v6
    v_mfma_f32_16x16x32_bf16 v[108:111], v[44:47], a[0:3], v[244:247]
    buffer_load_dwordx4 v[32:35], v8, s[20:23], s28 offen offset:0 sc1
    buffer_load_dwordx4 v[36:39], v8, s[20:23], s28 offen offset:1024 sc1
    v_mfma_f32_16x16x32_bf16 v[136:139], v[44:47], a[4:7], 0
    v_mul_f32 v236, v236, v208
    v_mul_f32 v237, v237, v209
    v_mfma_f32_16x16x32_bf16 v[164:167], v[44:47], a[8:11], 0
    s_add_u32 s17, s17, 114688
    v_mul_f32 v238, v238, v210
    v_mfma_f32_16x16x32_bf16 v[192:195], v[44:47], a[12:15], 0
    s_waitcnt vmcnt(12)
    v_mfma_f32_16x16x32_bf16 v[96:99], v[48:51], a[16:19], v[96:99]
    buffer_load_dwordx4 v[40:43], v8, s[20:23], s28 offen offset:2048 sc1
    buffer_load_dwordx4 v[44:47], v8, s[20:23], s28 offen offset:3072 sc1
    v_mfma_f32_16x16x32_bf16 v[124:127], v[48:51], a[20:23], v[124:127]
    s_add_u32 s28, s29, s5
    v_mfma_f32_16x16x32_bf16 v[152:155], v[48:51], a[24:27], v[152:155]
    v_add_u32 v19, s17, v8
    v_mul_f32 v239, v239, v211
    v_mfma_f32_16x16x32_bf16 v[180:183], v[48:51], a[28:31], v[180:183]
    v_exp_f32 v236, v236
    v_mfma_f32_16x16x32_bf16 v[100:103], v[52:55], a[16:19], v[100:103]
    v_exp_f32 v237, v237
    v_mfma_f32_16x16x32_bf16 v[128:131], v[52:55], a[20:23], v[128:131]
    v_exp_f32 v238, v238
    v_mfma_f32_16x16x32_bf16 v[156:159], v[52:55], a[24:27], v[156:159]
    s_xor_b32 s17, s14, 2
    v_exp_f32 v239, v239
    v_mfma_f32_16x16x32_bf16 v[184:187], v[52:55], a[28:31], v[184:187]
    s_waitcnt vmcnt(12)
    v_mfma_f32_16x16x32_bf16 v[104:107], v[56:59], a[16:19], v[104:107]
    buffer_load_dwordx4 v[48:51], v8, s[20:23], s28 offen offset:0 sc1
    buffer_load_dwordx4 v[52:55], v8, s[20:23], s28 offen offset:1024 sc1
    v_mfma_f32_16x16x32_bf16 v[132:135], v[56:59], a[20:23], v[132:135]
    v_add_f32 v236, 1.0, v236
    v_add_f32 v237, 1.0, v237
    v_mfma_f32_16x16x32_bf16 v[160:163], v[56:59], a[24:27], v[160:163]
    s_mul_i32 s17, s17, 12288
    v_add_f32 v238, 1.0, v238
    v_mfma_f32_16x16x32_bf16 v[188:191], v[56:59], a[28:31], v[188:191]
    v_add_f32 v239, 1.0, v239
    v_mfma_f32_16x16x32_bf16 v[108:111], v[60:63], a[16:19], v[108:111]
    v_rcp_f32 v236, v236
    v_mfma_f32_16x16x32_bf16 v[136:139], v[60:63], a[20:23], v[136:139]
    v_rcp_f32 v237, v237
    v_mfma_f32_16x16x32_bf16 v[164:167], v[60:63], a[24:27], v[164:167]
    s_add_u32 s17, s17, 114688
    v_rcp_f32 v238, v238
    v_mfma_f32_16x16x32_bf16 v[192:195], v[60:63], a[28:31], v[192:195]
    s_waitcnt vmcnt(12)
    v_mfma_f32_16x16x32_bf16 v[96:99], v[64:67], a[32:35], v[96:99]
    buffer_load_dwordx4 v[56:59], v8, s[20:23], s28 offen offset:2048 sc1
    buffer_load_dwordx4 v[60:63], v8, s[20:23], s28 offen offset:3072 sc1
    v_mfma_f32_16x16x32_bf16 v[124:127], v[64:67], a[36:39], v[124:127]
    s_add_u32 s28, s29, s6
    v_mfma_f32_16x16x32_bf16 v[152:155], v[64:67], a[40:43], v[152:155]
    v_add_u32 v20, s17, v8
    v_rcp_f32 v239, v239
    v_mfma_f32_16x16x32_bf16 v[180:183], v[64:67], a[44:47], v[180:183]
    v_mul_f32 v208, v236, v208
    v_mul_f32 v209, v237, v209
    v_mfma_f32_16x16x32_bf16 v[100:103], v[68:71], a[32:35], v[100:103]
    v_mul_f32 v210, v238, v210
    v_mul_f32 v211, v239, v211
    v_mfma_f32_16x16x32_bf16 v[128:131], v[68:71], a[36:39], v[128:131]
    v_mul_f32 v240, v212, v212
    v_mul_f32 v241, v213, v213
    v_mfma_f32_16x16x32_bf16 v[156:159], v[68:71], a[40:43], v[156:159]
    s_xor_b32 s17, s14, 3
    v_mul_f32 v242, v214, v214
    v_mfma_f32_16x16x32_bf16 v[184:187], v[68:71], a[44:47], v[184:187]
    s_waitcnt vmcnt(12)
    v_mfma_f32_16x16x32_bf16 v[104:107], v[72:75], a[32:35], v[104:107]
    buffer_load_dwordx4 v[64:67], v8, s[20:23], s28 offen offset:0 sc1
    buffer_load_dwordx4 v[68:71], v8, s[20:23], s28 offen offset:1024 sc1
    v_mfma_f32_16x16x32_bf16 v[132:135], v[72:75], a[36:39], v[132:135]
    v_mul_f32 v243, v215, v215
    v_fma_f32 v240, v240, s36, v6
    v_mfma_f32_16x16x32_bf16 v[160:163], v[72:75], a[40:43], v[160:163]
    s_mul_i32 s17, s17, 12288
    v_fma_f32 v241, v241, s36, v6
    v_mfma_f32_16x16x32_bf16 v[188:191], v[72:75], a[44:47], v[188:191]
    v_fma_f32 v242, v242, s36, v6
    v_fma_f32 v243, v243, s36, v6
    v_mfma_f32_16x16x32_bf16 v[108:111], v[76:79], a[32:35], v[108:111]
    v_mul_f32 v240, v240, v212
    v_mul_f32 v241, v241, v213
    v_mfma_f32_16x16x32_bf16 v[136:139], v[76:79], a[36:39], v[136:139]
    v_mul_f32 v242, v242, v214
    v_mul_f32 v243, v243, v215
    v_mfma_f32_16x16x32_bf16 v[164:167], v[76:79], a[40:43], v[164:167]
    s_add_u32 s17, s17, 114688
    v_exp_f32 v240, v240
    v_mfma_f32_16x16x32_bf16 v[192:195], v[76:79], a[44:47], v[192:195]
    s_waitcnt vmcnt(12)
    v_mfma_f32_16x16x32_bf16 v[96:99], v[80:83], a[48:51], v[96:99]
    buffer_load_dwordx4 v[72:75], v8, s[20:23], s28 offen offset:2048 sc1
    buffer_load_dwordx4 v[76:79], v8, s[20:23], s28 offen offset:3072 sc1
    v_mfma_f32_16x16x32_bf16 v[124:127], v[80:83], a[52:55], v[124:127]
    s_add_u32 s28, s29, s7
    v_mfma_f32_16x16x32_bf16 v[152:155], v[80:83], a[56:59], v[152:155]
    v_add_u32 v21, s17, v8
    v_exp_f32 v241, v241
    v_mfma_f32_16x16x32_bf16 v[180:183], v[80:83], a[60:63], v[180:183]
    v_exp_f32 v242, v242
    v_mfma_f32_16x16x32_bf16 v[100:103], v[84:87], a[48:51], v[100:103]
    v_exp_f32 v243, v243
    v_mfma_f32_16x16x32_bf16 v[128:131], v[84:87], a[52:55], v[128:131]
    v_add_f32 v240, 1.0, v240
    v_add_f32 v241, 1.0, v241
    v_mfma_f32_16x16x32_bf16 v[156:159], v[84:87], a[56:59], v[156:159]
    s_mul_i32 s17, s14, 12288
    v_add_f32 v242, 1.0, v242
    v_mfma_f32_16x16x32_bf16 v[184:187], v[84:87], a[60:63], v[184:187]
    s_waitcnt vmcnt(12)
    v_mfma_f32_16x16x32_bf16 v[104:107], v[88:91], a[48:51], v[104:107]
    buffer_load_dwordx4 v[80:83], v8, s[20:23], s28 offen offset:0 sc1
    buffer_load_dwordx4 v[84:87], v8, s[20:23], s28 offen offset:1024 sc1
    v_mfma_f32_16x16x32_bf16 v[132:135], v[88:91], a[52:55], v[132:135]
    v_add_f32 v243, 1.0, v243
    v_mfma_f32_16x16x32_bf16 v[160:163], v[88:91], a[56:59], v[160:163]
    s_add_u32 s17, s17, 114688
    v_rcp_f32 v240, v240
    v_mfma_f32_16x16x32_bf16 v[188:191], v[88:91], a[60:63], v[188:191]
    v_rcp_f32 v241, v241
    v_mfma_f32_16x16x32_bf16 v[108:111], v[92:95], a[48:51], v[108:111]
    v_rcp_f32 v242, v242
    v_mfma_f32_16x16x32_bf16 v[136:139], v[92:95], a[52:55], v[136:139]
    v_rcp_f32 v243, v243
    v_mfma_f32_16x16x32_bf16 v[164:167], v[92:95], a[56:59], v[164:167]
    v_add_u32 v17, s17, v8
    v_mul_f32 v212, v240, v212
    v_mfma_f32_16x16x32_bf16 v[192:195], v[92:95], a[60:63], v[192:195]
    s_waitcnt vmcnt(12)
    v_mfma_f32_16x16x32_bf16 v[96:99], v[32:35], a[64:67], v[96:99]
    buffer_load_dwordx4 v[88:91], v8, s[20:23], s28 offen offset:2048 sc1
    buffer_load_dwordx4 v[92:95], v8, s[20:23], s28 offen offset:3072 sc1
    v_mfma_f32_16x16x32_bf16 v[124:127], v[32:35], a[68:71], v[124:127]
    s_xor_b32 s29, s86, 512
    s_mul_i32 s29, s29, 112
    v_mfma_f32_16x16x32_bf16 v[152:155], v[32:35], a[72:75], v[152:155]
    s_add_u32 s29, s29, s34
    s_add_u32 s28, s29, s4
    v_mfma_f32_16x16x32_bf16 v[180:183], v[32:35], a[76:79], v[180:183]
    v_mul_f32 v213, v241, v213
    v_mul_f32 v214, v242, v214
    v_mfma_f32_16x16x32_bf16 v[100:103], v[36:39], a[64:67], v[100:103]
    v_mul_f32 v215, v243, v215
    v_mul_f32 v236, v216, v216
    v_mfma_f32_16x16x32_bf16 v[128:131], v[36:39], a[68:71], v[128:131]
    v_mul_f32 v237, v217, v217
    v_mul_f32 v238, v218, v218
    v_mfma_f32_16x16x32_bf16 v[156:159], v[36:39], a[72:75], v[156:159]
    v_lshlrev_b32 v23, 9, v12
    v_mul_f32 v239, v219, v219
    v_mfma_f32_16x16x32_bf16 v[184:187], v[36:39], a[76:79], v[184:187]
    s_waitcnt vmcnt(12)
    v_mfma_f32_16x16x32_bf16 v[104:107], v[40:43], a[64:67], v[104:107]
    buffer_load_dwordx4 v[32:35], v8, s[20:23], s28 offen offset:0 sc1
    buffer_load_dwordx4 v[36:39], v8, s[20:23], s28 offen offset:1024 sc1
    v_mfma_f32_16x16x32_bf16 v[132:135], v[40:43], a[68:71], v[132:135]
    v_fma_f32 v236, v236, s36, v6
    v_fma_f32 v237, v237, s36, v6
    v_mfma_f32_16x16x32_bf16 v[160:163], v[40:43], a[72:75], v[160:163]
    v_lshl_add_u32 v23, v11, 4, v23
    v_fma_f32 v238, v238, s36, v6
    v_mfma_f32_16x16x32_bf16 v[188:191], v[40:43], a[76:79], v[188:191]
    v_fma_f32 v239, v239, s36, v6
    v_mul_f32 v236, v236, v216
    v_mfma_f32_16x16x32_bf16 v[108:111], v[44:47], a[64:67], v[108:111]
    v_mul_f32 v237, v237, v217
    v_mul_f32 v238, v238, v218
    v_mfma_f32_16x16x32_bf16 v[136:139], v[44:47], a[68:71], v[136:139]
    v_mul_f32 v239, v239, v219
    v_mfma_f32_16x16x32_bf16 v[164:167], v[44:47], a[72:75], v[164:167]
    s_mul_i32 s38, s19, 56
    v_exp_f32 v236, v236
    v_mfma_f32_16x16x32_bf16 v[192:195], v[44:47], a[76:79], v[192:195]
    s_waitcnt vmcnt(12)
    v_mfma_f32_16x16x32_bf16 v[96:99], v[48:51], a[80:83], v[96:99]
    buffer_load_dwordx4 v[40:43], v8, s[20:23], s28 offen offset:2048 sc1
    buffer_load_dwordx4 v[44:47], v8, s[20:23], s28 offen offset:3072 sc1
    v_mfma_f32_16x16x32_bf16 v[124:127], v[48:51], a[84:87], v[124:127]
    s_add_u32 s28, s29, s5
    v_mfma_f32_16x16x32_bf16 v[152:155], v[48:51], a[88:91], v[152:155]
    s_mul_i32 s17, s11, 7
    v_exp_f32 v237, v237
    v_mfma_f32_16x16x32_bf16 v[180:183], v[48:51], a[92:95], v[180:183]
    v_exp_f32 v238, v238
    v_mfma_f32_16x16x32_bf16 v[100:103], v[52:55], a[80:83], v[100:103]
    v_exp_f32 v239, v239
    v_mfma_f32_16x16x32_bf16 v[128:131], v[52:55], a[84:87], v[128:131]
    v_add_f32 v236, 1.0, v236
    v_add_f32 v237, 1.0, v237
    v_mfma_f32_16x16x32_bf16 v[156:159], v[52:55], a[88:91], v[156:159]
    s_add_u32 s38, s38, s17
    v_add_f32 v238, 1.0, v238
    v_mfma_f32_16x16x32_bf16 v[184:187], v[52:55], a[92:95], v[184:187]
    s_waitcnt vmcnt(12)
    v_mfma_f32_16x16x32_bf16 v[104:107], v[56:59], a[80:83], v[104:107]
    buffer_load_dwordx4 v[48:51], v8, s[20:23], s28 offen offset:0 sc1
    buffer_load_dwordx4 v[52:55], v8, s[20:23], s28 offen offset:1024 sc1
    v_mfma_f32_16x16x32_bf16 v[132:135], v[56:59], a[84:87], v[132:135]
    v_add_f32 v239, 1.0, v239
    v_mfma_f32_16x16x32_bf16 v[160:163], v[56:59], a[88:91], v[160:163]
    s_lshl_b32 s38, s38, 10
    v_rcp_f32 v236, v236
    v_mfma_f32_16x16x32_bf16 v[188:191], v[56:59], a[92:95], v[188:191]
    v_rcp_f32 v237, v237
    v_mfma_f32_16x16x32_bf16 v[108:111], v[60:63], a[80:83], v[108:111]
    v_rcp_f32 v238, v238
    v_mfma_f32_16x16x32_bf16 v[136:139], v[60:63], a[84:87], v[136:139]
    v_rcp_f32 v239, v239
    v_mfma_f32_16x16x32_bf16 v[164:167], v[60:63], a[88:91], v[164:167]
    s_lshl_b32 s17, s16, 8
    v_mul_f32 v216, v236, v216
    v_mfma_f32_16x16x32_bf16 v[192:195], v[60:63], a[92:95], v[192:195]
    s_waitcnt vmcnt(12)
    v_mfma_f32_16x16x32_bf16 v[96:99], v[64:67], a[96:99], v[96:99]
    buffer_load_dwordx4 v[56:59], v8, s[20:23], s28 offen offset:2048 sc1
    buffer_load_dwordx4 v[60:63], v8, s[20:23], s28 offen offset:3072 sc1
    v_mfma_f32_16x16x32_bf16 v[124:127], v[64:67], a[100:103], v[124:127]
    s_add_u32 s28, s29, s6
    v_mfma_f32_16x16x32_bf16 v[152:155], v[64:67], a[104:107], v[152:155]
    s_add_u32 s38, s38, s17
    v_mul_f32 v217, v237, v217
    v_mfma_f32_16x16x32_bf16 v[180:183], v[64:67], a[108:111], v[180:183]
    v_mul_f32 v218, v238, v218
    v_mul_f32 v219, v239, v219
    v_mfma_f32_16x16x32_bf16 v[100:103], v[68:71], a[96:99], v[100:103]
    v_mul_f32 v240, v220, v220
    v_mul_f32 v241, v221, v221
    v_mfma_f32_16x16x32_bf16 v[128:131], v[68:71], a[100:103], v[128:131]
    v_mul_f32 v242, v222, v222
    v_mul_f32 v243, v223, v223
    v_mfma_f32_16x16x32_bf16 v[156:159], v[68:71], a[104:107], v[156:159]
    s_add_u32 s38, s38, 0xe80000
    v_fma_f32 v240, v240, s36, v6
    v_mfma_f32_16x16x32_bf16 v[184:187], v[68:71], a[108:111], v[184:187]
    s_waitcnt vmcnt(12)
    v_mfma_f32_16x16x32_bf16 v[104:107], v[72:75], a[96:99], v[104:107]
    buffer_load_dwordx4 v[64:67], v8, s[20:23], s28 offen offset:0 sc1
    buffer_load_dwordx4 v[68:71], v8, s[20:23], s28 offen offset:1024 sc1
    v_mfma_f32_16x16x32_bf16 v[132:135], v[72:75], a[100:103], v[132:135]
    v_fma_f32 v241, v241, s36, v6
    v_fma_f32 v242, v242, s36, v6
    v_mfma_f32_16x16x32_bf16 v[160:163], v[72:75], a[104:107], v[160:163]
    s_add_u32 s39, s38, 4096
    v_fma_f32 v243, v243, s36, v6
    v_mfma_f32_16x16x32_bf16 v[188:191], v[72:75], a[108:111], v[188:191]
    v_mul_f32 v240, v240, v220
    v_mul_f32 v241, v241, v221
    v_mfma_f32_16x16x32_bf16 v[108:111], v[76:79], a[96:99], v[108:111]
    v_mul_f32 v242, v242, v222
    v_mul_f32 v243, v243, v223
    v_mfma_f32_16x16x32_bf16 v[136:139], v[76:79], a[100:103], v[136:139]
    v_exp_f32 v240, v240
    v_mfma_f32_16x16x32_bf16 v[164:167], v[76:79], a[104:107], v[164:167]
    v_and_b32 v24, 0x3ff, v23
    v_exp_f32 v241, v241
    v_mfma_f32_16x16x32_bf16 v[192:195], v[76:79], a[108:111], v[192:195]
    s_waitcnt vmcnt(12)
    v_mfma_f32_16x16x32_bf16 v[96:99], v[80:83], a[112:115], v[96:99]
    buffer_load_dwordx4 v[72:75], v8, s[20:23], s28 offen offset:2048 sc1
    buffer_load_dwordx4 v[76:79], v8, s[20:23], s28 offen offset:3072 sc1
    v_mfma_f32_16x16x32_bf16 v[124:127], v[80:83], a[116:119], v[124:127]
    s_add_u32 s28, s29, s7
    v_mfma_f32_16x16x32_bf16 v[152:155], v[80:83], a[120:123], v[152:155]
    v_lshl_add_u32 v24, v9, 3, v24
    v_exp_f32 v242, v242
    v_mfma_f32_16x16x32_bf16 v[180:183], v[80:83], a[124:127], v[180:183]
    v_exp_f32 v243, v243
    v_mfma_f32_16x16x32_bf16 v[100:103], v[84:87], a[112:115], v[100:103]
    v_add_f32 v240, 1.0, v240
    v_add_f32 v241, 1.0, v241
    v_mfma_f32_16x16x32_bf16 v[128:131], v[84:87], a[116:119], v[128:131]
    v_add_f32 v242, 1.0, v242
    v_add_f32 v243, 1.0, v243
    v_mfma_f32_16x16x32_bf16 v[156:159], v[84:87], a[120:123], v[156:159]
    s_lshl_b32 s17, s19, 6
    v_rcp_f32 v240, v240
    v_mfma_f32_16x16x32_bf16 v[184:187], v[84:87], a[124:127], v[184:187]
    s_waitcnt vmcnt(12)
    v_mfma_f32_16x16x32_bf16 v[104:107], v[88:91], a[112:115], v[104:107]
    buffer_load_dwordx4 v[80:83], v8, s[20:23], s28 offen offset:0 sc1
    buffer_load_dwordx4 v[84:87], v8, s[20:23], s28 offen offset:1024 sc1
    v_mfma_f32_16x16x32_bf16 v[132:135], v[88:91], a[116:119], v[132:135]
    v_rcp_f32 v241, v241
    v_mfma_f32_16x16x32_bf16 v[160:163], v[88:91], a[120:123], v[160:163]
    s_lshr_b32 s35, s11, 2
    v_rcp_f32 v242, v242
    v_mfma_f32_16x16x32_bf16 v[188:191], v[88:91], a[124:127], v[188:191]
    v_rcp_f32 v243, v243
    v_mfma_f32_16x16x32_bf16 v[108:111], v[92:95], a[112:115], v[108:111]
    v_mul_f32 v220, v240, v220
    v_mul_f32 v221, v241, v221
    v_mfma_f32_16x16x32_bf16 v[136:139], v[92:95], a[116:119], v[136:139]
    v_mul_f32 v222, v242, v222
    v_mul_f32 v223, v243, v223
    v_mfma_f32_16x16x32_bf16 v[164:167], v[92:95], a[120:123], v[164:167]
    s_lshl_b32 s35, s35, 5
    v_mul_f32 v236, v224, v224
    v_mfma_f32_16x16x32_bf16 v[192:195], v[92:95], a[124:127], v[192:195]
    s_waitcnt vmcnt(12)
    v_mfma_f32_16x16x32_bf16 v[96:99], v[32:35], a[128:131], v[96:99]
    buffer_load_dwordx4 v[88:91], v8, s[20:23], s28 offen offset:2048 sc1
    buffer_load_dwordx4 v[92:95], v8, s[20:23], s28 offen offset:3072 sc1
    v_mfma_f32_16x16x32_bf16 v[124:127], v[32:35], a[132:135], v[124:127]
    s_xor_b32 s29, s86, 768
    s_mul_i32 s29, s29, 112
    v_mfma_f32_16x16x32_bf16 v[152:155], v[32:35], a[136:139], v[152:155]
    s_add_u32 s29, s29, s34
    s_add_u32 s28, s29, s4
    v_mfma_f32_16x16x32_bf16 v[180:183], v[32:35], a[140:143], v[180:183]
    v_mul_f32 v237, v225, v225
    v_mul_f32 v238, v226, v226
    v_mfma_f32_16x16x32_bf16 v[100:103], v[36:39], a[128:131], v[100:103]
    v_mul_f32 v239, v227, v227
    v_fma_f32 v236, v236, s36, v6
    v_mfma_f32_16x16x32_bf16 v[128:131], v[36:39], a[132:135], v[128:131]
    v_fma_f32 v237, v237, s36, v6
    v_fma_f32 v238, v238, s36, v6
    v_mfma_f32_16x16x32_bf16 v[156:159], v[36:39], a[136:139], v[156:159]
    s_add_u32 s17, s17, s35
    v_fma_f32 v239, v239, s36, v6
    v_mfma_f32_16x16x32_bf16 v[184:187], v[36:39], a[140:143], v[184:187]
    s_waitcnt vmcnt(12)
    v_mfma_f32_16x16x32_bf16 v[104:107], v[40:43], a[128:131], v[104:107]
    buffer_load_dwordx4 v[32:35], v8, s[20:23], s28 offen offset:0 sc1
    buffer_load_dwordx4 v[36:39], v8, s[20:23], s28 offen offset:1024 sc1
    v_mfma_f32_16x16x32_bf16 v[132:135], v[40:43], a[132:135], v[132:135]
    v_mul_f32 v236, v236, v224
    v_mul_f32 v237, v237, v225
    v_mfma_f32_16x16x32_bf16 v[160:163], v[40:43], a[136:139], v[160:163]
    s_and_b32 s35, s11, 3
    v_mul_f32 v238, v238, v226
    v_mfma_f32_16x16x32_bf16 v[188:191], v[40:43], a[140:143], v[188:191]
    v_mul_f32 v239, v239, v227
    v_mfma_f32_16x16x32_bf16 v[108:111], v[44:47], a[128:131], v[108:111]
    v_exp_f32 v236, v236
    v_mfma_f32_16x16x32_bf16 v[136:139], v[44:47], a[132:135], v[136:139]
    v_exp_f32 v237, v237
    v_mfma_f32_16x16x32_bf16 v[164:167], v[44:47], a[136:139], v[164:167]
    s_lshl_b32 s35, s35, 1
    v_exp_f32 v238, v238
    v_mfma_f32_16x16x32_bf16 v[192:195], v[44:47], a[140:143], v[192:195]
    s_waitcnt vmcnt(12)
    v_mfma_f32_16x16x32_bf16 v[96:99], v[48:51], a[144:147], v[96:99]
    buffer_load_dwordx4 v[40:43], v8, s[20:23], s28 offen offset:2048 sc1
    buffer_load_dwordx4 v[44:47], v8, s[20:23], s28 offen offset:3072 sc1
    v_mfma_f32_16x16x32_bf16 v[124:127], v[48:51], a[148:151], v[124:127]
    s_add_u32 s28, s29, s5
    v_mfma_f32_16x16x32_bf16 v[152:155], v[48:51], a[152:155], v[152:155]
    s_add_u32 s35, s35, s16
    v_exp_f32 v239, v239
    v_mfma_f32_16x16x32_bf16 v[180:183], v[48:51], a[156:159], v[180:183]
    v_add_f32 v236, 1.0, v236
    v_add_f32 v237, 1.0, v237
    v_mfma_f32_16x16x32_bf16 v[100:103], v[52:55], a[144:147], v[100:103]
    v_add_f32 v238, 1.0, v238
    v_add_f32 v239, 1.0, v239
    v_mfma_f32_16x16x32_bf16 v[128:131], v[52:55], a[148:151], v[128:131]
    v_rcp_f32 v236, v236
    v_mfma_f32_16x16x32_bf16 v[156:159], v[52:55], a[152:155], v[156:159]
    s_lshl_b32 s35, s35, 2
    v_rcp_f32 v237, v237
    v_mfma_f32_16x16x32_bf16 v[184:187], v[52:55], a[156:159], v[184:187]
    s_waitcnt vmcnt(12)
    v_mfma_f32_16x16x32_bf16 v[104:107], v[56:59], a[144:147], v[104:107]
    buffer_load_dwordx4 v[48:51], v8, s[20:23], s28 offen offset:0 sc1
    buffer_load_dwordx4 v[52:55], v8, s[20:23], s28 offen offset:1024 sc1
    v_mfma_f32_16x16x32_bf16 v[132:135], v[56:59], a[148:151], v[132:135]
    v_rcp_f32 v238, v238
    v_mfma_f32_16x16x32_bf16 v[160:163], v[56:59], a[152:155], v[160:163]
    s_add_u32 s17, s17, s35
    v_rcp_f32 v239, v239
    v_mfma_f32_16x16x32_bf16 v[188:191], v[56:59], a[156:159], v[188:191]
    v_mul_f32 v224, v236, v224
    v_mul_f32 v225, v237, v225
    v_mfma_f32_16x16x32_bf16 v[108:111], v[60:63], a[144:147], v[108:111]
    v_mul_f32 v226, v238, v226
    v_mul_f32 v227, v239, v227
    v_mfma_f32_16x16x32_bf16 v[136:139], v[60:63], a[148:151], v[136:139]
    v_mul_f32 v240, v228, v228
    v_mul_f32 v241, v229, v229
    v_mfma_f32_16x16x32_bf16 v[164:167], v[60:63], a[152:155], v[164:167]
    s_lshl_b32 s17, s17, 5
    v_mul_f32 v242, v230, v230
    v_mfma_f32_16x16x32_bf16 v[192:195], v[60:63], a[156:159], v[192:195]
    s_waitcnt vmcnt(12)
    v_mfma_f32_16x16x32_bf16 v[96:99], v[64:67], a[160:163], v[96:99]
    buffer_load_dwordx4 v[56:59], v8, s[20:23], s28 offen offset:2048 sc1
    buffer_load_dwordx4 v[60:63], v8, s[20:23], s28 offen offset:3072 sc1
    v_mfma_f32_16x16x32_bf16 v[124:127], v[64:67], a[164:167], v[124:127]
    s_add_u32 s28, s29, s6
    v_mfma_f32_16x16x32_bf16 v[152:155], v[64:67], a[168:171], v[152:155]
    s_add_u32 s17, s17, 0x1720000
    v_mul_f32 v243, v231, v231
    v_mfma_f32_16x16x32_bf16 v[180:183], v[64:67], a[172:175], v[180:183]
    v_fma_f32 v240, v240, s36, v6
    v_fma_f32 v241, v241, s36, v6
    v_mfma_f32_16x16x32_bf16 v[100:103], v[68:71], a[160:163], v[100:103]
    v_fma_f32 v242, v242, s36, v6
    v_fma_f32 v243, v243, s36, v6
    v_mfma_f32_16x16x32_bf16 v[128:131], v[68:71], a[164:167], v[128:131]
    v_mul_f32 v240, v240, v228
    v_mul_f32 v241, v241, v229
    v_mfma_f32_16x16x32_bf16 v[156:159], v[68:71], a[168:171], v[156:159]
    s_lshl_b32 s32, s18, 6
    v_mul_f32 v242, v242, v230
    v_mfma_f32_16x16x32_bf16 v[184:187], v[68:71], a[172:175], v[184:187]
    s_waitcnt vmcnt(12)
    v_mfma_f32_16x16x32_bf16 v[104:107], v[72:75], a[160:163], v[104:107]
    buffer_load_dwordx4 v[64:67], v8, s[20:23], s28 offen offset:0 sc1
    buffer_load_dwordx4 v[68:71], v8, s[20:23], s28 offen offset:1024 sc1
    v_mfma_f32_16x16x32_bf16 v[132:135], v[72:75], a[164:167], v[132:135]
    v_mul_f32 v243, v243, v231
    v_mfma_f32_16x16x32_bf16 v[160:163], v[72:75], a[168:171], v[160:163]
    s_lshl_b32 s35, s16, 5
    v_exp_f32 v240, v240
    v_mfma_f32_16x16x32_bf16 v[188:191], v[72:75], a[172:175], v[188:191]
    v_exp_f32 v241, v241
    v_mfma_f32_16x16x32_bf16 v[108:111], v[76:79], a[160:163], v[108:111]
    v_exp_f32 v242, v242
    v_mfma_f32_16x16x32_bf16 v[136:139], v[76:79], a[164:167], v[136:139]
    v_exp_f32 v243, v243
    v_mfma_f32_16x16x32_bf16 v[164:167], v[76:79], a[168:171], v[164:167]
    s_add_u32 s32, s32, s35
    v_add_f32 v240, 1.0, v240
    v_mfma_f32_16x16x32_bf16 v[192:195], v[76:79], a[172:175], v[192:195]
    s_waitcnt vmcnt(12)
    v_mfma_f32_16x16x32_bf16 v[96:99], v[80:83], a[176:179], v[96:99]
    buffer_load_dwordx4 v[72:75], v8, s[20:23], s28 offen offset:2048 sc1
    buffer_load_dwordx4 v[76:79], v8, s[20:23], s28 offen offset:3072 sc1
    v_mfma_f32_16x16x32_bf16 v[124:127], v[80:83], a[180:183], v[124:127]
    s_add_u32 s28, s29, s7
    v_mfma_f32_16x16x32_bf16 v[152:155], v[80:83], a[184:187], v[152:155]
    s_lshl_b32 s32, s32, 5
    v_add_f32 v241, 1.0, v241
    v_mfma_f32_16x16x32_bf16 v[180:183], v[80:83], a[188:191], v[180:183]
    v_add_f32 v242, 1.0, v242
    v_add_f32 v243, 1.0, v243
    v_mfma_f32_16x16x32_bf16 v[100:103], v[84:87], a[176:179], v[100:103]
    v_rcp_f32 v240, v240
    v_mfma_f32_16x16x32_bf16 v[128:131], v[84:87], a[180:183], v[128:131]
    v_rcp_f32 v241, v241
    v_mfma_f32_16x16x32_bf16 v[156:159], v[84:87], a[184:187], v[156:159]
    s_add_u32 s32, s32, 0x1720000
    v_rcp_f32 v242, v242
    v_mfma_f32_16x16x32_bf16 v[184:187], v[84:87], a[188:191], v[184:187]
    s_waitcnt vmcnt(12)
    v_mfma_f32_16x16x32_bf16 v[104:107], v[88:91], a[176:179], v[104:107]
    buffer_load_dwordx4 v[80:83], v8, s[20:23], s28 offen offset:0 sc1
    buffer_load_dwordx4 v[84:87], v8, s[20:23], s28 offen offset:1024 sc1
    v_mfma_f32_16x16x32_bf16 v[132:135], v[88:91], a[180:183], v[132:135]
    s_add_u32 s34, s34, 4096
    v_mfma_f32_16x16x32_bf16 v[160:163], v[88:91], a[184:187], v[160:163]
    v_and_b32 v30, 7, v1
    v_rcp_f32 v243, v243
    v_mfma_f32_16x16x32_bf16 v[188:191], v[88:91], a[188:191], v[188:191]
    v_mul_f32 v228, v240, v228
    v_mul_f32 v229, v241, v229
    v_mfma_f32_16x16x32_bf16 v[108:111], v[92:95], a[176:179], v[108:111]
    v_mul_f32 v230, v242, v230
    v_mul_f32 v231, v243, v231
    v_mfma_f32_16x16x32_bf16 v[136:139], v[92:95], a[180:183], v[136:139]
    v_mul_f32 v236, v232, v232
    v_mul_f32 v237, v233, v233
    v_mfma_f32_16x16x32_bf16 v[164:167], v[92:95], a[184:187], v[164:167]
    v_lshlrev_b32 v30, 7, v30
    v_mul_f32 v238, v234, v234
    v_mfma_f32_16x16x32_bf16 v[192:195], v[92:95], a[188:191], v[192:195]
    s_waitcnt vmcnt(12)
    v_mfma_f32_16x16x32_bf16 v[96:99], v[32:35], a[192:195], v[96:99]
    buffer_load_dwordx4 v[88:91], v8, s[20:23], s28 offen offset:2048 sc1
    buffer_load_dwordx4 v[92:95], v8, s[20:23], s28 offen offset:3072 sc1
    v_mfma_f32_16x16x32_bf16 v[124:127], v[32:35], a[196:199], v[124:127]
    s_xor_b32 s29, s86, 0
    s_mul_i32 s29, s29, 112
    v_mfma_f32_16x16x32_bf16 v[152:155], v[32:35], a[200:203], v[152:155]
    s_add_u32 s29, s29, s34
    s_add_u32 s28, s29, s4
    v_mfma_f32_16x16x32_bf16 v[180:183], v[32:35], a[204:207], v[180:183]
    v_mul_f32 v239, v235, v235
    v_fma_f32 v236, v236, s36, v6
    v_mfma_f32_16x16x32_bf16 v[100:103], v[36:39], a[192:195], v[100:103]
    v_fma_f32 v237, v237, s36, v6
    v_fma_f32 v238, v238, s36, v6
    v_mfma_f32_16x16x32_bf16 v[128:131], v[36:39], a[196:199], v[128:131]
    v_fma_f32 v239, v239, s36, v6
    v_mul_f32 v236, v236, v232
    v_mfma_f32_16x16x32_bf16 v[156:159], v[36:39], a[200:203], v[156:159]
    s_mul_i32 s33, s18, 56
    v_mul_f32 v237, v237, v233
    v_mfma_f32_16x16x32_bf16 v[184:187], v[36:39], a[204:207], v[184:187]
    s_waitcnt vmcnt(12)
    v_mfma_f32_16x16x32_bf16 v[104:107], v[40:43], a[192:195], v[104:107]
    v_mul_f32 v238, v238, v234
    v_mul_f32 v239, v239, v235
    v_mfma_f32_16x16x32_bf16 v[132:135], v[40:43], a[196:199], v[132:135]
    v_exp_f32 v236, v236
    v_mfma_f32_16x16x32_bf16 v[160:163], v[40:43], a[200:203], v[160:163]
    s_mul_i32 s35, s16, 28
    v_exp_f32 v237, v237
    v_mfma_f32_16x16x32_bf16 v[188:191], v[40:43], a[204:207], v[188:191]
    v_exp_f32 v238, v238
    v_mfma_f32_16x16x32_bf16 v[108:111], v[44:47], a[192:195], v[108:111]
    buffer_load_dwordx4 v[32:35], v8, s[20:23], s28 offen offset:0 sc1
    buffer_load_dwordx4 v[36:39], v8, s[20:23], s28 offen offset:1024 sc1
    buffer_load_dwordx4 v[40:43], v8, s[20:23], s28 offen offset:2048 sc1
    v_mfma_f32_16x16x32_bf16 v[136:139], v[44:47], a[196:199], v[136:139]
    s_add_u32 s28, s29, s5
    v_mfma_f32_16x16x32_bf16 v[164:167], v[44:47], a[200:203], v[164:167]
    s_add_u32 s33, s33, s35
    v_exp_f32 v239, v239
    v_mfma_f32_16x16x32_bf16 v[192:195], v[44:47], a[204:207], v[192:195]
    s_waitcnt vmcnt(13)
    v_mfma_f32_16x16x32_bf16 v[96:99], v[48:51], a[208:211], v[96:99]
    v_add_f32 v236, 1.0, v236
    v_add_f32 v237, 1.0, v237
    v_mfma_f32_16x16x32_bf16 v[124:127], v[48:51], a[212:215], v[124:127]
    v_add_f32 v238, 1.0, v238
    v_add_f32 v239, 1.0, v239
    v_mfma_f32_16x16x32_bf16 v[152:155], v[48:51], a[216:219], v[152:155]
    s_lshl_b32 s33, s33, 10
    v_rcp_f32 v236, v236
    v_mfma_f32_16x16x32_bf16 v[180:183], v[48:51], a[220:223], v[180:183]
    v_rcp_f32 v237, v237
    v_mfma_f32_16x16x32_bf16 v[100:103], v[52:55], a[208:211], v[100:103]
    v_rcp_f32 v238, v238
    v_mfma_f32_16x16x32_bf16 v[128:131], v[52:55], a[212:215], v[128:131]
    v_rcp_f32 v239, v239
    v_mfma_f32_16x16x32_bf16 v[156:159], v[52:55], a[216:219], v[156:159]
    s_add_u32 s33, s33, 0xe80000
    v_mul_f32 v232, v236, v232
    v_mul_f32 v233, v237, v233
    v_mfma_f32_16x16x32_bf16 v[184:187], v[52:55], a[220:223], v[184:187]
    s_waitcnt vmcnt(11)
    v_mfma_f32_16x16x32_bf16 v[104:107], v[56:59], a[208:211], v[104:107]
    buffer_load_dwordx4 v[44:47], v8, s[20:23], s28 offen offset:0 sc1
    buffer_load_dwordx4 v[48:51], v8, s[20:23], s28 offen offset:1024 sc1
    buffer_load_dwordx4 v[52:55], v8, s[20:23], s28 offen offset:2048 sc1
    v_mfma_f32_16x16x32_bf16 v[132:135], v[56:59], a[212:215], v[132:135]
    s_add_u32 s28, s29, s6
    v_mfma_f32_16x16x32_bf16 v[160:163], v[56:59], a[216:219], v[160:163]
    v_mul_f32 v234, v238, v234
    v_mul_f32 v235, v239, v235
    v_mfma_f32_16x16x32_bf16 v[188:191], v[56:59], a[220:223], v[188:191]
    v_mfma_f32_16x16x32_bf16 v[108:111], v[60:63], a[208:211], v[108:111]
    v_mfma_f32_16x16x32_bf16 v[136:139], v[60:63], a[212:215], v[136:139]
    v_mfma_f32_16x16x32_bf16 v[164:167], v[60:63], a[216:219], v[164:167]
    v_mfma_f32_16x16x32_bf16 v[192:195], v[60:63], a[220:223], v[192:195]
    s_waitcnt vmcnt(12)
    v_mfma_f32_16x16x32_bf16 v[96:99], v[64:67], a[224:227], v[96:99]
    v_mfma_f32_16x16x32_bf16 v[124:127], v[64:67], a[228:231], v[124:127]
    v_mfma_f32_16x16x32_bf16 v[152:155], v[64:67], a[232:235], v[152:155]
    v_mfma_f32_16x16x32_bf16 v[180:183], v[64:67], a[236:239], v[180:183]
    v_mfma_f32_16x16x32_bf16 v[100:103], v[68:71], a[224:227], v[100:103]
    buffer_load_dwordx4 v[56:59], v8, s[20:23], s28 offen offset:0 sc1
    buffer_load_dwordx4 v[60:63], v8, s[20:23], s28 offen offset:1024 sc1
    buffer_load_dwordx4 v[64:67], v8, s[20:23], s28 offen offset:2048 sc1
    v_mfma_f32_16x16x32_bf16 v[128:131], v[68:71], a[228:231], v[128:131]
    s_add_u32 s28, s29, s7
    v_mfma_f32_16x16x32_bf16 v[156:159], v[68:71], a[232:235], v[156:159]
    v_mfma_f32_16x16x32_bf16 v[184:187], v[68:71], a[236:239], v[184:187]
    s_waitcnt vmcnt(13)
    v_mfma_f32_16x16x32_bf16 v[104:107], v[72:75], a[224:227], v[104:107]
    v_mfma_f32_16x16x32_bf16 v[132:135], v[72:75], a[228:231], v[132:135]
    v_mfma_f32_16x16x32_bf16 v[160:163], v[72:75], a[232:235], v[160:163]
    v_mfma_f32_16x16x32_bf16 v[188:191], v[72:75], a[236:239], v[188:191]
    v_mfma_f32_16x16x32_bf16 v[108:111], v[76:79], a[224:227], v[108:111]
    v_mfma_f32_16x16x32_bf16 v[136:139], v[76:79], a[228:231], v[136:139]
    v_mfma_f32_16x16x32_bf16 v[164:167], v[76:79], a[232:235], v[164:167]
    v_mfma_f32_16x16x32_bf16 v[192:195], v[76:79], a[236:239], v[192:195]
    s_waitcnt vmcnt(11)
    v_mfma_f32_16x16x32_bf16 v[96:99], v[80:83], a[240:243], v[96:99]
    buffer_load_dwordx4 v[68:71], v8, s[20:23], s28 offen offset:0 sc1
    buffer_load_dwordx4 v[72:75], v8, s[20:23], s28 offen offset:1024 sc1
    buffer_load_dwordx4 v[76:79], v8, s[20:23], s28 offen offset:2048 sc1
    v_mfma_f32_16x16x32_bf16 v[124:127], v[80:83], a[244:247], v[124:127]
    s_xor_b32 s29, s86, 256
    s_mul_i32 s29, s29, 112
    v_mfma_f32_16x16x32_bf16 v[152:155], v[80:83], a[248:251], v[152:155]
    s_add_u32 s29, s29, s34
    s_add_u32 s28, s29, s4
    v_mfma_f32_16x16x32_bf16 v[180:183], v[80:83], a[252:255], v[180:183]
    v_mfma_f32_16x16x32_bf16 v[100:103], v[84:87], a[240:243], v[100:103]
    v_mfma_f32_16x16x32_bf16 v[128:131], v[84:87], a[244:247], v[128:131]
    v_mfma_f32_16x16x32_bf16 v[156:159], v[84:87], a[248:251], v[156:159]
    v_mfma_f32_16x16x32_bf16 v[184:187], v[84:87], a[252:255], v[184:187]
    s_waitcnt vmcnt(12)
    v_mfma_f32_16x16x32_bf16 v[104:107], v[88:91], a[240:243], v[104:107]
    v_mfma_f32_16x16x32_bf16 v[132:135], v[88:91], a[244:247], v[132:135]
    v_mfma_f32_16x16x32_bf16 v[160:163], v[88:91], a[248:251], v[160:163]
    v_mfma_f32_16x16x32_bf16 v[188:191], v[88:91], a[252:255], v[188:191]
    v_mfma_f32_16x16x32_bf16 v[108:111], v[92:95], a[240:243], v[108:111]
    buffer_load_dwordx4 v[80:83], v8, s[20:23], s28 offen offset:0 sc1
    buffer_load_dwordx4 v[84:87], v8, s[20:23], s28 offen offset:1024 sc1
    buffer_load_dwordx4 v[88:91], v8, s[20:23], s28 offen offset:2048 sc1
    v_mfma_f32_16x16x32_bf16 v[136:139], v[92:95], a[244:247], v[136:139]
    s_add_u32 s28, s29, s5
    v_mfma_f32_16x16x32_bf16 v[164:167], v[92:95], a[248:251], v[164:167]
    v_mfma_f32_16x16x32_bf16 v[192:195], v[92:95], a[252:255], v[192:195]
    s_waitcnt vmcnt(12)
    v_mfma_f32_16x16x32_bf16 v[112:115], v[32:35], a[0:3], v[244:247]
    v_mfma_f32_16x16x32_bf16 v[140:143], v[32:35], a[4:7], 0
    v_mfma_f32_16x16x32_bf16 v[168:171], v[32:35], a[8:11], 0
    v_mfma_f32_16x16x32_bf16 v[196:199], v[32:35], a[12:15], 0
    v_mfma_f32_16x16x32_bf16 v[116:119], v[36:39], a[0:3], v[244:247]
    ds_write_b128 v19, v[124:127] offset:0
    v_mfma_f32_16x16x32_bf16 v[144:147], v[36:39], a[4:7], 0
    ds_write_b128 v19, v[128:131] offset:1024
    v_mfma_f32_16x16x32_bf16 v[172:175], v[36:39], a[8:11], 0
    v_mfma_f32_16x16x32_bf16 v[200:203], v[36:39], a[12:15], 0
    v_mfma_f32_16x16x32_bf16 v[120:123], v[40:43], a[0:3], v[244:247]
    buffer_load_dwordx4 v[92:95], v8, s[20:23], s28 offen offset:0 sc1
    buffer_load_dwordx4 v[32:35], v8, s[20:23], s28 offen offset:1024 sc1
    buffer_load_dwordx4 v[36:39], v8, s[20:23], s28 offen offset:2048 sc1
    v_mfma_f32_16x16x32_bf16 v[148:151], v[40:43], a[4:7], 0
    ds_write_b128 v19, v[132:135] offset:2048
    v_mfma_f32_16x16x32_bf16 v[176:179], v[40:43], a[8:11], 0
    ds_write_b128 v19, v[136:139] offset:3072
    v_mfma_f32_16x16x32_bf16 v[204:207], v[40:43], a[12:15], 0
    s_waitcnt vmcnt(12)
    v_mfma_f32_16x16x32_bf16 v[112:115], v[44:47], a[16:19], v[112:115]
    ds_write_b128 v20, v[152:155] offset:4096
    v_mfma_f32_16x16x32_bf16 v[140:143], v[44:47], a[20:23], v[140:143]
    ds_write_b128 v20, v[156:159] offset:5120
    v_mfma_f32_16x16x32_bf16 v[168:171], v[44:47], a[24:27], v[168:171]
    s_add_u32 s28, s29, s6
    v_mfma_f32_16x16x32_bf16 v[196:199], v[44:47], a[28:31], v[196:199]
    v_mfma_f32_16x16x32_bf16 v[116:119], v[48:51], a[16:19], v[116:119]
    ds_write_b128 v20, v[160:163] offset:6144
    v_mfma_f32_16x16x32_bf16 v[144:147], v[48:51], a[20:23], v[144:147]
    ds_write_b128 v20, v[164:167] offset:7168
    v_mfma_f32_16x16x32_bf16 v[172:175], v[48:51], a[24:27], v[172:175]
    v_mfma_f32_16x16x32_bf16 v[200:203], v[48:51], a[28:31], v[200:203]
    v_mfma_f32_16x16x32_bf16 v[120:123], v[52:55], a[16:19], v[120:123]
    buffer_load_dwordx4 v[40:43], v8, s[20:23], s28 offen offset:0 sc1
    buffer_load_dwordx4 v[44:47], v8, s[20:23], s28 offen offset:1024 sc1
    buffer_load_dwordx4 v[48:51], v8, s[20:23], s28 offen offset:2048 sc1
    v_mfma_f32_16x16x32_bf16 v[148:151], v[52:55], a[20:23], v[148:151]
    ds_write_b128 v21, v[180:183] offset:8192
    v_mfma_f32_16x16x32_bf16 v[176:179], v[52:55], a[24:27], v[176:179]
    ds_write_b128 v21, v[184:187] offset:9216
    v_mfma_f32_16x16x32_bf16 v[204:207], v[52:55], a[28:31], v[204:207]
    s_waitcnt vmcnt(12)
    v_mfma_f32_16x16x32_bf16 v[112:115], v[56:59], a[32:35], v[112:115]
    ds_write_b128 v21, v[188:191] offset:10240
    v_mfma_f32_16x16x32_bf16 v[140:143], v[56:59], a[36:39], v[140:143]
    ds_write_b128 v21, v[192:195] offset:11264
    v_mfma_f32_16x16x32_bf16 v[168:171], v[56:59], a[40:43], v[168:171]
    s_add_u32 s28, s29, s7
    v_mfma_f32_16x16x32_bf16 v[196:199], v[56:59], a[44:47], v[196:199]
    ds_read_b64_tr_b16 a[0:1], v4 offset:0
    v_mfma_f32_16x16x32_bf16 v[116:119], v[60:63], a[32:35], v[116:119]
    ds_read_b64_tr_b16 a[2:3], v4 offset:2048
    v_mfma_f32_16x16x32_bf16 v[144:147], v[60:63], a[36:39], v[144:147]
    ds_read_b64_tr_b16 a[4:5], v5 offset:0
    v_mfma_f32_16x16x32_bf16 v[172:175], v[60:63], a[40:43], v[172:175]
    ds_read_b64_tr_b16 a[6:7], v5 offset:2048
    v_mfma_f32_16x16x32_bf16 v[200:203], v[60:63], a[44:47], v[200:203]
    ds_read_b64_tr_b16 a[8:9], v4 offset:1024
    s_waitcnt lgkmcnt(0)
    s_barrier
    v_mfma_f32_16x16x32_bf16 v[120:123], v[64:67], a[32:35], v[120:123]
    buffer_load_dwordx4 v[52:55], v8, s[20:23], s28 offen offset:0 sc1
    buffer_load_dwordx4 v[56:59], v8, s[20:23], s28 offen offset:1024 sc1
    buffer_load_dwordx4 v[60:63], v8, s[20:23], s28 offen offset:2048 sc1
    v_mfma_f32_16x16x32_bf16 v[148:151], v[64:67], a[36:39], v[148:151]
    ds_read_b128 v[124:127], v17 offset:0
    v_mfma_f32_16x16x32_bf16 v[176:179], v[64:67], a[40:43], v[176:179]
    ds_read_b128 v[152:155], v17 offset:4096
    v_mfma_f32_16x16x32_bf16 v[204:207], v[64:67], a[44:47], v[204:207]
    s_waitcnt vmcnt(12)
    ds_read_b128 v[180:183], v17 offset:8192
    v_mfma_f32_16x16x32_bf16 v[112:115], v[68:71], a[48:51], v[112:115]
    ds_read_b128 v[128:131], v17 offset:1024
    v_mfma_f32_16x16x32_bf16 v[140:143], v[68:71], a[52:55], v[140:143]
    ds_read_b128 v[156:159], v17 offset:5120
    v_mfma_f32_16x16x32_bf16 v[168:171], v[68:71], a[56:59], v[168:171]
    ds_read_b128 v[184:187], v17 offset:9216
    v_mfma_f32_16x16x32_bf16 v[196:199], v[68:71], a[60:63], v[196:199]
    s_xor_b32 s29, s86, 512
    s_mul_i32 s29, s29, 112
    v_mfma_f32_16x16x32_bf16 v[116:119], v[72:75], a[48:51], v[116:119]
    ds_read_b128 v[132:135], v17 offset:2048
    v_mfma_f32_16x16x32_bf16 v[144:147], v[72:75], a[52:55], v[144:147]
    ds_read_b128 v[160:163], v17 offset:6144
    v_mfma_f32_16x16x32_bf16 v[172:175], v[72:75], a[56:59], v[172:175]
    ds_read_b128 v[188:191], v17 offset:10240
    v_mfma_f32_16x16x32_bf16 v[200:203], v[72:75], a[60:63], v[200:203]
    s_add_u32 s29, s29, s34
    s_add_u32 s28, s29, s4
    v_mfma_f32_16x16x32_bf16 v[120:123], v[76:79], a[48:51], v[120:123]
    buffer_load_dwordx4 v[64:67], v8, s[20:23], s28 offen offset:0 sc1
    buffer_load_dwordx4 v[68:71], v8, s[20:23], s28 offen offset:1024 sc1
    buffer_load_dwordx4 v[72:75], v8, s[20:23], s28 offen offset:2048 sc1
    v_mfma_f32_16x16x32_bf16 v[148:151], v[76:79], a[52:55], v[148:151]
    ds_read_b128 v[136:139], v17 offset:3072
    v_mfma_f32_16x16x32_bf16 v[176:179], v[76:79], a[56:59], v[176:179]
    ds_read_b128 v[164:167], v17 offset:7168
    v_mfma_f32_16x16x32_bf16 v[204:207], v[76:79], a[60:63], v[204:207]
    s_waitcnt vmcnt(12)
    ds_read_b128 v[192:195], v17 offset:11264
    v_mfma_f32_16x16x32_bf16 v[112:115], v[80:83], a[64:67], v[112:115]
    s_add_u32 s28, s29, s5
    v_mfma_f32_16x16x32_bf16 v[140:143], v[80:83], a[68:71], v[140:143]
    ds_read_b64_tr_b16 a[10:11], v4 offset:3072
    v_mfma_f32_16x16x32_bf16 v[168:171], v[80:83], a[72:75], v[168:171]
    ds_read_b64_tr_b16 a[12:13], v5 offset:1024
    v_mfma_f32_16x16x32_bf16 v[196:199], v[80:83], a[76:79], v[196:199]
    ds_read_b64_tr_b16 a[14:15], v5 offset:3072
    v_mfma_f32_16x16x32_bf16 v[116:119], v[84:87], a[64:67], v[116:119]
    ds_read_b64_tr_b16 a[16:17], v4 offset:4096
    v_mfma_f32_16x16x32_bf16 v[144:147], v[84:87], a[68:71], v[144:147]
    ds_read_b64_tr_b16 a[18:19], v4 offset:6144
    v_mfma_f32_16x16x32_bf16 v[172:175], v[84:87], a[72:75], v[172:175]
    ds_read_b64_tr_b16 a[20:21], v5 offset:4096
    v_mfma_f32_16x16x32_bf16 v[200:203], v[84:87], a[76:79], v[200:203]
    ds_read_b64_tr_b16 a[22:23], v5 offset:6144
    s_waitcnt lgkmcnt(0)
    v_mfma_f32_16x16x32_bf16 v[120:123], v[88:91], a[64:67], v[120:123]
    buffer_load_dwordx4 v[76:79], v8, s[20:23], s28 offen offset:0 sc1
    buffer_load_dwordx4 v[80:83], v8, s[20:23], s28 offen offset:1024 sc1
    buffer_load_dwordx4 v[84:87], v8, s[20:23], s28 offen offset:2048 sc1
    v_mfma_f32_16x16x32_bf16 v[148:151], v[88:91], a[68:71], v[148:151]
    s_add_u32 s28, s29, s6
    v_mfma_f32_16x16x32_bf16 v[176:179], v[88:91], a[72:75], v[176:179]
    v_add_f32 v96, v96, v124
    v_add_f32 v97, v97, v125
    v_mfma_f32_16x16x32_bf16 v[204:207], v[88:91], a[76:79], v[204:207]
    s_waitcnt vmcnt(12)
    v_mfma_f32_16x16x32_bf16 v[112:115], v[92:95], a[80:83], v[112:115]
    v_add_f32 v98, v98, v126
    v_add_f32 v99, v99, v127
    v_mfma_f32_16x16x32_bf16 v[140:143], v[92:95], a[84:87], v[140:143]
    v_add_f32 v100, v100, v128
    v_add_f32 v101, v101, v129
    v_mfma_f32_16x16x32_bf16 v[168:171], v[92:95], a[88:91], v[168:171]
    v_add_f32 v102, v102, v130
    v_add_f32 v103, v103, v131
    v_mfma_f32_16x16x32_bf16 v[196:199], v[92:95], a[92:95], v[196:199]
    v_add_f32 v152, v152, v180
    v_add_f32 v153, v153, v181
    v_mfma_f32_16x16x32_bf16 v[116:119], v[32:35], a[80:83], v[116:119]
    v_add_f32 v154, v154, v182
    v_add_f32 v155, v155, v183
    v_mfma_f32_16x16x32_bf16 v[144:147], v[32:35], a[84:87], v[144:147]
    v_add_f32 v156, v156, v184
    v_add_f32 v157, v157, v185
    v_mfma_f32_16x16x32_bf16 v[172:175], v[32:35], a[88:91], v[172:175]
    v_add_f32 v158, v158, v186
    v_add_f32 v159, v159, v187
    v_mfma_f32_16x16x32_bf16 v[200:203], v[32:35], a[92:95], v[200:203]
    v_add_f32 v96, v96, v152
    v_add_f32 v97, v97, v153
    v_mfma_f32_16x16x32_bf16 v[120:123], v[36:39], a[80:83], v[120:123]
    buffer_load_dwordx4 v[88:91], v8, s[20:23], s28 offen offset:0 sc1
    buffer_load_dwordx4 v[92:95], v8, s[20:23], s28 offen offset:1024 sc1
    buffer_load_dwordx4 v[32:35], v8, s[20:23], s28 offen offset:2048 sc1
    v_mfma_f32_16x16x32_bf16 v[148:151], v[36:39], a[84:87], v[148:151]
    s_add_u32 s28, s29, s7
    v_mfma_f32_16x16x32_bf16 v[176:179], v[36:39], a[88:91], v[176:179]
    v_add_f32 v98, v98, v154
    v_add_f32 v99, v99, v155
    v_mfma_f32_16x16x32_bf16 v[204:207], v[36:39], a[92:95], v[204:207]
    s_waitcnt vmcnt(12)
    v_mfma_f32_16x16x32_bf16 v[112:115], v[40:43], a[96:99], v[112:115]
    v_add_f32 v100, v100, v156
    v_add_f32 v101, v101, v157
    v_mfma_f32_16x16x32_bf16 v[140:143], v[40:43], a[100:103], v[140:143]
    v_add_f32 v102, v102, v158
    v_add_f32 v103, v103, v159
    v_mfma_f32_16x16x32_bf16 v[168:171], v[40:43], a[104:107], v[168:171]
    v_mul_f32 v96, v96, v208
    v_mul_f32 v97, v97, v209
    v_mfma_f32_16x16x32_bf16 v[196:199], v[40:43], a[108:111], v[196:199]
    v_mul_f32 v98, v98, v210
    v_mul_f32 v99, v99, v211
    v_mfma_f32_16x16x32_bf16 v[116:119], v[44:47], a[96:99], v[116:119]
    v_mul_f32 v100, v100, v212
    v_mul_f32 v101, v101, v213
    v_mfma_f32_16x16x32_bf16 v[144:147], v[44:47], a[100:103], v[144:147]
    v_mul_f32 v102, v102, v214
    v_mul_f32 v103, v103, v215
    v_mfma_f32_16x16x32_bf16 v[172:175], v[44:47], a[104:107], v[172:175]
    v_cvt_pk_bf16_f32 v124, v96, v97
    v_cvt_pk_bf16_f32 v125, v98, v99
    v_mfma_f32_16x16x32_bf16 v[200:203], v[44:47], a[108:111], v[200:203]
    v_cvt_pk_bf16_f32 v126, v100, v101
    v_cvt_pk_bf16_f32 v127, v102, v103
    v_mfma_f32_16x16x32_bf16 v[120:123], v[48:51], a[96:99], v[120:123]
    buffer_load_dwordx4 v[36:39], v8, s[20:23], s28 offen offset:0 sc1
    buffer_load_dwordx4 v[40:43], v8, s[20:23], s28 offen offset:1024 sc1
    buffer_load_dwordx4 v[44:47], v8, s[20:23], s28 offen offset:2048 sc1
    v_mfma_f32_16x16x32_bf16 v[148:151], v[48:51], a[100:103], v[148:151]
    s_xor_b32 s29, s86, 768
    s_mul_i32 s29, s29, 112
    v_mfma_f32_16x16x32_bf16 v[176:179], v[48:51], a[104:107], v[176:179]
    s_add_u32 s29, s29, s34
    s_add_u32 s28, s29, s4
    v_mfma_f32_16x16x32_bf16 v[204:207], v[48:51], a[108:111], v[204:207]
    s_waitcnt vmcnt(12)
    v_mfma_f32_16x16x32_bf16 v[112:115], v[52:55], a[112:115], v[112:115]
    buffer_store_dwordx4 v[124:127], v23, s[20:23], s38 offen offset:0 sc1
    v_add_f32 v104, v104, v132
    v_mfma_f32_16x16x32_bf16 v[140:143], v[52:55], a[116:119], v[140:143]
    v_add_f32 v105, v105, v133
    v_add_f32 v106, v106, v134
    v_mfma_f32_16x16x32_bf16 v[168:171], v[52:55], a[120:123], v[168:171]
    v_add_f32 v107, v107, v135
    v_add_f32 v108, v108, v136
    v_mfma_f32_16x16x32_bf16 v[196:199], v[52:55], a[124:127], v[196:199]
    v_add_f32 v109, v109, v137
    v_add_f32 v110, v110, v138
    v_mfma_f32_16x16x32_bf16 v[116:119], v[56:59], a[112:115], v[116:119]
    v_add_f32 v111, v111, v139
    v_add_f32 v160, v160, v188
    v_mfma_f32_16x16x32_bf16 v[144:147], v[56:59], a[116:119], v[144:147]
    v_add_f32 v161, v161, v189
    v_add_f32 v162, v162, v190
    v_mfma_f32_16x16x32_bf16 v[172:175], v[56:59], a[120:123], v[172:175]
    v_add_f32 v163, v163, v191
    v_add_f32 v164, v164, v192
    v_mfma_f32_16x16x32_bf16 v[200:203], v[56:59], a[124:127], v[200:203]
    v_add_f32 v165, v165, v193
    v_add_f32 v166, v166, v194
    v_mfma_f32_16x16x32_bf16 v[120:123], v[60:63], a[112:115], v[120:123]
    buffer_load_dwordx4 v[48:51], v8, s[20:23], s28 offen offset:0 sc1
    buffer_load_dwordx4 v[52:55], v8, s[20:23], s28 offen offset:1024 sc1
    buffer_load_dwordx4 v[56:59], v8, s[20:23], s28 offen offset:2048 sc1
    v_mfma_f32_16x16x32_bf16 v[148:151], v[60:63], a[116:119], v[148:151]
    s_add_u32 s28, s29, s5
    v_mfma_f32_16x16x32_bf16 v[176:179], v[60:63], a[120:123], v[176:179]
    v_add_f32 v167, v167, v195
    v_add_f32 v104, v104, v160
    v_mfma_f32_16x16x32_bf16 v[204:207], v[60:63], a[124:127], v[204:207]
    s_waitcnt vmcnt(13)
    v_mfma_f32_16x16x32_bf16 v[112:115], v[64:67], a[128:131], v[112:115]
    v_add_f32 v105, v105, v161
    v_add_f32 v106, v106, v162
    v_mfma_f32_16x16x32_bf16 v[140:143], v[64:67], a[132:135], v[140:143]
    v_add_f32 v107, v107, v163
    v_add_f32 v108, v108, v164
    v_mfma_f32_16x16x32_bf16 v[168:171], v[64:67], a[136:139], v[168:171]
    v_add_f32 v109, v109, v165
    v_add_f32 v110, v110, v166
    v_mfma_f32_16x16x32_bf16 v[196:199], v[64:67], a[140:143], v[196:199]
    v_add_f32 v111, v111, v167
    v_mul_f32 v104, v104, v216
    v_mfma_f32_16x16x32_bf16 v[116:119], v[68:71], a[128:131], v[116:119]
    v_mul_f32 v105, v105, v217
    v_mul_f32 v106, v106, v218
    v_mfma_f32_16x16x32_bf16 v[144:147], v[68:71], a[132:135], v[144:147]
    v_mul_f32 v107, v107, v219
    v_mul_f32 v108, v108, v220
    v_mfma_f32_16x16x32_bf16 v[172:175], v[68:71], a[136:139], v[172:175]
    v_mul_f32 v109, v109, v221
    v_mul_f32 v110, v110, v222
    v_mfma_f32_16x16x32_bf16 v[200:203], v[68:71], a[140:143], v[200:203]
    v_mul_f32 v111, v111, v223
    v_cvt_pk_bf16_f32 v128, v104, v105
    v_mfma_f32_16x16x32_bf16 v[120:123], v[72:75], a[128:131], v[120:123]
    buffer_load_dwordx4 v[60:63], v8, s[20:23], s28 offen offset:0 sc1
    buffer_load_dwordx4 v[64:67], v8, s[20:23], s28 offen offset:1024 sc1
    buffer_load_dwordx4 v[68:71], v8, s[20:23], s28 offen offset:2048 sc1
    v_mfma_f32_16x16x32_bf16 v[148:151], v[72:75], a[132:135], v[148:151]
    s_add_u32 s28, s29, s6
    v_mfma_f32_16x16x32_bf16 v[176:179], v[72:75], a[136:139], v[176:179]
    v_cvt_pk_bf16_f32 v129, v106, v107
    v_cvt_pk_bf16_f32 v130, v108, v109
    v_mfma_f32_16x16x32_bf16 v[204:207], v[72:75], a[140:143], v[204:207]
    s_waitcnt vmcnt(13)
    v_mfma_f32_16x16x32_bf16 v[112:115], v[76:79], a[144:147], v[112:115]
    v_cvt_pk_bf16_f32 v131, v110, v111
    buffer_store_dwordx4 v[128:131], v23, s[20:23], s38 offen offset:2048 sc1
    v_mfma_f32_16x16x32_bf16 v[140:143], v[76:79], a[148:151], v[140:143]
    ds_read_b64_tr_b16 a[24:25], v4 offset:5120
    v_mfma_f32_16x16x32_bf16 v[168:171], v[76:79], a[152:155], v[168:171]
    ds_read_b64_tr_b16 a[26:27], v4 offset:7168
    v_mfma_f32_16x16x32_bf16 v[196:199], v[76:79], a[156:159], v[196:199]
    ds_read_b64_tr_b16 a[28:29], v5 offset:5120
    v_mfma_f32_16x16x32_bf16 v[116:119], v[80:83], a[144:147], v[116:119]
    ds_read_b64_tr_b16 a[30:31], v5 offset:7168
    v_mfma_f32_16x16x32_bf16 v[144:147], v[80:83], a[148:151], v[144:147]
    ds_read_b64_tr_b16 a[32:33], v4 offset:8192
    v_mfma_f32_16x16x32_bf16 v[172:175], v[80:83], a[152:155], v[172:175]
    ds_read_b64_tr_b16 a[34:35], v4 offset:10240
    v_mfma_f32_16x16x32_bf16 v[200:203], v[80:83], a[156:159], v[200:203]
    ds_read_b64_tr_b16 a[36:37], v5 offset:8192
    v_mfma_f32_16x16x32_bf16 v[120:123], v[84:87], a[144:147], v[120:123]
    buffer_load_dwordx4 v[72:75], v8, s[20:23], s28 offen offset:0 sc1
    buffer_load_dwordx4 v[76:79], v8, s[20:23], s28 offen offset:1024 sc1
    buffer_load_dwordx4 v[80:83], v8, s[20:23], s28 offen offset:2048 sc1
    v_mfma_f32_16x16x32_bf16 v[148:151], v[84:87], a[148:151], v[148:151]
    s_add_u32 s28, s29, s7
    v_mfma_f32_16x16x32_bf16 v[176:179], v[84:87], a[152:155], v[176:179]
    ds_read_b64_tr_b16 a[38:39], v5 offset:10240
    v_mfma_f32_16x16x32_bf16 v[204:207], v[84:87], a[156:159], v[204:207]
    s_waitcnt vmcnt(14)
    v_mfma_f32_16x16x32_bf16 v[112:115], v[88:91], a[160:163], v[112:115]
    ds_read_b64_tr_b16 a[40:41], v4 offset:9216
    v_mfma_f32_16x16x32_bf16 v[140:143], v[88:91], a[164:167], v[140:143]
    ds_read_b64_tr_b16 a[42:43], v4 offset:11264
    v_mfma_f32_16x16x32_bf16 v[168:171], v[88:91], a[168:171], v[168:171]
    ds_read_b64_tr_b16 a[44:45], v5 offset:9216
    v_mfma_f32_16x16x32_bf16 v[196:199], v[88:91], a[172:175], v[196:199]
    ds_read_b64_tr_b16 a[46:47], v5 offset:11264
    v_mfma_f32_16x16x32_bf16 v[116:119], v[92:95], a[160:163], v[116:119]
    ds_read_b64_tr_b16 a[48:49], v4 offset:12288
    v_mfma_f32_16x16x32_bf16 v[144:147], v[92:95], a[164:167], v[144:147]
    ds_read_b64_tr_b16 a[50:51], v4 offset:14336
    v_mfma_f32_16x16x32_bf16 v[172:175], v[92:95], a[168:171], v[172:175]
    ds_read_b64_tr_b16 a[52:53], v5 offset:12288
    v_mfma_f32_16x16x32_bf16 v[200:203], v[92:95], a[172:175], v[200:203]
    ds_read_b64_tr_b16 a[54:55], v5 offset:14336
    v_mfma_f32_16x16x32_bf16 v[120:123], v[32:35], a[160:163], v[120:123]
    buffer_load_dwordx4 v[84:87], v8, s[20:23], s28 offen offset:0 sc1
    buffer_load_dwordx4 v[88:91], v8, s[20:23], s28 offen offset:1024 sc1
    buffer_load_dwordx4 v[92:95], v8, s[20:23], s28 offen offset:2048 sc1
    v_mfma_f32_16x16x32_bf16 v[148:151], v[32:35], a[164:167], v[148:151]
    ds_read_b64_tr_b16 a[56:57], v4 offset:13312
    v_mfma_f32_16x16x32_bf16 v[176:179], v[32:35], a[168:171], v[176:179]
    s_add_u32 m0, s90, 65536
    s_add_u32 s30, s88, 65536
    buffer_load_dwordx4 v22, s[56:59], s30 offen lds
    v_mfma_f32_16x16x32_bf16 v[204:207], v[32:35], a[172:175], v[204:207]
    s_waitcnt vmcnt(15)
    v_mfma_f32_16x16x32_bf16 v[112:115], v[36:39], a[176:179], v[112:115]
    s_add_u32 m0, s90, 66560
    s_add_u32 s30, s88, 73728
    buffer_load_dwordx4 v22, s[56:59], s30 offen lds
    v_mfma_f32_16x16x32_bf16 v[140:143], v[36:39], a[180:183], v[140:143]
    ds_read_b64_tr_b16 a[58:59], v4 offset:15360
    v_mfma_f32_16x16x32_bf16 v[168:171], v[36:39], a[184:187], v[168:171]
    s_add_u32 m0, s90, 67584
    s_add_u32 s30, s88, 81920
    buffer_load_dwordx4 v22, s[56:59], s30 offen lds
    v_mfma_f32_16x16x32_bf16 v[196:199], v[36:39], a[188:191], v[196:199]
    ds_read_b64_tr_b16 a[60:61], v5 offset:13312
    s_barrier
    v_mfma_f32_16x16x32_bf16 v[116:119], v[40:43], a[176:179], v[116:119]
    s_add_u32 m0, s90, 68608
    s_add_u32 s30, s88, 90112
    buffer_load_dwordx4 v22, s[56:59], s30 offen lds
    v_mfma_f32_16x16x32_bf16 v[144:147], v[40:43], a[180:183], v[144:147]
    ds_read_b64_tr_b16 a[62:63], v5 offset:15360
    v_mfma_f32_16x16x32_bf16 v[172:175], v[40:43], a[184:187], v[172:175]
    s_add_u32 m0, s90, 69632
    s_add_u32 s30, s88, 98304
    buffer_load_dwordx4 v22, s[56:59], s30 offen lds
    v_mfma_f32_16x16x32_bf16 v[200:203], v[40:43], a[188:191], v[200:203]
    ds_read_b64_tr_b16 a[64:65], v4 offset:16384
    v_mfma_f32_16x16x32_bf16 v[120:123], v[44:47], a[176:179], v[120:123]
    s_add_u32 m0, s90, 70656
    s_add_u32 s30, s88, 106496
    buffer_load_dwordx4 v22, s[56:59], s30 offen lds
    v_mfma_f32_16x16x32_bf16 v[148:151], v[44:47], a[180:183], v[148:151]
    ds_read_b64_tr_b16 a[66:67], v4 offset:18432
    v_mfma_f32_16x16x32_bf16 v[176:179], v[44:47], a[184:187], v[176:179]
    s_add_u32 m0, s90, 71680
    s_add_u32 s30, s89, 65536
    buffer_load_dwordx4 v22, s[56:59], s30 offen lds
    v_mfma_f32_16x16x32_bf16 v[204:207], v[44:47], a[188:191], v[204:207]
    s_waitcnt vmcnt(17)
    v_mov_b32 v2, 0
    v_mov_b32 v3, s87
    s_mov_b64 exec, 1
    s_waitcnt vmcnt(13)
    buffer_store_dword v3, v2, s[20:23], s17 offen sc1
    s_mov_b64 exec, -1
    v_mfma_f32_16x16x32_bf16 v[112:115], v[48:51], a[192:195], v[112:115]
    s_add_u32 m0, s90, 72704
    s_add_u32 s30, s89, 73728
    buffer_load_dwordx4 v22, s[56:59], s30 offen lds
    v_mfma_f32_16x16x32_bf16 v[140:143], v[48:51], a[196:199], v[140:143]
    ds_read_b64_tr_b16 a[68:69], v5 offset:16384
    v_mfma_f32_16x16x32_bf16 v[168:171], v[48:51], a[200:203], v[168:171]
    s_add_u32 m0, s90, 73728
    s_add_u32 s30, s89, 81920
    buffer_load_dwordx4 v22, s[56:59], s30 offen lds
    v_mfma_f32_16x16x32_bf16 v[196:199], v[48:51], a[204:207], v[196:199]
    ds_read_b64_tr_b16 a[70:71], v5 offset:18432
    v_mfma_f32_16x16x32_bf16 v[116:119], v[52:55], a[192:195], v[116:119]
    s_add_u32 m0, s90, 74752
    s_add_u32 s30, s89, 90112
    buffer_load_dwordx4 v22, s[56:59], s30 offen lds
    v_mfma_f32_16x16x32_bf16 v[144:147], v[52:55], a[196:199], v[144:147]
    ds_read_b64_tr_b16 a[72:73], v4 offset:17408
    v_mfma_f32_16x16x32_bf16 v[172:175], v[52:55], a[200:203], v[172:175]
    s_add_u32 m0, s90, 75776
    s_add_u32 s30, s89, 98304
    buffer_load_dwordx4 v22, s[56:59], s30 offen lds
    v_mfma_f32_16x16x32_bf16 v[200:203], v[52:55], a[204:207], v[200:203]
    ds_read_b64_tr_b16 a[74:75], v4 offset:19456
    v_mfma_f32_16x16x32_bf16 v[120:123], v[56:59], a[192:195], v[120:123]
    s_add_u32 m0, s90, 76800
    s_add_u32 s30, s89, 106496
    buffer_load_dwordx4 v22, s[56:59], s30 offen lds
    v_mfma_f32_16x16x32_bf16 v[148:151], v[56:59], a[196:199], v[148:151]
    ds_read_b64_tr_b16 a[76:77], v5 offset:17408
    v_mfma_f32_16x16x32_bf16 v[176:179], v[56:59], a[200:203], v[176:179]
    ds_read_b64_tr_b16 a[78:79], v5 offset:19456
    v_mfma_f32_16x16x32_bf16 v[204:207], v[56:59], a[204:207], v[204:207]
    s_waitcnt vmcnt(20)
    v_mfma_f32_16x16x32_bf16 v[112:115], v[60:63], a[208:211], v[112:115]
    ds_read_b64_tr_b16 a[80:81], v4 offset:20480
    v_mfma_f32_16x16x32_bf16 v[140:143], v[60:63], a[212:215], v[140:143]
    ds_read_b64_tr_b16 a[82:83], v4 offset:22528
    v_mfma_f32_16x16x32_bf16 v[168:171], v[60:63], a[216:219], v[168:171]
    ds_read_b64_tr_b16 a[84:85], v5 offset:20480
    v_mfma_f32_16x16x32_bf16 v[196:199], v[60:63], a[220:223], v[196:199]
    ds_read_b64_tr_b16 a[86:87], v5 offset:22528
    v_mfma_f32_16x16x32_bf16 v[116:119], v[64:67], a[208:211], v[116:119]
    ds_read_b64_tr_b16 a[88:89], v4 offset:21504
    v_mfma_f32_16x16x32_bf16 v[144:147], v[64:67], a[212:215], v[144:147]
    ds_read_b64_tr_b16 a[90:91], v4 offset:23552
    v_mfma_f32_16x16x32_bf16 v[172:175], v[64:67], a[216:219], v[172:175]
    ds_read_b64_tr_b16 a[92:93], v5 offset:21504
    v_mfma_f32_16x16x32_bf16 v[200:203], v[64:67], a[220:223], v[200:203]
    ds_read_b64_tr_b16 a[94:95], v5 offset:23552
    v_mfma_f32_16x16x32_bf16 v[120:123], v[68:71], a[208:211], v[120:123]
    ds_read_b64_tr_b16 a[96:97], v4 offset:24576
    v_mfma_f32_16x16x32_bf16 v[148:151], v[68:71], a[212:215], v[148:151]
    ds_read_b64_tr_b16 a[98:99], v4 offset:26624
    v_mfma_f32_16x16x32_bf16 v[176:179], v[68:71], a[216:219], v[176:179]
    ds_read_b64_tr_b16 a[100:101], v5 offset:24576
    v_mfma_f32_16x16x32_bf16 v[204:207], v[68:71], a[220:223], v[204:207]
    s_waitcnt vmcnt(16)
    s_waitcnt vmcnt(18)
    v_mfma_f32_16x16x32_bf16 v[140:143], v[72:75], a[228:231], v[140:143]
    ds_read_b64_tr_b16 a[102:103], v5 offset:26624
    s_waitcnt vmcnt(17)
    v_mfma_f32_16x16x32_bf16 v[144:147], v[76:79], a[228:231], v[144:147]
    ds_read_b64_tr_b16 a[104:105], v4 offset:25600
    s_waitcnt vmcnt(16)
    v_mfma_f32_16x16x32_bf16 v[148:151], v[80:83], a[228:231], v[148:151]
    ds_read_b64_tr_b16 a[106:107], v4 offset:27648
    s_waitcnt vmcnt(15)
    v_mfma_f32_16x16x32_bf16 v[140:143], v[84:87], a[244:247], v[140:143]
    ds_read_b64_tr_b16 a[108:109], v5 offset:25600
    s_waitcnt vmcnt(14)
    v_mfma_f32_16x16x32_bf16 v[144:147], v[88:91], a[244:247], v[144:147]
    ds_read_b64_tr_b16 a[110:111], v5 offset:27648
    s_waitcnt vmcnt(13)
    v_mfma_f32_16x16x32_bf16 v[148:151], v[92:95], a[244:247], v[148:151]
    ds_read_b64_tr_b16 a[112:113], v4 offset:28672
    v_mfma_f32_16x16x32_bf16 v[168:171], v[72:75], a[232:235], v[168:171]
    ds_read_b64_tr_b16 a[114:115], v4 offset:30720
    v_mfma_f32_16x16x32_bf16 v[172:175], v[76:79], a[232:235], v[172:175]
    ds_write_b128 v19, v[140:143] offset:0
    v_mfma_f32_16x16x32_bf16 v[176:179], v[80:83], a[232:235], v[176:179]
    ds_read_b64_tr_b16 a[116:117], v5 offset:28672
    v_mfma_f32_16x16x32_bf16 v[168:171], v[84:87], a[248:251], v[168:171]
    ds_write_b128 v19, v[144:147] offset:1024
    v_mfma_f32_16x16x32_bf16 v[172:175], v[88:91], a[248:251], v[172:175]
    ds_read_b64_tr_b16 a[118:119], v5 offset:30720
    v_mfma_f32_16x16x32_bf16 v[176:179], v[92:95], a[248:251], v[176:179]
    ds_write_b128 v19, v[148:151] offset:2048
    v_mfma_f32_16x16x32_bf16 v[196:199], v[72:75], a[236:239], v[196:199]
    ds_read_b64_tr_b16 a[120:121], v4 offset:29696
    v_mfma_f32_16x16x32_bf16 v[200:203], v[76:79], a[236:239], v[200:203]
    ds_write_b128 v20, v[168:171] offset:4096
    v_mfma_f32_16x16x32_bf16 v[204:207], v[80:83], a[236:239], v[204:207]
    ds_read_b64_tr_b16 a[122:123], v4 offset:31744
    v_mfma_f32_16x16x32_bf16 v[196:199], v[84:87], a[252:255], v[196:199]
    ds_write_b128 v20, v[172:175] offset:5120
    v_mfma_f32_16x16x32_bf16 v[200:203], v[88:91], a[252:255], v[200:203]
    ds_read_b64_tr_b16 a[124:125], v5 offset:29696
    v_mfma_f32_16x16x32_bf16 v[204:207], v[92:95], a[252:255], v[204:207]
    ds_write_b128 v20, v[176:179] offset:6144
    v_mfma_f32_16x16x32_bf16 v[112:115], v[72:75], a[224:227], v[112:115]
    ds_read_b64_tr_b16 a[126:127], v5 offset:31744
    v_mfma_f32_16x16x32_bf16 v[116:119], v[76:79], a[224:227], v[116:119]
    ds_write_b128 v21, v[196:199] offset:8192
    v_mfma_f32_16x16x32_bf16 v[120:123], v[80:83], a[224:227], v[120:123]
    v_mfma_f32_16x16x32_bf16 v[112:115], v[84:87], a[240:243], v[112:115]
    ds_write_b128 v21, v[200:203] offset:9216
    v_mfma_f32_16x16x32_bf16 v[116:119], v[88:91], a[240:243], v[116:119]
    v_mfma_f32_16x16x32_bf16 v[120:123], v[92:95], a[240:243], v[120:123]
    ds_write_b128 v21, v[204:207] offset:10240
    buffer_load_dword v31, v30, s[20:23], s32 offen sc1
    s_waitcnt vmcnt(1) lgkmcnt(0)
    s_barrier
    ds_read_b128 v[140:143], v17 offset:0
    ds_read_b128 v[168:171], v17 offset:4096
    ds_read_b128 v[196:199], v17 offset:8192
    ds_read_b128 v[144:147], v17 offset:1024
    ds_read_b128 v[172:175], v17 offset:5120
    ds_read_b128 v[200:203], v17 offset:9216
    ds_read_b128 v[148:151], v17 offset:2048
    ds_read_b128 v[176:179], v17 offset:6144
    ds_read_b128 v[204:207], v17 offset:10240
    s_waitcnt lgkmcnt(3)
    v_pk_add_f32 v[112:113], v[112:113], v[140:141]
    v_pk_add_f32 v[114:115], v[114:115], v[142:143]
    v_pk_add_f32 v[116:117], v[116:117], v[144:145]
    v_pk_add_f32 v[118:119], v[118:119], v[146:147]
    v_pk_add_f32 v[168:169], v[168:169], v[196:197]
    v_pk_add_f32 v[170:171], v[170:171], v[198:199]
    v_pk_add_f32 v[172:173], v[172:173], v[200:201]
    v_pk_add_f32 v[174:175], v[174:175], v[202:203]
    v_pk_add_f32 v[112:113], v[112:113], v[168:169]
    v_pk_add_f32 v[114:115], v[114:115], v[170:171]
    v_pk_add_f32 v[116:117], v[116:117], v[172:173]
    v_pk_add_f32 v[118:119], v[118:119], v[174:175]
    v_pk_mul_f32 v[112:113], v[112:113], v[224:225]
    v_pk_mul_f32 v[114:115], v[114:115], v[226:227]
    v_pk_mul_f32 v[116:117], v[116:117], v[228:229]
    v_pk_mul_f32 v[118:119], v[118:119], v[230:231]
    v_cvt_pk_bf16_f32 v132, v112, v113
    v_cvt_pk_bf16_f32 v133, v114, v115
    v_cvt_pk_bf16_f32 v134, v116, v117
    v_cvt_pk_bf16_f32 v135, v118, v119
    buffer_store_dwordx4 v[132:135], v23, s[20:23], s39 offen sc1
    s_waitcnt lgkmcnt(0)
    v_pk_add_f32 v[120:121], v[120:121], v[148:149]
    v_pk_add_f32 v[122:123], v[122:123], v[150:151]
    v_pk_add_f32 v[176:177], v[176:177], v[204:205]
    v_pk_add_f32 v[178:179], v[178:179], v[206:207]
    v_pk_add_f32 v[120:121], v[120:121], v[176:177]
    v_pk_add_f32 v[122:123], v[122:123], v[178:179]
    v_pk_mul_f32 v[120:121], v[120:121], v[232:233]
    v_pk_mul_f32 v[122:123], v[122:123], v[234:235]
    v_cvt_pk_bf16_f32 v136, v120, v121
    v_cvt_pk_bf16_f32 v137, v122, v123
    buffer_store_dwordx2 v[136:137], v24, s[20:23], s39 offen offset:2048 sc1
    s_waitcnt vmcnt(2)
    v_cmp_ne_u32 vcc, s87, v31
    s_cbranch_vccz k2_main_kernel_doneD
    s_mov_b32 s40, 100000
    buffer_load_dword v31, v30, s[20:23], s32 offen sc1
k2_main_kernel_pollD:
    s_waitcnt vmcnt(0)
    v_cmp_ne_u32 vcc, s87, v31
    s_cbranch_vccz k2_main_kernel_doneD
    buffer_load_dword v31, v30, s[20:23], s32 offen sc1
    s_sub_u32 s40, s40, 1
    s_cbranch_scc0 k2_main_kernel_pollD
k2_main_kernel_doneD:
    s_xor_b32 s35, s31, 0
    s_mul_i32 s35, s35, 28
    s_add_u32 s35, s35, s33
    buffer_load_dwordx4 v[32:35], v8, s[20:23], s35 offen offset:0 sc1
    buffer_load_dwordx4 v[36:39], v8, s[20:23], s35 offen offset:1024 sc1
    buffer_load_dwordx4 v[40:43], v8, s[20:23], s35 offen offset:2048 sc1
    buffer_load_dwordx4 v[44:47], v8, s[20:23], s35 offen offset:3072 sc1
    s_xor_b32 s35, s31, 256
    s_mul_i32 s35, s35, 28
    s_add_u32 s35, s35, s33
    buffer_load_dwordx4 v[48:51], v8, s[20:23], s35 offen offset:0 sc1
    buffer_load_dwordx4 v[52:55], v8, s[20:23], s35 offen offset:1024 sc1
    buffer_load_dwordx4 v[56:59], v8, s[20:23], s35 offen offset:2048 sc1
    buffer_load_dwordx4 v[60:63], v8, s[20:23], s35 offen offset:3072 sc1
    s_add_u32 s17, s17, 262144
    s_add_u32 s32, s32, 262144
    v_lshlrev_b32 v96, 16, v248
    v_and_b32 v97, 0xffff0000, v248
    v_lshlrev_b32 v98, 16, v249
    v_and_b32 v99, 0xffff0000, v249
    v_lshlrev_b32 v100, 16, v250
    v_and_b32 v101, 0xffff0000, v250
    v_lshlrev_b32 v102, 16, v251
    v_and_b32 v103, 0xffff0000, v251
    v_lshlrev_b32 v104, 16, v252
    v_and_b32 v105, 0xffff0000, v252
    v_lshlrev_b32 v106, 16, v253
    v_and_b32 v107, 0xffff0000, v253
    v_lshlrev_b32 v108, 16, v254
    v_and_b32 v109, 0xffff0000, v254
    v_lshlrev_b32 v110, 16, v255
    v_and_b32 v111, 0xffff0000, v255
    v_mov_b32 v2, 0
    v_mov_b32 v3, s87
    s_mov_b64 exec, 1
    s_waitcnt vmcnt(8)
    buffer_store_dword v3, v2, s[20:23], s17 offen sc1
    s_mov_b64 exec, -1
    s_mul_i32 s30, s16, 24576
    s_add_u32 s30, s30, 65536
    v_add_u32 v4, s30, v15
    v_xor_b32 v5, 64, v4
    s_waitcnt lgkmcnt(0)
    s_waitcnt vmcnt(8)
    v_mfma_f32_32x32x16_bf16 v[96:111], a[0:3], v[32:35], v[96:111]
    s_xor_b32 s35, s31, 512
    s_mul_i32 s35, s35, 28
    s_add_u32 s35, s35, s33
    buffer_load_dwordx4 v[64:67], v8, s[20:23], s35 offen offset:0 sc1
    v_mfma_f32_32x32x16_bf16 v[152:167], a[4:7], v[32:35], 0
    buffer_load_dwordx4 v[68:71], v8, s[20:23], s35 offen offset:1024 sc1
    s_waitcnt vmcnt(9)
    v_mfma_f32_32x32x16_bf16 v[96:111], a[8:11], v[36:39], v[96:111]
    buffer_load_dwordx4 v[72:75], v8, s[20:23], s35 offen offset:2048 sc1
    v_mfma_f32_32x32x16_bf16 v[152:167], a[12:15], v[36:39], v[152:167]
    buffer_load_dwordx4 v[76:79], v8, s[20:23], s35 offen offset:3072 sc1
    s_waitcnt vmcnt(10)
    v_mfma_f32_32x32x16_bf16 v[96:111], a[16:19], v[40:43], v[96:111]
    s_xor_b32 s35, s31, 768
    s_mul_i32 s35, s35, 28
    s_add_u32 s35, s35, s33
    buffer_load_dwordx4 v[80:83], v8, s[20:23], s35 offen offset:0 sc1
    v_mfma_f32_32x32x16_bf16 v[152:167], a[20:23], v[40:43], v[152:167]
    buffer_load_dwordx4 v[84:87], v8, s[20:23], s35 offen offset:1024 sc1
    s_waitcnt vmcnt(11)
    v_mfma_f32_32x32x16_bf16 v[96:111], a[24:27], v[44:47], v[96:111]
    buffer_load_dwordx4 v[88:91], v8, s[20:23], s35 offen offset:2048 sc1
    ds_read_b64_tr_b16 a[128:129], v4 offset:0
    ds_read_b64_tr_b16 a[130:131], v4 offset:2048
    v_mfma_f32_32x32x16_bf16 v[152:167], a[28:31], v[44:47], v[152:167]
    buffer_load_dwordx4 v[92:95], v8, s[20:23], s35 offen offset:3072 sc1
    ds_read_b64_tr_b16 a[132:133], v5 offset:0
    ds_read_b64_tr_b16 a[134:135], v5 offset:2048
    s_waitcnt vmcnt(12)
    v_mfma_f32_32x32x16_bf16 v[96:111], a[32:35], v[48:51], v[96:111]
    ds_read_b64_tr_b16 a[136:137], v4 offset:1024
    ds_read_b64_tr_b16 a[138:139], v4 offset:3072
    v_mfma_f32_32x32x16_bf16 v[152:167], a[36:39], v[48:51], v[152:167]
    ds_read_b64_tr_b16 a[140:141], v5 offset:1024
    ds_read_b64_tr_b16 a[142:143], v5 offset:3072
    s_waitcnt vmcnt(11)
    v_mfma_f32_32x32x16_bf16 v[96:111], a[40:43], v[52:55], v[96:111]
    ds_read_b64_tr_b16 a[144:145], v4 offset:4096
    ds_read_b64_tr_b16 a[146:147], v4 offset:5120
    v_mfma_f32_32x32x16_bf16 v[152:167], a[44:47], v[52:55], v[152:167]
    ds_read_b64_tr_b16 a[148:149], v5 offset:4096
    ds_read_b64_tr_b16 a[150:151], v5 offset:5120
    s_waitcnt vmcnt(10)
    v_mfma_f32_32x32x16_bf16 v[96:111], a[48:51], v[56:59], v[96:111]
    ds_read_b64_tr_b16 a[152:153], v4 offset:6144
    ds_read_b64_tr_b16 a[154:155], v4 offset:8192
    v_mfma_f32_32x32x16_bf16 v[152:167], a[52:55], v[56:59], v[152:167]
    ds_read_b64_tr_b16 a[156:157], v5 offset:6144
    ds_read_b64_tr_b16 a[158:159], v5 offset:8192
    s_waitcnt vmcnt(9)
    v_mfma_f32_32x32x16_bf16 v[96:111], a[56:59], v[60:63], v[96:111]
    ds_read_b64_tr_b16 a[160:161], v4 offset:7168
    ds_read_b64_tr_b16 a[162:163], v4 offset:9216
    v_mfma_f32_32x32x16_bf16 v[152:167], a[60:63], v[60:63], v[152:167]
    ds_read_b64_tr_b16 a[164:165], v5 offset:7168
    ds_read_b64_tr_b16 a[166:167], v5 offset:9216
    s_waitcnt vmcnt(7)
    v_mfma_f32_32x32x16_bf16 v[96:111], a[64:67], v[64:67], v[96:111]
    ds_read_b64_tr_b16 a[168:169], v4 offset:10240
    ds_read_b64_tr_b16 a[170:171], v4 offset:11264
    v_mfma_f32_32x32x16_bf16 v[152:167], a[68:71], v[64:67], v[152:167]
    ds_read_b64_tr_b16 a[172:173], v5 offset:10240
    ds_read_b64_tr_b16 a[174:175], v5 offset:11264
    s_waitcnt vmcnt(6)
    v_mfma_f32_32x32x16_bf16 v[96:111], a[72:75], v[68:71], v[96:111]
    ds_read_b64_tr_b16 a[176:177], v4 offset:12288
    ds_read_b64_tr_b16 a[178:179], v4 offset:14336
    v_mfma_f32_32x32x16_bf16 v[152:167], a[76:79], v[68:71], v[152:167]
    ds_read_b64_tr_b16 a[180:181], v5 offset:12288
    ds_read_b64_tr_b16 a[182:183], v5 offset:14336
    s_waitcnt vmcnt(5)
    v_mfma_f32_32x32x16_bf16 v[96:111], a[80:83], v[72:75], v[96:111]
    buffer_load_dword v31, v30, s[20:23], s32 offen sc1
    ds_read_b64_tr_b16 a[184:185], v4 offset:13312
    ds_read_b64_tr_b16 a[186:187], v4 offset:15360
    v_mfma_f32_32x32x16_bf16 v[152:167], a[84:87], v[72:75], v[152:167]
    ds_read_b64_tr_b16 a[188:189], v5 offset:13312
    ds_read_b64_tr_b16 a[190:191], v5 offset:15360
    s_waitcnt vmcnt(5)
    v_mfma_f32_32x32x16_bf16 v[96:111], a[88:91], v[76:79], v[96:111]
    ds_read_b64_tr_b16 a[192:193], v4 offset:16384
    ds_read_b64_tr_b16 a[194:195], v4 offset:17408
    v_mfma_f32_32x32x16_bf16 v[152:167], a[92:95], v[76:79], v[152:167]
    ds_read_b64_tr_b16 a[196:197], v5 offset:16384
    ds_read_b64_tr_b16 a[198:199], v5 offset:17408
    s_waitcnt vmcnt(4)
    v_mfma_f32_32x32x16_bf16 v[96:111], a[96:99], v[80:83], v[96:111]
    ds_read_b64_tr_b16 a[200:201], v4 offset:18432
    ds_read_b64_tr_b16 a[202:203], v4 offset:20480
    v_mfma_f32_32x32x16_bf16 v[152:167], a[100:103], v[80:83], v[152:167]
    ds_read_b64_tr_b16 a[204:205], v5 offset:18432
    ds_read_b64_tr_b16 a[206:207], v5 offset:20480
    s_waitcnt vmcnt(3)
    v_mfma_f32_32x32x16_bf16 v[96:111], a[104:107], v[84:87], v[96:111]
    ds_read_b64_tr_b16 a[208:209], v4 offset:19456
    ds_read_b64_tr_b16 a[210:211], v4 offset:21504
    v_mfma_f32_32x32x16_bf16 v[152:167], a[108:111], v[84:87], v[152:167]
    ds_read_b64_tr_b16 a[212:213], v5 offset:19456
    ds_read_b64_tr_b16 a[214:215], v5 offset:21504
    s_waitcnt vmcnt(2)
    v_mfma_f32_32x32x16_bf16 v[96:111], a[112:115], v[88:91], v[96:111]
    ds_read_b64_tr_b16 a[216:217], v4 offset:22528
    ds_read_b64_tr_b16 a[218:219], v4 offset:23552
    v_mfma_f32_32x32x16_bf16 v[152:167], a[116:119], v[88:91], v[152:167]
    ds_read_b64_tr_b16 a[220:221], v5 offset:22528
    ds_read_b64_tr_b16 a[222:223], v5 offset:23552
    s_waitcnt vmcnt(1)
    v_mfma_f32_32x32x16_bf16 v[96:111], a[120:123], v[92:95], v[96:111]
    v_mfma_f32_32x32x16_bf16 v[152:167], a[124:127], v[92:95], v[152:167]
    s_waitcnt vmcnt(0)
    v_cmp_ne_u32 vcc, s87, v31
    s_cbranch_vccz k2_main_kernel_doneE
    s_mov_b32 s40, 100000
    buffer_load_dword v31, v30, s[20:23], s32 offen sc1
k2_main_kernel_pollE:
    s_waitcnt vmcnt(0)
    v_cmp_ne_u32 vcc, s87, v31
    s_cbranch_vccz k2_main_kernel_doneE
    buffer_load_dword v31, v30, s[20:23], s32 offen sc1
    s_sub_u32 s40, s40, 1
    s_cbranch_scc0 k2_main_kernel_pollE
k2_main_kernel_doneE:
    s_xor_b32 s35, s31, 0
    s_mul_i32 s35, s35, 28
    s_add_u32 s35, s35, s33
    s_add_u32 s35, s35, 4096
    buffer_load_dwordx4 v[112:115], v8, s[20:23], s35 offen offset:0 sc1
    buffer_load_dwordx4 v[116:119], v8, s[20:23], s35 offen offset:1024 sc1
    buffer_load_dwordx4 v[120:123], v8, s[20:23], s35 offen offset:2048 sc1
    s_xor_b32 s35, s31, 256
    s_mul_i32 s35, s35, 28
    s_add_u32 s35, s35, s33
    s_add_u32 s35, s35, 4096
    buffer_load_dwordx4 v[140:143], v8, s[20:23], s35 offen offset:0 sc1
    buffer_load_dwordx4 v[144:147], v8, s[20:23], s35 offen offset:1024 sc1
    buffer_load_dwordx4 v[148:151], v8, s[20:23], s35 offen offset:2048 sc1
    s_xor_b32 s35, s31, 512
    s_mul_i32 s35, s35, 28
    s_add_u32 s35, s35, s33
    s_add_u32 s35, s35, 4096
    buffer_load_dwordx4 v[168:171], v8, s[20:23], s35 offen offset:0 sc1
    buffer_load_dwordx4 v[172:175], v8, s[20:23], s35 offen offset:1024 sc1
    buffer_load_dwordx4 v[176:179], v8, s[20:23], s35 offen offset:2048 sc1
    s_xor_b32 s35, s31, 768
    s_mul_i32 s35, s35, 28
    s_add_u32 s35, s35, s33
    s_add_u32 s35, s35, 4096
    buffer_load_dwordx4 v[196:199], v8, s[20:23], s35 offen offset:0 sc1
    buffer_load_dwordx4 v[200:203], v8, s[20:23], s35 offen offset:1024 sc1
    buffer_load_dwordx4 v[204:207], v8, s[20:23], s35 offen offset:2048 sc1
    s_waitcnt lgkmcnt(0)
    s_barrier
    s_waitcnt vmcnt(11)
    v_mfma_f32_32x32x16_bf16 v[96:111], a[128:131], v[112:115], v[96:111]
    v_mfma_f32_32x32x16_bf16 v[152:167], a[132:135], v[112:115], v[152:167]
    s_waitcnt vmcnt(10)
    v_mfma_f32_32x32x16_bf16 v[96:111], a[136:139], v[116:119], v[96:111]
    v_mfma_f32_32x32x16_bf16 v[152:167], a[140:143], v[116:119], v[152:167]
    s_waitcnt vmcnt(9)
    v_mfma_f32_32x32x16_bf16 v[96:111], a[144:147], v[120:123], v[96:111]
    v_mfma_f32_32x32x16_bf16 v[152:167], a[148:151], v[120:123], v[152:167]
    s_waitcnt vmcnt(8)
    v_mfma_f32_32x32x16_bf16 v[96:111], a[152:155], v[140:143], v[96:111]
    v_mfma_f32_32x32x16_bf16 v[152:167], a[156:159], v[140:143], v[152:167]
    s_waitcnt vmcnt(7)
    v_mfma_f32_32x32x16_bf16 v[96:111], a[160:163], v[144:147], v[96:111]
    v_mfma_f32_32x32x16_bf16 v[152:167], a[164:167], v[144:147], v[152:167]
    s_waitcnt vmcnt(6)
    v_mfma_f32_32x32x16_bf16 v[96:111], a[168:171], v[148:151], v[96:111]
    v_mfma_f32_32x32x16_bf16 v[152:167], a[172:175], v[148:151], v[152:167]
    s_waitcnt vmcnt(5)
    v_mfma_f32_32x32x16_bf16 v[96:111], a[176:179], v[168:171], v[96:111]
    v_mfma_f32_32x32x16_bf16 v[152:167], a[180:183], v[168:171], v[152:167]
    s_waitcnt vmcnt(4)
    v_mfma_f32_32x32x16_bf16 v[96:111], a[184:187], v[172:175], v[96:111]
    v_mfma_f32_32x32x16_bf16 v[152:167], a[188:191], v[172:175], v[152:167]
    s_waitcnt vmcnt(3)
    v_mfma_f32_32x32x16_bf16 v[96:111], a[192:195], v[176:179], v[96:111]
    v_mfma_f32_32x32x16_bf16 v[152:167], a[196:199], v[176:179], v[152:167]
    s_waitcnt vmcnt(2)
    v_mfma_f32_32x32x16_bf16 v[96:111], a[200:203], v[196:199], v[96:111]
    v_mfma_f32_32x32x16_bf16 v[152:167], a[204:207], v[196:199], v[152:167]
    s_waitcnt vmcnt(1)
    v_mfma_f32_32x32x16_bf16 v[96:111], a[208:211], v[200:203], v[96:111]
    v_mfma_f32_32x32x16_bf16 v[152:167], a[212:215], v[200:203], v[152:167]
    s_waitcnt vmcnt(0)
    v_mfma_f32_32x32x16_bf16 v[96:111], a[216:219], v[204:207], v[96:111]
    v_mfma_f32_32x32x16_bf16 v[152:167], a[220:223], v[204:207], v[152:167]
    s_nop 11
    ds_write_b128 v13, v[152:155] offset:0
    ds_write_b128 v13, v[156:159] offset:1024
    ds_write_b128 v13, v[160:163] offset:2048
    ds_write_b128 v13, v[164:167] offset:3072
    s_waitcnt lgkmcnt(0)
    s_barrier
    ds_read_b128 v[180:183], v14 offset:0
    ds_read_b128 v[184:187], v14 offset:1024
    ds_read_b128 v[188:191], v14 offset:2048
    ds_read_b128 v[192:195], v14 offset:3072
    s_mov_b32 s24, s52
    s_mov_b32 s25, s53
    s_mov_b32 s26, 0x200000
    s_mov_b32 s27, 0x00020000
    v_lshl_add_u32 v2, v9, 4, v16
    s_waitcnt lgkmcnt(0)
    v_pk_add_f32 v[96:97], v[96:97], v[180:181]
    v_pk_add_f32 v[98:99], v[98:99], v[182:183]
    v_pk_add_f32 v[100:101], v[100:101], v[184:185]
    v_pk_add_f32 v[102:103], v[102:103], v[186:187]
    v_pk_add_f32 v[104:105], v[104:105], v[188:189]
    v_pk_add_f32 v[106:107], v[106:107], v[190:191]
    v_pk_add_f32 v[108:109], v[108:109], v[192:193]
    v_pk_add_f32 v[110:111], v[110:111], v[194:195]
    v_cvt_pk_bf16_f32 v180, v96, v97
    v_cvt_pk_bf16_f32 v181, v98, v99
    v_cvt_pk_bf16_f32 v182, v100, v101
    v_cvt_pk_bf16_f32 v183, v102, v103
    v_cvt_pk_bf16_f32 v184, v104, v105
    v_cvt_pk_bf16_f32 v185, v106, v107
    v_cvt_pk_bf16_f32 v186, v108, v109
    v_cvt_pk_bf16_f32 v187, v110, v111
    v_permlane32_swap_b32 v180, v182
    v_permlane32_swap_b32 v181, v183
    v_permlane32_swap_b32 v184, v186
    v_permlane32_swap_b32 v185, v187
    buffer_store_dwordx4 v[180:183], v2, s[24:27], 0 offen
    buffer_store_dwordx4 v[184:187], v2, s[24:27], 0 offen offset:32
k2_main_kernel_end:
    s_endpgm
k2_main_kernel_slow:
    s_add_u32 s40, s18, 0x200000
    s_mov_b32 s35, 64
    v_mov_b32 v22, 0xff800000
    v_mov_b32 v23, 0xff800000
    v_mov_b32 v112, 0xff800000
    v_mov_b32 v113, 0xff800000
k2_main_kernel_mloop:
    buffer_load_dwordx4 v[52:55], v8, s[20:23], s40 offen sc1
    s_waitcnt vmcnt(0)
    v_mfma_f32_32x32x16_bf16 v[96:111], v[52:55], v[24:27], 0
    s_nop 11
    v_max3_f32 v22, v96, v97, v22
    v_max3_f32 v22, v98, v99, v22
    v_max3_f32 v22, v100, v101, v22
    v_max3_f32 v22, v102, v103, v22
    v_max3_f32 v22, v104, v105, v22
    v_max3_f32 v22, v106, v107, v22
    v_max3_f32 v22, v108, v109, v22
    v_max3_f32 v22, v110, v111, v22
    v_mfma_f32_32x32x16_bf16 v[96:111], v[52:55], v[28:31], 0
    s_nop 11
    v_max3_f32 v23, v96, v97, v23
    v_max3_f32 v23, v98, v99, v23
    v_max3_f32 v23, v100, v101, v23
    v_max3_f32 v23, v102, v103, v23
    v_max3_f32 v23, v104, v105, v23
    v_max3_f32 v23, v106, v107, v23
    v_max3_f32 v23, v108, v109, v23
    v_max3_f32 v23, v110, v111, v23
    v_mfma_f32_32x32x16_bf16 v[96:111], v[52:55], v[32:35], 0
    s_nop 11
    v_max3_f32 v112, v96, v97, v112
    v_max3_f32 v112, v98, v99, v112
    v_max3_f32 v112, v100, v101, v112
    v_max3_f32 v112, v102, v103, v112
    v_max3_f32 v112, v104, v105, v112
    v_max3_f32 v112, v106, v107, v112
    v_max3_f32 v112, v108, v109, v112
    v_max3_f32 v112, v110, v111, v112
    v_mfma_f32_32x32x16_bf16 v[96:111], v[52:55], v[36:39], 0
    s_nop 11
    v_max3_f32 v113, v96, v97, v113
    v_max3_f32 v113, v98, v99, v113
    v_max3_f32 v113, v100, v101, v113
    v_max3_f32 v113, v102, v103, v113
    v_max3_f32 v113, v104, v105, v113
    v_max3_f32 v113, v106, v107, v113
    v_max3_f32 v113, v108, v109, v113
    v_max3_f32 v113, v110, v111, v113
    s_add_u32 s40, s40, 1024
    s_sub_u32 s35, s35, 1
    s_cmp_lg_u32 s35, 0
    s_cbranch_scc1 k2_main_kernel_mloop
    v_mov_b32 v2, v22
    s_nop 1
    v_permlane32_swap_b32 v22, v2
    v_max_f32 v22, v22, v2
    v_mov_b32 v2, v23
    s_nop 1
    v_permlane32_swap_b32 v23, v2
    v_max_f32 v23, v23, v2
    v_mov_b32 v2, v112
    s_nop 1
    v_permlane32_swap_b32 v112, v2
    v_max_f32 v112, v112, v2
    v_mov_b32 v2, v113
    s_nop 1
    v_permlane32_swap_b32 v113, v2
    v_max_f32 v113, v113, v2
    s_branch k2_main_kernel_fast
.section .rodata,"a"
.p2align 6
.amdhsa_kernel k2_main_kernel
  .amdhsa_next_free_vgpr 512
  .amdhsa_next_free_sgpr 102
  .amdhsa_accum_offset 256
  .amdhsa_group_segment_fixed_size 0
  .amdhsa_kernarg_size 88
  .amdhsa_user_sgpr_count 2
  .amdhsa_user_sgpr_kernarg_segment_ptr 1
  .amdhsa_system_sgpr_workgroup_id_x 1
.end_amdhsa_kernel
```
